```python
import torch

def _softmax(x, axis=-1):
    return torch.softmax(x, dim=axis)

def _gelu(x):
    return torch.nn.functional.gelu(x, approximate='tanh')

def _silu(x):
    return torch.nn.functional.silu(x)

def _sigmoid(x):
    return torch.sigmoid(x)

def _layernorm(x, axis=-1, eps=1e-05):
    m = x.mean(dim=axis, keepdim=True)
    v = x.var(dim=axis, keepdim=True, unbiased=False)
    return (x - m) / torch.sqrt(v + eps)

def _scatter_add(tgt, idx, src, axis=0):
    return tgt.clone().index_add_(axis, idx, src)

def _segment_sum(src, seg, n):
    out = torch.zeros((n,) + src.shape[1:], dtype=src.dtype)
    return out.index_add_(0, seg, src)

def _pad(x, pw):
    flat = tuple((v for pair in reversed(pw) for v in pair))
    return torch.nn.functional.pad(x, flat)
kernel_name = 'concat_heads__mha_block__memory_aug_recurrent_mem_tr__prompt'

def setup_inputs():

    _w = lambda a: (lambda t: t.to(torch.bfloat16) if t.is_floating_point() else t)(torch.as_tensor(a))

    def _A_setup():
        B, S, D, H = (1, 2048, 512, 32)
        return {'x': _w((lambda *s: torch.randn(*s, dtype=torch.bfloat16) * 0.2)(B, S, D)), 'wqkv': _w((lambda *s: torch.randn(*s, dtype=torch.bfloat16) * 0.2)(D, 3 * D)), 'wo': _w((lambda *s: torch.randn(*s, dtype=torch.bfloat16) * 0.05)(D, D))}
    _A_in = _A_setup()

    def _B_setup():
        B, S, Dm = (1, 2048, 512)
        H, Dh = (32, 128)
        M, seg = (8, 32)
        seg = min(seg, S)
        S = S // seg * seg
        return {'x': _w((lambda *s: torch.randn(*s, dtype=torch.bfloat16) * 0.05)(B, S, Dm)), 'mem0': _w((lambda *s: torch.randn(*s, dtype=torch.bfloat16) * 0.8)(B, M, Dm)), 'Wq': _w((lambda *s: torch.randn(*s, dtype=torch.bfloat16) * 1.6)(Dm, H, Dh) * Dm ** (-0.5)), 'Wk': _w((lambda *s: torch.randn(*s, dtype=torch.bfloat16) * 1.6)(Dm, H, Dh) * Dm ** (-0.5)), 'Wv': _w((lambda *s: torch.randn(*s, dtype=torch.bfloat16) * 0.8)(Dm, H, Dh) * Dm ** (-0.5)), 'Wo': _w((lambda *s: torch.randn(*s, dtype=torch.bfloat16) * 0.8)(H, Dh, Dm) * (H * Dh) ** (-0.5)), 'seg_len': seg}
    _B_in = _B_setup()
    return {'A_x': _A_in['x'], 'A_wqkv': _A_in['wqkv'], 'A_wo': _A_in['wo'], 'B_x': _B_in['x'], 'B_mem0': _B_in['mem0'], 'B_Wq': _B_in['Wq'], 'B_Wk': _B_in['Wk'], 'B_Wv': _B_in['Wv'], 'B_Wo': _B_in['Wo'], 'B_seg_len': _B_in['seg_len']}

def reference(A_x, A_wqkv, A_wo, B_x, B_mem0, B_Wq, B_Wk, B_Wv, B_Wo, B_seg_len):

    def _A_ref(x, wqkv, wo):
        B, S, D = x.shape
        H = 32
        Dh = D // H
        qkv = (lambda x, *d: x.permute(*d))((x @ wqkv).reshape(B, S, 3, H, Dh), 2, 0, 3, 1, 4)
        q, k, v = (qkv[0], qkv[1], qkv[2])
        scores = torch.einsum('bhqd,bhkd->bhqk', q, k) * Dh ** (-0.5)
        p = _softmax(scores, axis=-1)
        o = torch.einsum('bhqk,bhkd->bhqd', p, v)
        return (lambda x, *d: x.permute(*d))(o, 0, 2, 1, 3).reshape(B, S, D) @ wo

    def _B_ref(x, mem0, Wq, Wk, Wv, Wo, seg_len):
        B, S, Dm = x.shape
        H, Dh = (Wq.shape[1], Wq.shape[2])
        M = mem0.shape[1]
        scale = Dh ** (-0.5)
        n_seg = S // seg_len
        L = M + seg_len
        idx = torch.arange(L)
        mask = (idx[:, None] < M) | (idx[:, None] >= idx[None, :])
        mem = mem0
        outs = []
        for s in range(n_seg):
            xs = x[:, s * seg_len:(s + 1) * seg_len, :].clone()
            h = torch.concatenate([mem, xs], axis=1)
            q = torch.einsum('btd,dhe->bhte', h, Wq)
            k = torch.einsum('btd,dhe->bhte', h, Wk)
            v = torch.einsum('btd,dhe->bhte', h, Wv)
            scores = torch.einsum('bhqe,bhke->bhqk', q, k) * scale
            scores = torch.where(mask[None, None], scores, -1000000000.0)
            p = _softmax(scores, axis=-1)
            o = torch.einsum('bhqk,bhke->bhqe', p, v)
            o = torch.einsum('bhte,hed->btd', o, Wo)
            mem = o[:, :M, :].clone()
            outs.append(o[:, M:, :])
        return torch.concatenate(outs, axis=1)
    a = _A_ref(A_x, A_wqkv, A_wo)
    b = _B_ref(B_x, B_mem0, B_Wq, B_Wk, B_Wv, B_Wo, B_seg_len)
    return torch.concatenate([a, b], axis=-1)
```

```asm
; @launch grid=(256,1,1) block=(256,1,1) lds=163840
.amdgcn_target "amdgcn-amd-amdhsa--gfx950"
.text
.globl concat_heads__mha_block__memory_aug_recurrent_mem_tr__prompt_kernel
.p2align 8
.type concat_heads__mha_block__memory_aug_recurrent_mem_tr__prompt_kernel,@function
concat_heads__mha_block__memory_aug_recurrent_mem_tr__prompt_kernel:
  s_cmp_ge_u32 s2, 256
  s_cbranch_scc0 K_go
  s_endpgm
K_go:
  s_load_dwordx2 s[4:5], s[0:1], 96
  s_mov_b32 s6, 268435456
  s_mov_b32 s7, 0x20000
  s_load_dwordx2 s[12:13], s[0:1], 88
  s_mov_b32 s14, 256
  s_mov_b32 s15, 0x20000
  v_lshrrev_b32 v1, 6, v0
  s_mov_b32 s18, 0x40000
  v_readfirstlane_b32 s16, v1
  s_getreg_b32 s3, hwreg(HW_REG_XCC_ID)
  s_and_b32 s3, s3, 7
  s_mul_i32 s20, s3, 24
  s_add_u32 s20, s20, 56
  s_cmp_eq_u32 s3, 0
  s_cselect_b32 s20, 0, s20
  v_mov_b32 v2, 1
  v_mov_b32 v3, 0
  s_cmp_eq_u32 s16, 0
  s_cselect_b64 exec, 1, 0
  s_waitcnt lgkmcnt(0)
  buffer_atomic_add v2, off, s[12:15], s20 sc0
  s_mov_b64 exec, -1
  s_waitcnt vmcnt(0)
    K_got:
  s_cmp_eq_u32 s16, 0
  s_cbranch_scc0 K_tick
  s_mov_b64 exec, 1
  ds_write_b32 v3, v2
  s_waitcnt lgkmcnt(0)
  s_mov_b64 exec, -1
    K_tick:
  s_barrier
  ds_read_b32 v2, v3
  s_waitcnt lgkmcnt(0)
  v_readfirstlane_b32 s17, v2
  s_cmp_lt_u32 s17, 32
  s_cbranch_scc1 K_role
  s_endpgm
    K_role:
  s_cmp_eq_u32 s3, 0
  s_cbranch_scc1 R_entry
  s_sub_u32 s3, s3, 1
  s_lshl_b32 s3, s3, 5
  s_add_u32 s3, s3, s17
  v_and_b32 v255, 63, v0
W_entry:
  s_mov_b32 s48, 1
  s_mov_b32 s44, 32
  s_mov_b32 s39, 65536
  s_and_b32 s23, s3, 1
  s_lshl_b32 s38, s23, 15
  s_mov_b32 s43, 1.0
  s_cmp_ge_u32 s3, 216
  s_cbranch_scc1 FA_entry
  s_mov_b32 s32, s4
  s_mov_b32 s33, s5
  s_mov_b32 s34, s6
  s_mov_b32 s35, 0x20000
  s_cmp_ge_u32 s3, 192
  s_cbranch_scc1 W_a1
  s_lshr_b32 s20, s3, 1
  s_mul_i32 s21, s20, 43691
  s_lshr_b32 s21, s21, 17
  s_mul_i32 s22, s21, 3
  s_sub_u32 s22, s20, s22
  s_lshl_b32 s36, s21, 8
  s_mov_b32 s37, 8192
  s_mov_b32 s47, 0
  s_mov_b32 s42, 524288
  s_lshl_b32 s40, s22, 24
  s_lshl_b32 s20, s21, 13
  s_add_u32 s40, s40, s20
  s_lshl_b32 s20, s23, 18
  s_add_u32 s40, s40, s20
  s_lshl_b32 s45, s21, 7
  s_lshl_b32 s20, s22, 3
  s_add_u32 s45, s45, s20
  s_lshl_b32 s20, s23, 2
  s_add_u32 s45, s45, s20
  s_add_u32 s45, s45, 83886080
  s_load_dwordx2 s[28:29], s[0:1], 24
  s_mov_b32 s30, 2097152
  s_mov_b32 s31, 0x20000
  v_bfe_u32 v81, v255, 3, 1
  v_lshrrev_b32 v82, 4, v255
  v_and_b32 v83, 7, v255
  v_lshlrev_b32 v80, 9, v81
  v_lshl_add_u32 v80, v82, 7, v80
  v_lshl_add_u32 v80, v83, 4, v80
  s_cmp_eq_u32 s22, 2
  s_cbranch_scc1 W_bv
  s_mov_b32 s46, 0
  s_mov_b32 s41, 4096
  s_lshl_b32 s20, s16, 10
  s_add_u32 s40, s40, s20
  s_cmp_eq_u32 s22, 1
  s_cbranch_scc1 W_bk
  s_mov_b32 s43, 0x3e0293ee
  s_load_dwordx2 s[24:25], s[0:1], 40
  s_mov_b32 s26, 4194304
  s_mov_b32 s27, 0x20000
  s_branch G_entry
W_bk:
  s_load_dwordx2 s[24:25], s[0:1], 48
  s_mov_b32 s26, 4194304
  s_mov_b32 s27, 0x20000
  s_branch G_entry
W_bv:
  s_mov_b32 s46, 1
  s_mov_b32 s41, 1024
  s_lshl_b32 s20, s16, 11
  s_add_u32 s40, s40, s20
  s_load_dwordx2 s[24:25], s[0:1], 56
  s_mov_b32 s26, 4194304
  s_mov_b32 s27, 0x20000
  s_branch G_entry
W_a1:
  s_sub_u32 s20, s3, 192
  s_lshl_b32 s45, s20, 2
  s_add_u32 s45, s45, 83890688
  s_lshr_b32 s20, s20, 1
  s_lshl_b32 s36, s20, 8
  s_mov_b32 s37, 3072
  s_mov_b32 s42, 2048
  s_lshl_b32 s40, s20, 19
  s_add_u32 s40, s40, 92274688
  s_lshl_b32 s21, s16, 17
  s_add_u32 s40, s40, s21
  s_lshl_b32 s21, s23, 10
  s_add_u32 s40, s40, s21
  s_load_dwordx2 s[28:29], s[0:1], 0
  s_mov_b32 s30, 2097152
  s_mov_b32 s31, 0x20000
  s_load_dwordx2 s[24:25], s[0:1], 8
  s_mov_b32 s26, 1572864
  s_mov_b32 s27, 0x20000
  s_cmp_ge_u32 s20, 8
  s_cbranch_scc1 W_av
  s_mov_b32 s46, 0
  s_mov_b32 s47, 1
  s_mov_b32 s41, 128
  s_cmp_lt_u32 s20, 4
  s_cselect_b32 s43, 0x3eb8aa3b, 1.0
  v_lshrrev_b32 v81, 5, v255
  v_lshlrev_b32 v80, 16, v81
  v_bfe_u32 v81, v255, 4, 1
  v_lshl_add_u32 v80, v81, 9, v80
  v_bfe_u32 v81, v255, 3, 1
  v_lshl_add_u32 v80, v81, 8, v80
  v_and_b32 v81, 7, v255
  v_lshl_add_u32 v80, v81, 4, v80
  s_branch G_entry
    W_av:
  s_mov_b32 s46, 1
  s_mov_b32 s47, 0
  s_mov_b32 s41, 65536
  v_lshlrev_b32 v80, 4, v255
  s_branch G_entry
W_a3:
  s_mov_b32 s48, 3
  s_mov_b32 s44, 4
  s_mov_b32 s39, 32768
  s_sub_u32 s20, s3, 128
  s_and_b32 s21, s20, 3
  s_lshr_b32 s20, s20, 2
  s_lshl_b32 s38, s20, 17
  s_add_u32 s38, s38, 98566144
  s_mov_b32 s43, 1.0
  s_lshl_b32 s36, s21, 8
  s_mov_b32 s37, 1024
  s_mov_b32 s46, 0
  s_mov_b32 s47, 1
  s_mov_b32 s41, 32768
  s_mov_b32 s42, 65536
  s_lshl_b32 s40, s20, 18
  s_add_u32 s40, s40, s36
  s_lshl_b32 s21, s16, 6
  s_add_u32 s40, s40, s21
  s_lshl_b32 s45, s3, 2
  s_add_u32 s45, s45, 83892224
  v_and_b32 v81, 15, v255
  v_lshrrev_b32 v82, 4, v255
  v_lshlrev_b32 v80, 11, v81
  v_lshl_add_u32 v80, v82, 4, v80
  s_mov_b32 s28, s4
  s_mov_b32 s29, s5
  s_mov_b32 s30, s6
  s_mov_b32 s31, 0x20000
  s_load_dwordx2 s[24:25], s[0:1], 16
  s_mov_b32 s26, 524288
  s_mov_b32 s27, 0x20000
  s_load_dwordx2 s[32:33], s[0:1], 80
  s_mov_b32 s34, 4194304
  s_mov_b32 s35, 0x20000
  s_branch G_entry
G_entry:
  v_and_b32 v84, 15, v255
  v_lshrrev_b32 v85, 4, v255
  v_lshrrev_b32 v86, 2, v84
  v_and_b32 v87, 3, v255
  s_lshr_b32 s20, s16, 1
  s_lshl_b32 s20, s20, 3
  v_lshlrev_b32 v81, 1, v85
  v_or_b32 v81, s20, v81
  v_xor_b32 v81, v81, v84
  s_lshl_b32 s20, s16, 2
  v_add_u32 v82, s20, v85
  v_mul_lo_u32 v82, v82, s37
  v_lshl_add_u32 v81, v81, 4, v82
  s_lshl_b32 s21, s16, 10
  s_add_u32 s21, s21, 32768
  s_lshl_b32 s22, s37, 4
  s_mov_b32 s20, s36
  s_waitcnt lgkmcnt(0)
  s_barrier
  s_mov_b32 m0, s21
  s_add_u32 s21, s21, 4096
  buffer_load_dwordx4 v81, s[24:27], s20 offen lds
  s_add_u32 s20, s20, s22
  s_mov_b32 m0, s21
  s_add_u32 s21, s21, 4096
  buffer_load_dwordx4 v81, s[24:27], s20 offen lds
  s_add_u32 s20, s20, s22
  s_mov_b32 m0, s21
  s_add_u32 s21, s21, 4096
  buffer_load_dwordx4 v81, s[24:27], s20 offen lds
  s_add_u32 s20, s20, s22
  s_mov_b32 m0, s21
  s_add_u32 s21, s21, 4096
  buffer_load_dwordx4 v81, s[24:27], s20 offen lds
  s_add_u32 s20, s20, s22
  s_mov_b32 m0, s21
  s_add_u32 s21, s21, 4096
  buffer_load_dwordx4 v81, s[24:27], s20 offen lds
  s_add_u32 s20, s20, s22
  s_mov_b32 m0, s21
  s_add_u32 s21, s21, 4096
  buffer_load_dwordx4 v81, s[24:27], s20 offen lds
  s_add_u32 s20, s20, s22
  s_mov_b32 m0, s21
  s_add_u32 s21, s21, 4096
  buffer_load_dwordx4 v81, s[24:27], s20 offen lds
  s_add_u32 s20, s20, s22
  s_mov_b32 m0, s21
  s_add_u32 s21, s21, 4096
  buffer_load_dwordx4 v81, s[24:27], s20 offen lds
  s_add_u32 s20, s20, s22
  s_mov_b32 m0, s21
  s_add_u32 s21, s21, 4096
  buffer_load_dwordx4 v81, s[24:27], s20 offen lds
  s_add_u32 s20, s20, s22
  s_mov_b32 m0, s21
  s_add_u32 s21, s21, 4096
  buffer_load_dwordx4 v81, s[24:27], s20 offen lds
  s_add_u32 s20, s20, s22
  s_mov_b32 m0, s21
  s_add_u32 s21, s21, 4096
  buffer_load_dwordx4 v81, s[24:27], s20 offen lds
  s_add_u32 s20, s20, s22
  s_mov_b32 m0, s21
  s_add_u32 s21, s21, 4096
  buffer_load_dwordx4 v81, s[24:27], s20 offen lds
  s_add_u32 s20, s20, s22
  s_mov_b32 m0, s21
  s_add_u32 s21, s21, 4096
  buffer_load_dwordx4 v81, s[24:27], s20 offen lds
  s_add_u32 s20, s20, s22
  s_mov_b32 m0, s21
  s_add_u32 s21, s21, 4096
  buffer_load_dwordx4 v81, s[24:27], s20 offen lds
  s_add_u32 s20, s20, s22
  s_mov_b32 m0, s21
  s_add_u32 s21, s21, 4096
  buffer_load_dwordx4 v81, s[24:27], s20 offen lds
  s_add_u32 s20, s20, s22
  s_mov_b32 m0, s21
  s_add_u32 s21, s21, 4096
  buffer_load_dwordx4 v81, s[24:27], s20 offen lds
  s_add_u32 s20, s20, s22
  s_mov_b32 m0, s21
  s_add_u32 s21, s21, 4096
  buffer_load_dwordx4 v81, s[24:27], s20 offen lds
  s_add_u32 s20, s20, s22
  s_mov_b32 m0, s21
  s_add_u32 s21, s21, 4096
  buffer_load_dwordx4 v81, s[24:27], s20 offen lds
  s_add_u32 s20, s20, s22
  s_mov_b32 m0, s21
  s_add_u32 s21, s21, 4096
  buffer_load_dwordx4 v81, s[24:27], s20 offen lds
  s_add_u32 s20, s20, s22
  s_mov_b32 m0, s21
  s_add_u32 s21, s21, 4096
  buffer_load_dwordx4 v81, s[24:27], s20 offen lds
  s_add_u32 s20, s20, s22
  s_mov_b32 m0, s21
  s_add_u32 s21, s21, 4096
  buffer_load_dwordx4 v81, s[24:27], s20 offen lds
  s_add_u32 s20, s20, s22
  s_mov_b32 m0, s21
  s_add_u32 s21, s21, 4096
  buffer_load_dwordx4 v81, s[24:27], s20 offen lds
  s_add_u32 s20, s20, s22
  s_mov_b32 m0, s21
  s_add_u32 s21, s21, 4096
  buffer_load_dwordx4 v81, s[24:27], s20 offen lds
  s_add_u32 s20, s20, s22
  s_mov_b32 m0, s21
  s_add_u32 s21, s21, 4096
  buffer_load_dwordx4 v81, s[24:27], s20 offen lds
  s_add_u32 s20, s20, s22
  s_mov_b32 m0, s21
  s_add_u32 s21, s21, 4096
  buffer_load_dwordx4 v81, s[24:27], s20 offen lds
  s_add_u32 s20, s20, s22
  s_mov_b32 m0, s21
  s_add_u32 s21, s21, 4096
  buffer_load_dwordx4 v81, s[24:27], s20 offen lds
  s_add_u32 s20, s20, s22
  s_mov_b32 m0, s21
  s_add_u32 s21, s21, 4096
  buffer_load_dwordx4 v81, s[24:27], s20 offen lds
  s_add_u32 s20, s20, s22
  s_mov_b32 m0, s21
  s_add_u32 s21, s21, 4096
  buffer_load_dwordx4 v81, s[24:27], s20 offen lds
  s_add_u32 s20, s20, s22
  s_mov_b32 m0, s21
  s_add_u32 s21, s21, 4096
  buffer_load_dwordx4 v81, s[24:27], s20 offen lds
  s_add_u32 s20, s20, s22
  s_mov_b32 m0, s21
  s_add_u32 s21, s21, 4096
  buffer_load_dwordx4 v81, s[24:27], s20 offen lds
  s_add_u32 s20, s20, s22
  s_mov_b32 m0, s21
  s_add_u32 s21, s21, 4096
  buffer_load_dwordx4 v81, s[24:27], s20 offen lds
  s_add_u32 s20, s20, s22
  s_mov_b32 m0, s21
  s_add_u32 s21, s21, 4096
  buffer_load_dwordx4 v81, s[24:27], s20 offen lds
  s_add_u32 s20, s20, s22
  s_cmp_eq_u32 s48, 1
  s_cbranch_scc0 G_nopf
  s_and_b32 s20, s3, 31
  s_lshl_b32 s20, s20, 2
  s_add_u32 s20, s20, s16
  s_lshl_b32 s20, s20, 13
  s_cmp_ge_u32 s3, 192
  s_cselect_b32 s21, 3, 4
  s_lshl_b32 s21, s21, 18
  v_lshlrev_b32 v82, 7, v255
  v_add_u32 v82, s20, v82
  buffer_load_dword v88, v82, s[28:31], 0 offen
  v_add_u32 v82, s21, v82
  buffer_load_dword v88, v82, s[28:31], 0 offen
  v_add_u32 v82, s21, v82
  buffer_load_dword v88, v82, s[28:31], 0 offen
        G_nopf:
  s_lshl_b32 s20, s16, 3
  s_add_u32 s21, s20, 0
  s_and_b32 s22, s21, 15
  s_lshl_b32 s21, s21, 10
  v_xor_b32 v64, s22, v255
  v_lshlrev_b32 v64, 4, v64
  v_add_u32 v64, s21, v64
  s_add_u32 s21, s20, 1
  s_and_b32 s22, s21, 15
  s_lshl_b32 s21, s21, 10
  v_xor_b32 v65, s22, v255
  v_lshlrev_b32 v65, 4, v65
  v_add_u32 v65, s21, v65
  s_add_u32 s21, s20, 2
  s_and_b32 s22, s21, 15
  s_lshl_b32 s21, s21, 10
  v_xor_b32 v66, s22, v255
  v_lshlrev_b32 v66, 4, v66
  v_add_u32 v66, s21, v66
  s_add_u32 s21, s20, 3
  s_and_b32 s22, s21, 15
  s_lshl_b32 s21, s21, 10
  v_xor_b32 v67, s22, v255
  v_lshlrev_b32 v67, 4, v67
  v_add_u32 v67, s21, v67
  s_add_u32 s21, s20, 4
  s_and_b32 s22, s21, 15
  s_lshl_b32 s21, s21, 10
  v_xor_b32 v68, s22, v255
  v_lshlrev_b32 v68, 4, v68
  v_add_u32 v68, s21, v68
  s_add_u32 s21, s20, 5
  s_and_b32 s22, s21, 15
  s_lshl_b32 s21, s21, 10
  v_xor_b32 v69, s22, v255
  v_lshlrev_b32 v69, 4, v69
  v_add_u32 v69, s21, v69
  s_add_u32 s21, s20, 6
  s_and_b32 s22, s21, 15
  s_lshl_b32 s21, s21, 10
  v_xor_b32 v70, s22, v255
  v_lshlrev_b32 v70, 4, v70
  v_add_u32 v70, s21, v70
  s_add_u32 s21, s20, 7
  s_and_b32 s22, s21, 15
  s_lshl_b32 s21, s21, 10
  v_xor_b32 v71, s22, v255
  v_lshlrev_b32 v71, 4, v71
  v_add_u32 v71, s21, v71
  v_add_u32 v82, 0, v85
  v_xor_b32 v82, v82, v84
  v_lshlrev_b32 v82, 4, v82
  v_lshl_add_u32 v72, v84, 10, v82
  v_mov_b32 v76, v72
  v_add_u32 v82, 4, v85
  v_xor_b32 v82, v82, v84
  v_lshlrev_b32 v82, 4, v82
  v_lshl_add_u32 v73, v84, 10, v82
  v_mov_b32 v77, v73
  v_add_u32 v82, 8, v85
  v_xor_b32 v82, v82, v84
  v_lshlrev_b32 v82, 4, v82
  v_lshl_add_u32 v74, v84, 10, v82
  v_mov_b32 v78, v74
  v_add_u32 v82, 12, v85
  v_xor_b32 v82, v82, v84
  v_lshlrev_b32 v82, 4, v82
  v_lshl_add_u32 v75, v84, 10, v82
  v_mov_b32 v79, v75
  s_cmp_eq_u32 s48, 3
  s_cbranch_scc0 G_nowait
  v_lshlrev_b32 v81, 2, v255
  v_mov_b32 v82, 1
  s_mov_b32 s20, 83890816
  s_cmp_eq_u32 s16, 0
  s_cbranch_scc0 G_wa0_ok
G_wa0:
  buffer_load_dword v83, v81, s[4:7], s20 offen sc1
  s_waitcnt vmcnt(0)
  v_cmp_gt_u32 vcc, v82, v83
  s_cbranch_vccz G_wa0_ok
  s_sleep 16
  s_sub_u32 s18, s18, 1
  s_cbranch_scc0 G_wa0
  s_endpgm
    G_wa0_ok:
  s_mov_b32 s20, 83891072
  s_cmp_eq_u32 s16, 0
  s_cbranch_scc0 G_wa1_ok
G_wa1:
  buffer_load_dword v83, v81, s[4:7], s20 offen sc1
  s_waitcnt vmcnt(0)
  v_cmp_gt_u32 vcc, v82, v83
  s_cbranch_vccz G_wa1_ok
  s_sleep 16
  s_sub_u32 s18, s18, 1
  s_cbranch_scc0 G_wa1
  s_endpgm
    G_wa1_ok:
  s_mov_b32 s20, 83891328
  s_cmp_eq_u32 s16, 0
  s_cbranch_scc0 G_wa2_ok
G_wa2:
  buffer_load_dword v83, v81, s[4:7], s20 offen sc1
  s_waitcnt vmcnt(0)
  v_cmp_gt_u32 vcc, v82, v83
  s_cbranch_vccz G_wa2_ok
  s_sleep 16
  s_sub_u32 s18, s18, 1
  s_cbranch_scc0 G_wa2
  s_endpgm
    G_wa2_ok:
  s_barrier
G_nowait:
  s_lshl_b32 s50, s16, 13
  s_add_u32 m0, s50, 0
  s_nop 0
  buffer_load_dwordx4 v64, s[28:31], s38 offen sc1 lds
  s_add_u32 m0, s50, 1024
  s_nop 0
  buffer_load_dwordx4 v65, s[28:31], s38 offen sc1 lds
  s_add_u32 m0, s50, 2048
  s_nop 0
  buffer_load_dwordx4 v66, s[28:31], s38 offen sc1 lds
  s_add_u32 m0, s50, 3072
  s_nop 0
  buffer_load_dwordx4 v67, s[28:31], s38 offen sc1 lds
  s_add_u32 m0, s50, 4096
  s_nop 0
  buffer_load_dwordx4 v68, s[28:31], s38 offen sc1 lds
  s_add_u32 m0, s50, 5120
  s_nop 0
  buffer_load_dwordx4 v69, s[28:31], s38 offen sc1 lds
  s_add_u32 m0, s50, 6144
  s_nop 0
  buffer_load_dwordx4 v70, s[28:31], s38 offen sc1 lds
  s_add_u32 m0, s50, 7168
  s_nop 0
  buffer_load_dwordx4 v71, s[28:31], s38 offen sc1 lds
  s_add_u32 s38, s38, s39
  s_cmp_eq_u32 s47, 0
  s_cselect_b32 s20, 3, 4
  s_cselect_b32 s21, 32, 8
  v_lshlrev_b32 v81, s20, v87
  s_lshl_b32 s22, s16, 6
  v_add_u32 v81, s22, v81
  v_add_u32 v82, s21, v81
  v_and_b32 v83, 1, v85
  v_lshl_add_u32 v83, v83, 2, v86
  v_lshlrev_b32 v83, 5, v83
  v_xor_b32 v81, v81, v83
  v_xor_b32 v82, v82, v83
  v_lshl_add_u32 v83, v85, 3, v86
  v_lshlrev_b32 v83, 8, v83
  v_add_u32 v83, 32768, v83
  v_add_u32 v81, v81, v83
  v_add_u32 v82, v82, v83
  s_waitcnt vmcnt(8)
  s_barrier
  ds_read_b64_tr_b16 a[0:1], v81 offset:0
  ds_read_b64_tr_b16 a[2:3], v81 offset:1024
  ds_read_b64_tr_b16 a[64:65], v82 offset:0
  ds_read_b64_tr_b16 a[66:67], v82 offset:1024
  ds_read_b64_tr_b16 a[4:5], v81 offset:8192
  ds_read_b64_tr_b16 a[6:7], v81 offset:9216
  ds_read_b64_tr_b16 a[68:69], v82 offset:8192
  ds_read_b64_tr_b16 a[70:71], v82 offset:9216
  s_waitcnt lgkmcnt(0)
  ds_read_b64_tr_b16 a[8:9], v81 offset:16384
  ds_read_b64_tr_b16 a[10:11], v81 offset:17408
  ds_read_b64_tr_b16 a[72:73], v82 offset:16384
  ds_read_b64_tr_b16 a[74:75], v82 offset:17408
  ds_read_b64_tr_b16 a[12:13], v81 offset:24576
  ds_read_b64_tr_b16 a[14:15], v81 offset:25600
  ds_read_b64_tr_b16 a[76:77], v82 offset:24576
  ds_read_b64_tr_b16 a[78:79], v82 offset:25600
  s_waitcnt lgkmcnt(0)
  ds_read_b64_tr_b16 a[16:17], v81 offset:32768
  ds_read_b64_tr_b16 a[18:19], v81 offset:33792
  ds_read_b64_tr_b16 a[80:81], v82 offset:32768
  ds_read_b64_tr_b16 a[82:83], v82 offset:33792
  ds_read_b64_tr_b16 a[20:21], v81 offset:40960
  ds_read_b64_tr_b16 a[22:23], v81 offset:41984
  ds_read_b64_tr_b16 a[84:85], v82 offset:40960
  ds_read_b64_tr_b16 a[86:87], v82 offset:41984
  s_waitcnt lgkmcnt(0)
  ds_read_b64_tr_b16 a[24:25], v81 offset:49152
  ds_read_b64_tr_b16 a[26:27], v81 offset:50176
  ds_read_b64_tr_b16 a[88:89], v82 offset:49152
  ds_read_b64_tr_b16 a[90:91], v82 offset:50176
  ds_read_b64_tr_b16 a[28:29], v81 offset:57344
  ds_read_b64_tr_b16 a[30:31], v81 offset:58368
  ds_read_b64_tr_b16 a[92:93], v82 offset:57344
  ds_read_b64_tr_b16 a[94:95], v82 offset:58368
  s_waitcnt lgkmcnt(0)
  v_add_u32 v81, 0x10000, v81
  v_add_u32 v82, 0x10000, v82
  ds_read_b64_tr_b16 a[32:33], v81 offset:0
  ds_read_b64_tr_b16 a[34:35], v81 offset:1024
  ds_read_b64_tr_b16 a[96:97], v82 offset:0
  ds_read_b64_tr_b16 a[98:99], v82 offset:1024
  ds_read_b64_tr_b16 a[36:37], v81 offset:8192
  ds_read_b64_tr_b16 a[38:39], v81 offset:9216
  ds_read_b64_tr_b16 a[100:101], v82 offset:8192
  ds_read_b64_tr_b16 a[102:103], v82 offset:9216
  s_waitcnt lgkmcnt(0)
  ds_read_b64_tr_b16 a[40:41], v81 offset:16384
  ds_read_b64_tr_b16 a[42:43], v81 offset:17408
  ds_read_b64_tr_b16 a[104:105], v82 offset:16384
  ds_read_b64_tr_b16 a[106:107], v82 offset:17408
  ds_read_b64_tr_b16 a[44:45], v81 offset:24576
  ds_read_b64_tr_b16 a[46:47], v81 offset:25600
  ds_read_b64_tr_b16 a[108:109], v82 offset:24576
  ds_read_b64_tr_b16 a[110:111], v82 offset:25600
  s_waitcnt lgkmcnt(0)
  ds_read_b64_tr_b16 a[48:49], v81 offset:32768
  ds_read_b64_tr_b16 a[50:51], v81 offset:33792
  ds_read_b64_tr_b16 a[112:113], v82 offset:32768
  ds_read_b64_tr_b16 a[114:115], v82 offset:33792
  ds_read_b64_tr_b16 a[52:53], v81 offset:40960
  ds_read_b64_tr_b16 a[54:55], v81 offset:41984
  ds_read_b64_tr_b16 a[116:117], v82 offset:40960
  ds_read_b64_tr_b16 a[118:119], v82 offset:41984
  s_waitcnt lgkmcnt(0)
  ds_read_b64_tr_b16 a[56:57], v81 offset:49152
  ds_read_b64_tr_b16 a[58:59], v81 offset:50176
  ds_read_b64_tr_b16 a[120:121], v82 offset:49152
  ds_read_b64_tr_b16 a[122:123], v82 offset:50176
  ds_read_b64_tr_b16 a[60:61], v81 offset:57344
  ds_read_b64_tr_b16 a[62:63], v81 offset:58368
  ds_read_b64_tr_b16 a[124:125], v82 offset:57344
  ds_read_b64_tr_b16 a[126:127], v82 offset:58368
  s_waitcnt lgkmcnt(0)
  s_barrier
  s_add_u32 s50, s50, 32768
  s_add_u32 m0, s50, 0
  s_nop 0
  buffer_load_dwordx4 v64, s[28:31], s38 offen sc1 lds
  s_add_u32 m0, s50, 1024
  s_nop 0
  buffer_load_dwordx4 v65, s[28:31], s38 offen sc1 lds
  s_add_u32 m0, s50, 2048
  s_nop 0
  buffer_load_dwordx4 v66, s[28:31], s38 offen sc1 lds
  s_add_u32 m0, s50, 3072
  s_nop 0
  buffer_load_dwordx4 v67, s[28:31], s38 offen sc1 lds
  s_add_u32 m0, s50, 4096
  s_nop 0
  buffer_load_dwordx4 v68, s[28:31], s38 offen sc1 lds
  s_add_u32 m0, s50, 5120
  s_nop 0
  buffer_load_dwordx4 v69, s[28:31], s38 offen sc1 lds
  s_add_u32 m0, s50, 6144
  s_nop 0
  buffer_load_dwordx4 v70, s[28:31], s38 offen sc1 lds
  s_add_u32 m0, s50, 7168
  s_nop 0
  buffer_load_dwordx4 v71, s[28:31], s38 offen sc1 lds
  s_add_u32 s38, s38, s39
  s_add_u32 s50, s50, 32768
  s_add_u32 m0, s50, 0
  s_nop 0
  buffer_load_dwordx4 v64, s[28:31], s38 offen sc1 lds
  s_add_u32 m0, s50, 1024
  s_nop 0
  buffer_load_dwordx4 v65, s[28:31], s38 offen sc1 lds
  s_add_u32 m0, s50, 2048
  s_nop 0
  buffer_load_dwordx4 v66, s[28:31], s38 offen sc1 lds
  s_add_u32 m0, s50, 3072
  s_nop 0
  buffer_load_dwordx4 v67, s[28:31], s38 offen sc1 lds
  s_add_u32 m0, s50, 4096
  s_nop 0
  buffer_load_dwordx4 v68, s[28:31], s38 offen sc1 lds
  s_add_u32 m0, s50, 5120
  s_nop 0
  buffer_load_dwordx4 v69, s[28:31], s38 offen sc1 lds
  s_add_u32 m0, s50, 6144
  s_nop 0
  buffer_load_dwordx4 v70, s[28:31], s38 offen sc1 lds
  s_add_u32 m0, s50, 7168
  s_nop 0
  buffer_load_dwordx4 v71, s[28:31], s38 offen sc1 lds
  v_mov_b32 v81, 4
  v_mov_b32 v82, 32
  s_cmp_eq_u32 s16, 0
  s_cbranch_scc0 G_init_ok
G_init:
  buffer_load_dword v83, v81, s[12:15], 0 offen sc1
  s_waitcnt vmcnt(0)
  v_cmp_gt_u32 vcc, v82, v83
  s_cbranch_vccz G_init_ok
  s_sleep 8
  s_sub_u32 s18, s18, 1
  s_cbranch_scc0 G_init
  s_endpgm
    G_init_ok:
  s_waitcnt vmcnt(0)
  s_mov_b32 s49, 0
  s_mov_b64 s[52:53], 0
  s_cmp_eq_u32 s37, 8192
  s_cselect_b64 s[54:55], 1, 0
  s_cmp_eq_u32 s16, 0
  s_cselect_b64 s[54:55], s[54:55], 0
  s_cmp_eq_u32 s46, 0
  s_cbranch_scc0 G_loopV
G_loopT:
  s_waitcnt vmcnt(20)
  s_barrier
  ds_read_b128 v[32:35], v76 offset:0
  ds_read_b128 v[36:39], v76 offset:16384
  ds_read_b128 v[40:43], v77 offset:0
  ds_read_b128 v[44:47], v77 offset:16384
  ds_read_b128 v[48:51], v78 offset:0
  ds_read_b128 v[52:55], v78 offset:16384
  s_add_u32 s20, s49, 3
  s_cmp_lt_u32 s20, s44
  s_cselect_b32 s21, s39, 0
  s_add_u32 s38, s38, s21
  s_add_u32 s50, s50, 32768
  s_and_b32 s50, s50, 0x1ffff
  s_add_u32 s51, s40, s41
  s_sub_i32 s22, s49, 3
  s_max_i32 s22, s22, 0
  s_add_u32 s49, s49, 1
  s_and_b32 s23, s49, 3
  s_lshl_b32 s23, s23, 15
  s_waitcnt lgkmcnt(5)
  v_mfma_f32_16x16x32_bf16 v[0:3], a[0:3], v[32:35], 0
  ds_read_b128 v[56:59], v79 offset:0
  v_mul_f32 v16, s43, v16
  v_mfma_f32_16x16x32_bf16 v[4:7], a[64:67], v[32:35], 0
  s_add_u32 m0, s50, 0
  s_nop 0
  buffer_load_dwordx4 v64, s[28:31], s38 offen sc1 lds
  s_waitcnt lgkmcnt(5)
  v_mfma_f32_16x16x32_bf16 v[8:11], a[0:3], v[36:39], 0
  ds_read_b128 v[60:63], v79 offset:16384
  v_mul_f32 v17, s43, v17
  v_mfma_f32_16x16x32_bf16 v[12:15], a[64:67], v[36:39], 0
  v_mul_f32 v18, s43, v18
  s_waitcnt lgkmcnt(5)
  v_mfma_f32_16x16x32_bf16 v[0:3], a[4:7], v[40:43], v[0:3]
  ds_read_b128 v[32:35], v76 offset:256
  v_mul_f32 v19, s43, v19
  v_mfma_f32_16x16x32_bf16 v[4:7], a[68:71], v[40:43], v[4:7]
  v_mul_f32 v20, s43, v20
  s_waitcnt lgkmcnt(5)
  v_mfma_f32_16x16x32_bf16 v[8:11], a[4:7], v[44:47], v[8:11]
  ds_read_b128 v[36:39], v76 offset:16640
  v_mul_f32 v21, s43, v21
  v_mfma_f32_16x16x32_bf16 v[12:15], a[68:71], v[44:47], v[12:15]
  v_mul_f32 v22, s43, v22
  s_waitcnt lgkmcnt(5)
  v_mfma_f32_16x16x32_bf16 v[0:3], a[8:11], v[48:51], v[0:3]
  ds_read_b128 v[40:43], v77 offset:256
  v_mul_f32 v23, s43, v23
  v_mfma_f32_16x16x32_bf16 v[4:7], a[72:75], v[48:51], v[4:7]
  s_add_u32 m0, s50, 1024
  s_nop 0
  buffer_load_dwordx4 v65, s[28:31], s38 offen sc1 lds
  s_waitcnt lgkmcnt(5)
  v_mfma_f32_16x16x32_bf16 v[8:11], a[8:11], v[52:55], v[8:11]
  ds_read_b128 v[44:47], v77 offset:16640
  v_mul_f32 v24, s43, v24
  v_mfma_f32_16x16x32_bf16 v[12:15], a[72:75], v[52:55], v[12:15]
  v_mul_f32 v25, s43, v25
  s_waitcnt lgkmcnt(5)
  v_mfma_f32_16x16x32_bf16 v[0:3], a[12:15], v[56:59], v[0:3]
  ds_read_b128 v[48:51], v78 offset:256
  v_mul_f32 v26, s43, v26
  v_mfma_f32_16x16x32_bf16 v[4:7], a[76:79], v[56:59], v[4:7]
  v_mul_f32 v27, s43, v27
  s_waitcnt lgkmcnt(5)
  v_mfma_f32_16x16x32_bf16 v[8:11], a[12:15], v[60:63], v[8:11]
  ds_read_b128 v[52:55], v78 offset:16640
  v_mul_f32 v28, s43, v28
  v_mfma_f32_16x16x32_bf16 v[12:15], a[76:79], v[60:63], v[12:15]
  v_mul_f32 v29, s43, v29
  s_waitcnt lgkmcnt(5)
  v_mfma_f32_16x16x32_bf16 v[0:3], a[16:19], v[32:35], v[0:3]
  ds_read_b128 v[56:59], v79 offset:256
  v_mul_f32 v30, s43, v30
  v_mfma_f32_16x16x32_bf16 v[4:7], a[80:83], v[32:35], v[4:7]
  s_add_u32 m0, s50, 2048
  s_nop 0
  buffer_load_dwordx4 v66, s[28:31], s38 offen sc1 lds
  s_waitcnt lgkmcnt(5)
  v_mfma_f32_16x16x32_bf16 v[8:11], a[16:19], v[36:39], v[8:11]
  ds_read_b128 v[60:63], v79 offset:16640
  v_mul_f32 v31, s43, v31
  v_mfma_f32_16x16x32_bf16 v[12:15], a[80:83], v[36:39], v[12:15]
  v_cvt_pk_bf16_f32 v16, v16, v17
  s_waitcnt lgkmcnt(5)
  v_mfma_f32_16x16x32_bf16 v[0:3], a[20:23], v[40:43], v[0:3]
  ds_read_b128 v[32:35], v76 offset:512
  v_cvt_pk_bf16_f32 v17, v18, v19
  v_mfma_f32_16x16x32_bf16 v[4:7], a[84:87], v[40:43], v[4:7]
  v_cvt_pk_bf16_f32 v18, v20, v21
  s_waitcnt lgkmcnt(5)
  v_mfma_f32_16x16x32_bf16 v[8:11], a[20:23], v[44:47], v[8:11]
  ds_read_b128 v[36:39], v76 offset:16896
  v_cvt_pk_bf16_f32 v19, v22, v23
  v_mfma_f32_16x16x32_bf16 v[12:15], a[84:87], v[44:47], v[12:15]
  v_cvt_pk_bf16_f32 v24, v24, v25
  s_waitcnt lgkmcnt(5)
  v_mfma_f32_16x16x32_bf16 v[0:3], a[24:27], v[48:51], v[0:3]
  ds_read_b128 v[40:43], v77 offset:512
  v_cvt_pk_bf16_f32 v25, v26, v27
  v_mfma_f32_16x16x32_bf16 v[4:7], a[88:91], v[48:51], v[4:7]
  s_add_u32 m0, s50, 3072
  s_nop 0
  buffer_load_dwordx4 v67, s[28:31], s38 offen sc1 lds
  s_waitcnt lgkmcnt(5)
  v_mfma_f32_16x16x32_bf16 v[8:11], a[24:27], v[52:55], v[8:11]
  ds_read_b128 v[44:47], v77 offset:16896
  v_cvt_pk_bf16_f32 v26, v28, v29
  v_mfma_f32_16x16x32_bf16 v[12:15], a[88:91], v[52:55], v[12:15]
  v_cvt_pk_bf16_f32 v27, v30, v31
  s_waitcnt lgkmcnt(5)
  v_mfma_f32_16x16x32_bf16 v[0:3], a[28:31], v[56:59], v[0:3]
  ds_read_b128 v[48:51], v78 offset:512
  v_mov_b32 v88, s22
  v_mfma_f32_16x16x32_bf16 v[4:7], a[92:95], v[56:59], v[4:7]
  s_waitcnt lgkmcnt(5)
  v_mfma_f32_16x16x32_bf16 v[8:11], a[28:31], v[60:63], v[8:11]
  ds_read_b128 v[52:55], v78 offset:16896
  v_mfma_f32_16x16x32_bf16 v[12:15], a[92:95], v[60:63], v[12:15]
  s_waitcnt lgkmcnt(5)
  v_mfma_f32_16x16x32_bf16 v[0:3], a[32:35], v[32:35], v[0:3]
  ds_read_b128 v[56:59], v79 offset:512
  v_mfma_f32_16x16x32_bf16 v[4:7], a[96:99], v[32:35], v[4:7]
  s_add_u32 m0, s50, 4096
  s_nop 0
  buffer_load_dwordx4 v68, s[28:31], s38 offen sc1 lds
  s_mov_b64 exec, s[52:53]
  buffer_store_dwordx4 v[16:19], v80, s[32:35], s40 offen sc1
  s_mov_b64 exec, -1
  s_waitcnt lgkmcnt(5)
  v_mfma_f32_16x16x32_bf16 v[8:11], a[32:35], v[36:39], v[8:11]
  ds_read_b128 v[60:63], v79 offset:16896
  v_mfma_f32_16x16x32_bf16 v[12:15], a[96:99], v[36:39], v[12:15]
  s_waitcnt lgkmcnt(5)
  v_mfma_f32_16x16x32_bf16 v[0:3], a[36:39], v[40:43], v[0:3]
  ds_read_b128 v[32:35], v76 offset:768
  v_mfma_f32_16x16x32_bf16 v[4:7], a[100:103], v[40:43], v[4:7]
  s_mov_b64 exec, s[52:53]
  buffer_store_dwordx4 v[24:27], v80, s[32:35], s51 offen sc1
  s_mov_b64 exec, -1
  s_waitcnt lgkmcnt(5)
  v_mfma_f32_16x16x32_bf16 v[8:11], a[36:39], v[44:47], v[8:11]
  ds_read_b128 v[36:39], v76 offset:17152
  v_mfma_f32_16x16x32_bf16 v[12:15], a[100:103], v[44:47], v[12:15]
  s_waitcnt lgkmcnt(5)
  v_mfma_f32_16x16x32_bf16 v[0:3], a[40:43], v[48:51], v[0:3]
  ds_read_b128 v[40:43], v77 offset:768
  v_mfma_f32_16x16x32_bf16 v[4:7], a[104:107], v[48:51], v[4:7]
  s_add_u32 m0, s50, 5120
  s_nop 0
  buffer_load_dwordx4 v69, s[28:31], s38 offen sc1 lds
  s_mov_b64 exec, s[54:55]
  buffer_store_dword v88, off, s[4:7], s45 sc1
  s_mov_b64 exec, -1
  s_waitcnt lgkmcnt(5)
  v_mfma_f32_16x16x32_bf16 v[8:11], a[40:43], v[52:55], v[8:11]
  ds_read_b128 v[44:47], v77 offset:17152
  v_mfma_f32_16x16x32_bf16 v[12:15], a[104:107], v[52:55], v[12:15]
  s_waitcnt lgkmcnt(5)
  v_mfma_f32_16x16x32_bf16 v[0:3], a[44:47], v[56:59], v[0:3]
  ds_read_b128 v[48:51], v78 offset:768
  v_mfma_f32_16x16x32_bf16 v[4:7], a[108:111], v[56:59], v[4:7]
  s_waitcnt lgkmcnt(5)
  v_mfma_f32_16x16x32_bf16 v[8:11], a[44:47], v[60:63], v[8:11]
  ds_read_b128 v[52:55], v78 offset:17152
  v_mfma_f32_16x16x32_bf16 v[12:15], a[108:111], v[60:63], v[12:15]
  s_waitcnt lgkmcnt(5)
  v_mfma_f32_16x16x32_bf16 v[0:3], a[48:51], v[32:35], v[0:3]
  ds_read_b128 v[56:59], v79 offset:768
  v_mfma_f32_16x16x32_bf16 v[4:7], a[112:115], v[32:35], v[4:7]
  s_add_u32 m0, s50, 6144
  s_nop 0
  buffer_load_dwordx4 v70, s[28:31], s38 offen sc1 lds
  s_waitcnt lgkmcnt(5)
  v_mfma_f32_16x16x32_bf16 v[8:11], a[48:51], v[36:39], v[8:11]
  ds_read_b128 v[60:63], v79 offset:17152
  v_mfma_f32_16x16x32_bf16 v[12:15], a[112:115], v[36:39], v[12:15]
  s_waitcnt lgkmcnt(5)
  v_mfma_f32_16x16x32_bf16 v[0:3], a[52:55], v[40:43], v[0:3]
  v_add_u32 v76, s23, v72
  v_mfma_f32_16x16x32_bf16 v[4:7], a[116:119], v[40:43], v[4:7]
  s_waitcnt lgkmcnt(4)
  v_mfma_f32_16x16x32_bf16 v[8:11], a[52:55], v[44:47], v[8:11]
  v_add_u32 v77, s23, v73
  v_mfma_f32_16x16x32_bf16 v[12:15], a[116:119], v[44:47], v[12:15]
  s_waitcnt lgkmcnt(3)
  v_mfma_f32_16x16x32_bf16 v[0:3], a[56:59], v[48:51], v[0:3]
  v_add_u32 v78, s23, v74
  v_mfma_f32_16x16x32_bf16 v[4:7], a[120:123], v[48:51], v[4:7]
  s_add_u32 m0, s50, 7168
  s_nop 0
  buffer_load_dwordx4 v71, s[28:31], s38 offen sc1 lds
  s_waitcnt lgkmcnt(2)
  v_mfma_f32_16x16x32_bf16 v[8:11], a[56:59], v[52:55], v[8:11]
  v_add_u32 v79, s23, v75
  v_mfma_f32_16x16x32_bf16 v[12:15], a[120:123], v[52:55], v[12:15]
  s_waitcnt lgkmcnt(1)
  v_mfma_f32_16x16x32_bf16 v[0:3], a[60:63], v[56:59], v[0:3]
  v_mfma_f32_16x16x32_bf16 v[4:7], a[124:127], v[56:59], v[4:7]
  s_waitcnt lgkmcnt(0)
  v_mfma_f32_16x16x32_bf16 v[8:11], a[60:63], v[60:63], v[8:11]
  v_mfma_f32_16x16x32_bf16 v[12:15], a[124:127], v[60:63], v[12:15]
  s_and_b32 s20, s42, s52
  s_add_u32 s40, s40, s20
  s_mov_b64 s[52:53], -1
  s_waitcnt vmcnt(20)
  s_barrier
  ds_read_b128 v[32:35], v76 offset:0
  ds_read_b128 v[36:39], v76 offset:16384
  ds_read_b128 v[40:43], v77 offset:0
  ds_read_b128 v[44:47], v77 offset:16384
  ds_read_b128 v[48:51], v78 offset:0
  ds_read_b128 v[52:55], v78 offset:16384
  s_add_u32 s20, s49, 3
  s_cmp_lt_u32 s20, s44
  s_cselect_b32 s21, s39, 0
  s_add_u32 s38, s38, s21
  s_add_u32 s50, s50, 32768
  s_and_b32 s50, s50, 0x1ffff
  s_add_u32 s51, s40, s41
  s_sub_i32 s22, s49, 3
  s_max_i32 s22, s22, 0
  s_add_u32 s49, s49, 1
  s_and_b32 s23, s49, 3
  s_lshl_b32 s23, s23, 15
  s_waitcnt lgkmcnt(5)
  v_mfma_f32_16x16x32_bf16 v[16:19], a[0:3], v[32:35], 0
  ds_read_b128 v[56:59], v79 offset:0
  v_mul_f32 v0, s43, v0
  v_mfma_f32_16x16x32_bf16 v[20:23], a[64:67], v[32:35], 0
  s_add_u32 m0, s50, 0
  s_nop 0
  buffer_load_dwordx4 v64, s[28:31], s38 offen sc1 lds
  s_waitcnt lgkmcnt(5)
  v_mfma_f32_16x16x32_bf16 v[24:27], a[0:3], v[36:39], 0
  ds_read_b128 v[60:63], v79 offset:16384
  v_mul_f32 v1, s43, v1
  v_mfma_f32_16x16x32_bf16 v[28:31], a[64:67], v[36:39], 0
  v_mul_f32 v2, s43, v2
  s_waitcnt lgkmcnt(5)
  v_mfma_f32_16x16x32_bf16 v[16:19], a[4:7], v[40:43], v[16:19]
  ds_read_b128 v[32:35], v76 offset:256
  v_mul_f32 v3, s43, v3
  v_mfma_f32_16x16x32_bf16 v[20:23], a[68:71], v[40:43], v[20:23]
  v_mul_f32 v4, s43, v4
  s_waitcnt lgkmcnt(5)
  v_mfma_f32_16x16x32_bf16 v[24:27], a[4:7], v[44:47], v[24:27]
  ds_read_b128 v[36:39], v76 offset:16640
  v_mul_f32 v5, s43, v5
  v_mfma_f32_16x16x32_bf16 v[28:31], a[68:71], v[44:47], v[28:31]
  v_mul_f32 v6, s43, v6
  s_waitcnt lgkmcnt(5)
  v_mfma_f32_16x16x32_bf16 v[16:19], a[8:11], v[48:51], v[16:19]
  ds_read_b128 v[40:43], v77 offset:256
  v_mul_f32 v7, s43, v7
  v_mfma_f32_16x16x32_bf16 v[20:23], a[72:75], v[48:51], v[20:23]
  s_add_u32 m0, s50, 1024
  s_nop 0
  buffer_load_dwordx4 v65, s[28:31], s38 offen sc1 lds
  s_waitcnt lgkmcnt(5)
  v_mfma_f32_16x16x32_bf16 v[24:27], a[8:11], v[52:55], v[24:27]
  ds_read_b128 v[44:47], v77 offset:16640
  v_mul_f32 v8, s43, v8
  v_mfma_f32_16x16x32_bf16 v[28:31], a[72:75], v[52:55], v[28:31]
  v_mul_f32 v9, s43, v9
  s_waitcnt lgkmcnt(5)
  v_mfma_f32_16x16x32_bf16 v[16:19], a[12:15], v[56:59], v[16:19]
  ds_read_b128 v[48:51], v78 offset:256
  v_mul_f32 v10, s43, v10
  v_mfma_f32_16x16x32_bf16 v[20:23], a[76:79], v[56:59], v[20:23]
  v_mul_f32 v11, s43, v11
  s_waitcnt lgkmcnt(5)
  v_mfma_f32_16x16x32_bf16 v[24:27], a[12:15], v[60:63], v[24:27]
  ds_read_b128 v[52:55], v78 offset:16640
  v_mul_f32 v12, s43, v12
  v_mfma_f32_16x16x32_bf16 v[28:31], a[76:79], v[60:63], v[28:31]
  v_mul_f32 v13, s43, v13
  s_waitcnt lgkmcnt(5)
  v_mfma_f32_16x16x32_bf16 v[16:19], a[16:19], v[32:35], v[16:19]
  ds_read_b128 v[56:59], v79 offset:256
  v_mul_f32 v14, s43, v14
  v_mfma_f32_16x16x32_bf16 v[20:23], a[80:83], v[32:35], v[20:23]
  s_add_u32 m0, s50, 2048
  s_nop 0
  buffer_load_dwordx4 v66, s[28:31], s38 offen sc1 lds
  s_waitcnt lgkmcnt(5)
  v_mfma_f32_16x16x32_bf16 v[24:27], a[16:19], v[36:39], v[24:27]
  ds_read_b128 v[60:63], v79 offset:16640
  v_mul_f32 v15, s43, v15
  v_mfma_f32_16x16x32_bf16 v[28:31], a[80:83], v[36:39], v[28:31]
  v_cvt_pk_bf16_f32 v0, v0, v1
  s_waitcnt lgkmcnt(5)
  v_mfma_f32_16x16x32_bf16 v[16:19], a[20:23], v[40:43], v[16:19]
  ds_read_b128 v[32:35], v76 offset:512
  v_cvt_pk_bf16_f32 v1, v2, v3
  v_mfma_f32_16x16x32_bf16 v[20:23], a[84:87], v[40:43], v[20:23]
  v_cvt_pk_bf16_f32 v2, v4, v5
  s_waitcnt lgkmcnt(5)
  v_mfma_f32_16x16x32_bf16 v[24:27], a[20:23], v[44:47], v[24:27]
  ds_read_b128 v[36:39], v76 offset:16896
  v_cvt_pk_bf16_f32 v3, v6, v7
  v_mfma_f32_16x16x32_bf16 v[28:31], a[84:87], v[44:47], v[28:31]
  v_cvt_pk_bf16_f32 v8, v8, v9
  s_waitcnt lgkmcnt(5)
  v_mfma_f32_16x16x32_bf16 v[16:19], a[24:27], v[48:51], v[16:19]
  ds_read_b128 v[40:43], v77 offset:512
  v_cvt_pk_bf16_f32 v9, v10, v11
  v_mfma_f32_16x16x32_bf16 v[20:23], a[88:91], v[48:51], v[20:23]
  s_add_u32 m0, s50, 3072
  s_nop 0
  buffer_load_dwordx4 v67, s[28:31], s38 offen sc1 lds
  s_waitcnt lgkmcnt(5)
  v_mfma_f32_16x16x32_bf16 v[24:27], a[24:27], v[52:55], v[24:27]
  ds_read_b128 v[44:47], v77 offset:16896
  v_cvt_pk_bf16_f32 v10, v12, v13
  v_mfma_f32_16x16x32_bf16 v[28:31], a[88:91], v[52:55], v[28:31]
  v_cvt_pk_bf16_f32 v11, v14, v15
  s_waitcnt lgkmcnt(5)
  v_mfma_f32_16x16x32_bf16 v[16:19], a[28:31], v[56:59], v[16:19]
  ds_read_b128 v[48:51], v78 offset:512
  v_mov_b32 v88, s22
  v_mfma_f32_16x16x32_bf16 v[20:23], a[92:95], v[56:59], v[20:23]
  s_waitcnt lgkmcnt(5)
  v_mfma_f32_16x16x32_bf16 v[24:27], a[28:31], v[60:63], v[24:27]
  ds_read_b128 v[52:55], v78 offset:16896
  v_mfma_f32_16x16x32_bf16 v[28:31], a[92:95], v[60:63], v[28:31]
  s_waitcnt lgkmcnt(5)
  v_mfma_f32_16x16x32_bf16 v[16:19], a[32:35], v[32:35], v[16:19]
  ds_read_b128 v[56:59], v79 offset:512
  v_mfma_f32_16x16x32_bf16 v[20:23], a[96:99], v[32:35], v[20:23]
  s_add_u32 m0, s50, 4096
  s_nop 0
  buffer_load_dwordx4 v68, s[28:31], s38 offen sc1 lds
  s_mov_b64 exec, s[52:53]
  buffer_store_dwordx4 v[0:3], v80, s[32:35], s40 offen sc1
  s_mov_b64 exec, -1
  s_waitcnt lgkmcnt(5)
  v_mfma_f32_16x16x32_bf16 v[24:27], a[32:35], v[36:39], v[24:27]
  ds_read_b128 v[60:63], v79 offset:16896
  v_mfma_f32_16x16x32_bf16 v[28:31], a[96:99], v[36:39], v[28:31]
  s_waitcnt lgkmcnt(5)
  v_mfma_f32_16x16x32_bf16 v[16:19], a[36:39], v[40:43], v[16:19]
  ds_read_b128 v[32:35], v76 offset:768
  v_mfma_f32_16x16x32_bf16 v[20:23], a[100:103], v[40:43], v[20:23]
  s_mov_b64 exec, s[52:53]
  buffer_store_dwordx4 v[8:11], v80, s[32:35], s51 offen sc1
  s_mov_b64 exec, -1
  s_waitcnt lgkmcnt(5)
  v_mfma_f32_16x16x32_bf16 v[24:27], a[36:39], v[44:47], v[24:27]
  ds_read_b128 v[36:39], v76 offset:17152
  v_mfma_f32_16x16x32_bf16 v[28:31], a[100:103], v[44:47], v[28:31]
  s_waitcnt lgkmcnt(5)
  v_mfma_f32_16x16x32_bf16 v[16:19], a[40:43], v[48:51], v[16:19]
  ds_read_b128 v[40:43], v77 offset:768
  v_mfma_f32_16x16x32_bf16 v[20:23], a[104:107], v[48:51], v[20:23]
  s_add_u32 m0, s50, 5120
  s_nop 0
  buffer_load_dwordx4 v69, s[28:31], s38 offen sc1 lds
  s_mov_b64 exec, s[54:55]
  buffer_store_dword v88, off, s[4:7], s45 sc1
  s_mov_b64 exec, -1
  s_waitcnt lgkmcnt(5)
  v_mfma_f32_16x16x32_bf16 v[24:27], a[40:43], v[52:55], v[24:27]
  ds_read_b128 v[44:47], v77 offset:17152
  v_mfma_f32_16x16x32_bf16 v[28:31], a[104:107], v[52:55], v[28:31]
  s_waitcnt lgkmcnt(5)
  v_mfma_f32_16x16x32_bf16 v[16:19], a[44:47], v[56:59], v[16:19]
  ds_read_b128 v[48:51], v78 offset:768
  v_mfma_f32_16x16x32_bf16 v[20:23], a[108:111], v[56:59], v[20:23]
  s_waitcnt lgkmcnt(5)
  v_mfma_f32_16x16x32_bf16 v[24:27], a[44:47], v[60:63], v[24:27]
  ds_read_b128 v[52:55], v78 offset:17152
  v_mfma_f32_16x16x32_bf16 v[28:31], a[108:111], v[60:63], v[28:31]
  s_waitcnt lgkmcnt(5)
  v_mfma_f32_16x16x32_bf16 v[16:19], a[48:51], v[32:35], v[16:19]
  ds_read_b128 v[56:59], v79 offset:768
  v_mfma_f32_16x16x32_bf16 v[20:23], a[112:115], v[32:35], v[20:23]
  s_add_u32 m0, s50, 6144
  s_nop 0
  buffer_load_dwordx4 v70, s[28:31], s38 offen sc1 lds
  s_waitcnt lgkmcnt(5)
  v_mfma_f32_16x16x32_bf16 v[24:27], a[48:51], v[36:39], v[24:27]
  ds_read_b128 v[60:63], v79 offset:17152
  v_mfma_f32_16x16x32_bf16 v[28:31], a[112:115], v[36:39], v[28:31]
  s_waitcnt lgkmcnt(5)
  v_mfma_f32_16x16x32_bf16 v[16:19], a[52:55], v[40:43], v[16:19]
  v_add_u32 v76, s23, v72
  v_mfma_f32_16x16x32_bf16 v[20:23], a[116:119], v[40:43], v[20:23]
  s_waitcnt lgkmcnt(4)
  v_mfma_f32_16x16x32_bf16 v[24:27], a[52:55], v[44:47], v[24:27]
  v_add_u32 v77, s23, v73
  v_mfma_f32_16x16x32_bf16 v[28:31], a[116:119], v[44:47], v[28:31]
  s_waitcnt lgkmcnt(3)
  v_mfma_f32_16x16x32_bf16 v[16:19], a[56:59], v[48:51], v[16:19]
  v_add_u32 v78, s23, v74
  v_mfma_f32_16x16x32_bf16 v[20:23], a[120:123], v[48:51], v[20:23]
  s_add_u32 m0, s50, 7168
  s_nop 0
  buffer_load_dwordx4 v71, s[28:31], s38 offen sc1 lds
  s_waitcnt lgkmcnt(2)
  v_mfma_f32_16x16x32_bf16 v[24:27], a[56:59], v[52:55], v[24:27]
  v_add_u32 v79, s23, v75
  v_mfma_f32_16x16x32_bf16 v[28:31], a[120:123], v[52:55], v[28:31]
  s_waitcnt lgkmcnt(1)
  v_mfma_f32_16x16x32_bf16 v[16:19], a[60:63], v[56:59], v[16:19]
  v_mfma_f32_16x16x32_bf16 v[20:23], a[124:127], v[56:59], v[20:23]
  s_waitcnt lgkmcnt(0)
  v_mfma_f32_16x16x32_bf16 v[24:27], a[60:63], v[60:63], v[24:27]
  v_mfma_f32_16x16x32_bf16 v[28:31], a[124:127], v[60:63], v[28:31]
  s_and_b32 s20, s42, s52
  s_add_u32 s40, s40, s20
  s_mov_b64 s[52:53], -1
  s_cmp_lt_u32 s49, s44
  s_cbranch_scc1 G_loopT
  s_add_u32 s51, s40, s41
  v_mul_f32 v16, s43, v16
  v_mul_f32 v17, s43, v17
  v_mul_f32 v18, s43, v18
  v_mul_f32 v19, s43, v19
  v_mul_f32 v20, s43, v20
  v_mul_f32 v21, s43, v21
  v_mul_f32 v22, s43, v22
  v_mul_f32 v23, s43, v23
  v_mul_f32 v24, s43, v24
  v_mul_f32 v25, s43, v25
  v_mul_f32 v26, s43, v26
  v_mul_f32 v27, s43, v27
  v_mul_f32 v28, s43, v28
  v_mul_f32 v29, s43, v29
  v_mul_f32 v30, s43, v30
  v_mul_f32 v31, s43, v31
  v_cvt_pk_bf16_f32 v16, v16, v17
  v_cvt_pk_bf16_f32 v17, v18, v19
  v_cvt_pk_bf16_f32 v18, v20, v21
  v_cvt_pk_bf16_f32 v19, v22, v23
  v_cvt_pk_bf16_f32 v24, v24, v25
  v_cvt_pk_bf16_f32 v25, v26, v27
  v_cvt_pk_bf16_f32 v26, v28, v29
  v_cvt_pk_bf16_f32 v27, v30, v31
  buffer_store_dwordx4 v[16:19], v80, s[32:35], s40 offen sc1
  buffer_store_dwordx4 v[24:27], v80, s[32:35], s51 offen sc1
  s_branch G_end
G_loopV:
  s_waitcnt vmcnt(20)
  s_barrier
  ds_read_b128 v[32:35], v76 offset:0
  ds_read_b128 v[36:39], v76 offset:16384
  ds_read_b128 v[40:43], v77 offset:0
  ds_read_b128 v[44:47], v77 offset:16384
  ds_read_b128 v[48:51], v78 offset:0
  ds_read_b128 v[52:55], v78 offset:16384
  s_add_u32 s20, s49, 3
  s_cmp_lt_u32 s20, s44
  s_cselect_b32 s21, s39, 0
  s_add_u32 s38, s38, s21
  s_add_u32 s50, s50, 32768
  s_and_b32 s50, s50, 0x1ffff
  s_add_u32 s51, s40, s41
  s_sub_i32 s22, s49, 3
  s_max_i32 s22, s22, 0
  s_add_u32 s49, s49, 1
  s_and_b32 s23, s49, 3
  s_lshl_b32 s23, s23, 15
  s_waitcnt lgkmcnt(5)
  v_mfma_f32_16x16x32_bf16 v[0:3], v[32:35], a[0:3], 0
  ds_read_b128 v[56:59], v79 offset:0
  v_cvt_pk_bf16_f32 v16, v16, v17
  v_mfma_f32_16x16x32_bf16 v[8:11], v[32:35], a[64:67], 0
  s_add_u32 m0, s50, 0
  s_nop 0
  buffer_load_dwordx4 v64, s[28:31], s38 offen sc1 lds
  s_waitcnt lgkmcnt(5)
  v_mfma_f32_16x16x32_bf16 v[4:7], v[36:39], a[0:3], 0
  ds_read_b128 v[60:63], v79 offset:16384
  v_cvt_pk_bf16_f32 v17, v18, v19
  v_mfma_f32_16x16x32_bf16 v[12:15], v[36:39], a[64:67], 0
  v_cvt_pk_bf16_f32 v18, v20, v21
  s_waitcnt lgkmcnt(5)
  v_mfma_f32_16x16x32_bf16 v[0:3], v[40:43], a[4:7], v[0:3]
  ds_read_b128 v[32:35], v76 offset:256
  v_cvt_pk_bf16_f32 v19, v22, v23
  v_mfma_f32_16x16x32_bf16 v[8:11], v[40:43], a[68:71], v[8:11]
  v_cvt_pk_bf16_f32 v24, v24, v25
  s_waitcnt lgkmcnt(5)
  v_mfma_f32_16x16x32_bf16 v[4:7], v[44:47], a[4:7], v[4:7]
  ds_read_b128 v[36:39], v76 offset:16640
  v_cvt_pk_bf16_f32 v25, v26, v27
  v_mfma_f32_16x16x32_bf16 v[12:15], v[44:47], a[68:71], v[12:15]
  v_cvt_pk_bf16_f32 v26, v28, v29
  s_waitcnt lgkmcnt(5)
  v_mfma_f32_16x16x32_bf16 v[0:3], v[48:51], a[8:11], v[0:3]
  ds_read_b128 v[40:43], v77 offset:256
  v_cvt_pk_bf16_f32 v27, v30, v31
  v_mfma_f32_16x16x32_bf16 v[8:11], v[48:51], a[72:75], v[8:11]
  s_add_u32 m0, s50, 1024
  s_nop 0
  buffer_load_dwordx4 v65, s[28:31], s38 offen sc1 lds
  s_waitcnt lgkmcnt(5)
  v_mfma_f32_16x16x32_bf16 v[4:7], v[52:55], a[8:11], v[4:7]
  ds_read_b128 v[44:47], v77 offset:16640
  v_mov_b32 v88, s22
  v_mfma_f32_16x16x32_bf16 v[12:15], v[52:55], a[72:75], v[12:15]
  s_waitcnt lgkmcnt(5)
  v_mfma_f32_16x16x32_bf16 v[0:3], v[56:59], a[12:15], v[0:3]
  ds_read_b128 v[48:51], v78 offset:256
  v_mfma_f32_16x16x32_bf16 v[8:11], v[56:59], a[76:79], v[8:11]
  s_waitcnt lgkmcnt(5)
  v_mfma_f32_16x16x32_bf16 v[4:7], v[60:63], a[12:15], v[4:7]
  ds_read_b128 v[52:55], v78 offset:16640
  v_mfma_f32_16x16x32_bf16 v[12:15], v[60:63], a[76:79], v[12:15]
  s_waitcnt lgkmcnt(5)
  v_mfma_f32_16x16x32_bf16 v[0:3], v[32:35], a[16:19], v[0:3]
  ds_read_b128 v[56:59], v79 offset:256
  v_mfma_f32_16x16x32_bf16 v[8:11], v[32:35], a[80:83], v[8:11]
  s_add_u32 m0, s50, 2048
  s_nop 0
  buffer_load_dwordx4 v66, s[28:31], s38 offen sc1 lds
  s_mov_b64 exec, s[52:53]
  buffer_store_dwordx4 v[16:19], v80, s[32:35], s40 offen sc1
  s_mov_b64 exec, -1
  s_waitcnt lgkmcnt(5)
  v_mfma_f32_16x16x32_bf16 v[4:7], v[36:39], a[16:19], v[4:7]
  ds_read_b128 v[60:63], v79 offset:16640
  v_mfma_f32_16x16x32_bf16 v[12:15], v[36:39], a[80:83], v[12:15]
  s_waitcnt lgkmcnt(5)
  v_mfma_f32_16x16x32_bf16 v[0:3], v[40:43], a[20:23], v[0:3]
  ds_read_b128 v[32:35], v76 offset:512
  v_mfma_f32_16x16x32_bf16 v[8:11], v[40:43], a[84:87], v[8:11]
  s_mov_b64 exec, s[52:53]
  buffer_store_dwordx4 v[24:27], v80, s[32:35], s51 offen sc1
  s_mov_b64 exec, -1
  s_waitcnt lgkmcnt(5)
  v_mfma_f32_16x16x32_bf16 v[4:7], v[44:47], a[20:23], v[4:7]
  ds_read_b128 v[36:39], v76 offset:16896
  v_mfma_f32_16x16x32_bf16 v[12:15], v[44:47], a[84:87], v[12:15]
  s_waitcnt lgkmcnt(5)
  v_mfma_f32_16x16x32_bf16 v[0:3], v[48:51], a[24:27], v[0:3]
  ds_read_b128 v[40:43], v77 offset:512
  v_mfma_f32_16x16x32_bf16 v[8:11], v[48:51], a[88:91], v[8:11]
  s_add_u32 m0, s50, 3072
  s_nop 0
  buffer_load_dwordx4 v67, s[28:31], s38 offen sc1 lds
  s_mov_b64 exec, s[54:55]
  buffer_store_dword v88, off, s[4:7], s45 sc1
  s_mov_b64 exec, -1
  s_waitcnt lgkmcnt(5)
  v_mfma_f32_16x16x32_bf16 v[4:7], v[52:55], a[24:27], v[4:7]
  ds_read_b128 v[44:47], v77 offset:16896
  v_mfma_f32_16x16x32_bf16 v[12:15], v[52:55], a[88:91], v[12:15]
  s_waitcnt lgkmcnt(5)
  v_mfma_f32_16x16x32_bf16 v[0:3], v[56:59], a[28:31], v[0:3]
  ds_read_b128 v[48:51], v78 offset:512
  v_mfma_f32_16x16x32_bf16 v[8:11], v[56:59], a[92:95], v[8:11]
  s_waitcnt lgkmcnt(5)
  v_mfma_f32_16x16x32_bf16 v[4:7], v[60:63], a[28:31], v[4:7]
  ds_read_b128 v[52:55], v78 offset:16896
  v_mfma_f32_16x16x32_bf16 v[12:15], v[60:63], a[92:95], v[12:15]
  s_waitcnt lgkmcnt(5)
  v_mfma_f32_16x16x32_bf16 v[0:3], v[32:35], a[32:35], v[0:3]
  ds_read_b128 v[56:59], v79 offset:512
  v_mfma_f32_16x16x32_bf16 v[8:11], v[32:35], a[96:99], v[8:11]
  s_add_u32 m0, s50, 4096
  s_nop 0
  buffer_load_dwordx4 v68, s[28:31], s38 offen sc1 lds
  s_waitcnt lgkmcnt(5)
  v_mfma_f32_16x16x32_bf16 v[4:7], v[36:39], a[32:35], v[4:7]
  ds_read_b128 v[60:63], v79 offset:16896
  v_mfma_f32_16x16x32_bf16 v[12:15], v[36:39], a[96:99], v[12:15]
  s_waitcnt lgkmcnt(5)
  v_mfma_f32_16x16x32_bf16 v[0:3], v[40:43], a[36:39], v[0:3]
  ds_read_b128 v[32:35], v76 offset:768
  v_mfma_f32_16x16x32_bf16 v[8:11], v[40:43], a[100:103], v[8:11]
  s_waitcnt lgkmcnt(5)
  v_mfma_f32_16x16x32_bf16 v[4:7], v[44:47], a[36:39], v[4:7]
  ds_read_b128 v[36:39], v76 offset:17152
  v_mfma_f32_16x16x32_bf16 v[12:15], v[44:47], a[100:103], v[12:15]
  s_waitcnt lgkmcnt(5)
  v_mfma_f32_16x16x32_bf16 v[0:3], v[48:51], a[40:43], v[0:3]
  ds_read_b128 v[40:43], v77 offset:768
  v_mfma_f32_16x16x32_bf16 v[8:11], v[48:51], a[104:107], v[8:11]
  s_add_u32 m0, s50, 5120
  s_nop 0
  buffer_load_dwordx4 v69, s[28:31], s38 offen sc1 lds
  s_waitcnt lgkmcnt(5)
  v_mfma_f32_16x16x32_bf16 v[4:7], v[52:55], a[40:43], v[4:7]
  ds_read_b128 v[44:47], v77 offset:17152
  v_mfma_f32_16x16x32_bf16 v[12:15], v[52:55], a[104:107], v[12:15]
  s_waitcnt lgkmcnt(5)
  v_mfma_f32_16x16x32_bf16 v[0:3], v[56:59], a[44:47], v[0:3]
  ds_read_b128 v[48:51], v78 offset:768
  v_mfma_f32_16x16x32_bf16 v[8:11], v[56:59], a[108:111], v[8:11]
  s_waitcnt lgkmcnt(5)
  v_mfma_f32_16x16x32_bf16 v[4:7], v[60:63], a[44:47], v[4:7]
  ds_read_b128 v[52:55], v78 offset:17152
  v_mfma_f32_16x16x32_bf16 v[12:15], v[60:63], a[108:111], v[12:15]
  s_waitcnt lgkmcnt(5)
  v_mfma_f32_16x16x32_bf16 v[0:3], v[32:35], a[48:51], v[0:3]
  ds_read_b128 v[56:59], v79 offset:768
  v_mfma_f32_16x16x32_bf16 v[8:11], v[32:35], a[112:115], v[8:11]
  s_add_u32 m0, s50, 6144
  s_nop 0
  buffer_load_dwordx4 v70, s[28:31], s38 offen sc1 lds
  s_waitcnt lgkmcnt(5)
  v_mfma_f32_16x16x32_bf16 v[4:7], v[36:39], a[48:51], v[4:7]
  ds_read_b128 v[60:63], v79 offset:17152
  v_mfma_f32_16x16x32_bf16 v[12:15], v[36:39], a[112:115], v[12:15]
  s_waitcnt lgkmcnt(5)
  v_mfma_f32_16x16x32_bf16 v[0:3], v[40:43], a[52:55], v[0:3]
  v_add_u32 v76, s23, v72
  v_mfma_f32_16x16x32_bf16 v[8:11], v[40:43], a[116:119], v[8:11]
  s_waitcnt lgkmcnt(4)
  v_mfma_f32_16x16x32_bf16 v[4:7], v[44:47], a[52:55], v[4:7]
  v_add_u32 v77, s23, v73
  v_mfma_f32_16x16x32_bf16 v[12:15], v[44:47], a[116:119], v[12:15]
  s_waitcnt lgkmcnt(3)
  v_mfma_f32_16x16x32_bf16 v[0:3], v[48:51], a[56:59], v[0:3]
  v_add_u32 v78, s23, v74
  v_mfma_f32_16x16x32_bf16 v[8:11], v[48:51], a[120:123], v[8:11]
  s_add_u32 m0, s50, 7168
  s_nop 0
  buffer_load_dwordx4 v71, s[28:31], s38 offen sc1 lds
  s_waitcnt lgkmcnt(2)
  v_mfma_f32_16x16x32_bf16 v[4:7], v[52:55], a[56:59], v[4:7]
  v_add_u32 v79, s23, v75
  v_mfma_f32_16x16x32_bf16 v[12:15], v[52:55], a[120:123], v[12:15]
  s_waitcnt lgkmcnt(1)
  v_mfma_f32_16x16x32_bf16 v[0:3], v[56:59], a[60:63], v[0:3]
  v_mfma_f32_16x16x32_bf16 v[8:11], v[56:59], a[124:127], v[8:11]
  s_waitcnt lgkmcnt(0)
  v_mfma_f32_16x16x32_bf16 v[4:7], v[60:63], a[60:63], v[4:7]
  v_mfma_f32_16x16x32_bf16 v[12:15], v[60:63], a[124:127], v[12:15]
  s_and_b32 s20, s42, s52
  s_add_u32 s40, s40, s20
  s_mov_b64 s[52:53], -1
  s_waitcnt vmcnt(20)
  s_barrier
  ds_read_b128 v[32:35], v76 offset:0
  ds_read_b128 v[36:39], v76 offset:16384
  ds_read_b128 v[40:43], v77 offset:0
  ds_read_b128 v[44:47], v77 offset:16384
  ds_read_b128 v[48:51], v78 offset:0
  ds_read_b128 v[52:55], v78 offset:16384
  s_add_u32 s20, s49, 3
  s_cmp_lt_u32 s20, s44
  s_cselect_b32 s21, s39, 0
  s_add_u32 s38, s38, s21
  s_add_u32 s50, s50, 32768
  s_and_b32 s50, s50, 0x1ffff
  s_add_u32 s51, s40, s41
  s_sub_i32 s22, s49, 3
  s_max_i32 s22, s22, 0
  s_add_u32 s49, s49, 1
  s_and_b32 s23, s49, 3
  s_lshl_b32 s23, s23, 15
  s_waitcnt lgkmcnt(5)
  v_mfma_f32_16x16x32_bf16 v[16:19], v[32:35], a[0:3], 0
  ds_read_b128 v[56:59], v79 offset:0
  v_cvt_pk_bf16_f32 v0, v0, v1
  v_mfma_f32_16x16x32_bf16 v[24:27], v[32:35], a[64:67], 0
  s_add_u32 m0, s50, 0
  s_nop 0
  buffer_load_dwordx4 v64, s[28:31], s38 offen sc1 lds
  s_waitcnt lgkmcnt(5)
  v_mfma_f32_16x16x32_bf16 v[20:23], v[36:39], a[0:3], 0
  ds_read_b128 v[60:63], v79 offset:16384
  v_cvt_pk_bf16_f32 v1, v2, v3
  v_mfma_f32_16x16x32_bf16 v[28:31], v[36:39], a[64:67], 0
  v_cvt_pk_bf16_f32 v2, v4, v5
  s_waitcnt lgkmcnt(5)
  v_mfma_f32_16x16x32_bf16 v[16:19], v[40:43], a[4:7], v[16:19]
  ds_read_b128 v[32:35], v76 offset:256
  v_cvt_pk_bf16_f32 v3, v6, v7
  v_mfma_f32_16x16x32_bf16 v[24:27], v[40:43], a[68:71], v[24:27]
  v_cvt_pk_bf16_f32 v8, v8, v9
  s_waitcnt lgkmcnt(5)
  v_mfma_f32_16x16x32_bf16 v[20:23], v[44:47], a[4:7], v[20:23]
  ds_read_b128 v[36:39], v76 offset:16640
  v_cvt_pk_bf16_f32 v9, v10, v11
  v_mfma_f32_16x16x32_bf16 v[28:31], v[44:47], a[68:71], v[28:31]
  v_cvt_pk_bf16_f32 v10, v12, v13
  s_waitcnt lgkmcnt(5)
  v_mfma_f32_16x16x32_bf16 v[16:19], v[48:51], a[8:11], v[16:19]
  ds_read_b128 v[40:43], v77 offset:256
  v_cvt_pk_bf16_f32 v11, v14, v15
  v_mfma_f32_16x16x32_bf16 v[24:27], v[48:51], a[72:75], v[24:27]
  s_add_u32 m0, s50, 1024
  s_nop 0
  buffer_load_dwordx4 v65, s[28:31], s38 offen sc1 lds
  s_waitcnt lgkmcnt(5)
  v_mfma_f32_16x16x32_bf16 v[20:23], v[52:55], a[8:11], v[20:23]
  ds_read_b128 v[44:47], v77 offset:16640
  v_mov_b32 v88, s22
  v_mfma_f32_16x16x32_bf16 v[28:31], v[52:55], a[72:75], v[28:31]
  s_waitcnt lgkmcnt(5)
  v_mfma_f32_16x16x32_bf16 v[16:19], v[56:59], a[12:15], v[16:19]
  ds_read_b128 v[48:51], v78 offset:256
  v_mfma_f32_16x16x32_bf16 v[24:27], v[56:59], a[76:79], v[24:27]
  s_waitcnt lgkmcnt(5)
  v_mfma_f32_16x16x32_bf16 v[20:23], v[60:63], a[12:15], v[20:23]
  ds_read_b128 v[52:55], v78 offset:16640
  v_mfma_f32_16x16x32_bf16 v[28:31], v[60:63], a[76:79], v[28:31]
  s_waitcnt lgkmcnt(5)
  v_mfma_f32_16x16x32_bf16 v[16:19], v[32:35], a[16:19], v[16:19]
  ds_read_b128 v[56:59], v79 offset:256
  v_mfma_f32_16x16x32_bf16 v[24:27], v[32:35], a[80:83], v[24:27]
  s_add_u32 m0, s50, 2048
  s_nop 0
  buffer_load_dwordx4 v66, s[28:31], s38 offen sc1 lds
  s_mov_b64 exec, s[52:53]
  buffer_store_dwordx4 v[0:3], v80, s[32:35], s40 offen sc1
  s_mov_b64 exec, -1
  s_waitcnt lgkmcnt(5)
  v_mfma_f32_16x16x32_bf16 v[20:23], v[36:39], a[16:19], v[20:23]
  ds_read_b128 v[60:63], v79 offset:16640
  v_mfma_f32_16x16x32_bf16 v[28:31], v[36:39], a[80:83], v[28:31]
  s_waitcnt lgkmcnt(5)
  v_mfma_f32_16x16x32_bf16 v[16:19], v[40:43], a[20:23], v[16:19]
  ds_read_b128 v[32:35], v76 offset:512
  v_mfma_f32_16x16x32_bf16 v[24:27], v[40:43], a[84:87], v[24:27]
  s_mov_b64 exec, s[52:53]
  buffer_store_dwordx4 v[8:11], v80, s[32:35], s51 offen sc1
  s_mov_b64 exec, -1
  s_waitcnt lgkmcnt(5)
  v_mfma_f32_16x16x32_bf16 v[20:23], v[44:47], a[20:23], v[20:23]
  ds_read_b128 v[36:39], v76 offset:16896
  v_mfma_f32_16x16x32_bf16 v[28:31], v[44:47], a[84:87], v[28:31]
  s_waitcnt lgkmcnt(5)
  v_mfma_f32_16x16x32_bf16 v[16:19], v[48:51], a[24:27], v[16:19]
  ds_read_b128 v[40:43], v77 offset:512
  v_mfma_f32_16x16x32_bf16 v[24:27], v[48:51], a[88:91], v[24:27]
  s_add_u32 m0, s50, 3072
  s_nop 0
  buffer_load_dwordx4 v67, s[28:31], s38 offen sc1 lds
  s_mov_b64 exec, s[54:55]
  buffer_store_dword v88, off, s[4:7], s45 sc1
  s_mov_b64 exec, -1
  s_waitcnt lgkmcnt(5)
  v_mfma_f32_16x16x32_bf16 v[20:23], v[52:55], a[24:27], v[20:23]
  ds_read_b128 v[44:47], v77 offset:16896
  v_mfma_f32_16x16x32_bf16 v[28:31], v[52:55], a[88:91], v[28:31]
  s_waitcnt lgkmcnt(5)
  v_mfma_f32_16x16x32_bf16 v[16:19], v[56:59], a[28:31], v[16:19]
  ds_read_b128 v[48:51], v78 offset:512
  v_mfma_f32_16x16x32_bf16 v[24:27], v[56:59], a[92:95], v[24:27]
  s_waitcnt lgkmcnt(5)
  v_mfma_f32_16x16x32_bf16 v[20:23], v[60:63], a[28:31], v[20:23]
  ds_read_b128 v[52:55], v78 offset:16896
  v_mfma_f32_16x16x32_bf16 v[28:31], v[60:63], a[92:95], v[28:31]
  s_waitcnt lgkmcnt(5)
  v_mfma_f32_16x16x32_bf16 v[16:19], v[32:35], a[32:35], v[16:19]
  ds_read_b128 v[56:59], v79 offset:512
  v_mfma_f32_16x16x32_bf16 v[24:27], v[32:35], a[96:99], v[24:27]
  s_add_u32 m0, s50, 4096
  s_nop 0
  buffer_load_dwordx4 v68, s[28:31], s38 offen sc1 lds
  s_waitcnt lgkmcnt(5)
  v_mfma_f32_16x16x32_bf16 v[20:23], v[36:39], a[32:35], v[20:23]
  ds_read_b128 v[60:63], v79 offset:16896
  v_mfma_f32_16x16x32_bf16 v[28:31], v[36:39], a[96:99], v[28:31]
  s_waitcnt lgkmcnt(5)
  v_mfma_f32_16x16x32_bf16 v[16:19], v[40:43], a[36:39], v[16:19]
  ds_read_b128 v[32:35], v76 offset:768
  v_mfma_f32_16x16x32_bf16 v[24:27], v[40:43], a[100:103], v[24:27]
  s_waitcnt lgkmcnt(5)
  v_mfma_f32_16x16x32_bf16 v[20:23], v[44:47], a[36:39], v[20:23]
  ds_read_b128 v[36:39], v76 offset:17152
  v_mfma_f32_16x16x32_bf16 v[28:31], v[44:47], a[100:103], v[28:31]
  s_waitcnt lgkmcnt(5)
  v_mfma_f32_16x16x32_bf16 v[16:19], v[48:51], a[40:43], v[16:19]
  ds_read_b128 v[40:43], v77 offset:768
  v_mfma_f32_16x16x32_bf16 v[24:27], v[48:51], a[104:107], v[24:27]
  s_add_u32 m0, s50, 5120
  s_nop 0
  buffer_load_dwordx4 v69, s[28:31], s38 offen sc1 lds
  s_waitcnt lgkmcnt(5)
  v_mfma_f32_16x16x32_bf16 v[20:23], v[52:55], a[40:43], v[20:23]
  ds_read_b128 v[44:47], v77 offset:17152
  v_mfma_f32_16x16x32_bf16 v[28:31], v[52:55], a[104:107], v[28:31]
  s_waitcnt lgkmcnt(5)
  v_mfma_f32_16x16x32_bf16 v[16:19], v[56:59], a[44:47], v[16:19]
  ds_read_b128 v[48:51], v78 offset:768
  v_mfma_f32_16x16x32_bf16 v[24:27], v[56:59], a[108:111], v[24:27]
  s_waitcnt lgkmcnt(5)
  v_mfma_f32_16x16x32_bf16 v[20:23], v[60:63], a[44:47], v[20:23]
  ds_read_b128 v[52:55], v78 offset:17152
  v_mfma_f32_16x16x32_bf16 v[28:31], v[60:63], a[108:111], v[28:31]
  s_waitcnt lgkmcnt(5)
  v_mfma_f32_16x16x32_bf16 v[16:19], v[32:35], a[48:51], v[16:19]
  ds_read_b128 v[56:59], v79 offset:768
  v_mfma_f32_16x16x32_bf16 v[24:27], v[32:35], a[112:115], v[24:27]
  s_add_u32 m0, s50, 6144
  s_nop 0
  buffer_load_dwordx4 v70, s[28:31], s38 offen sc1 lds
  s_waitcnt lgkmcnt(5)
  v_mfma_f32_16x16x32_bf16 v[20:23], v[36:39], a[48:51], v[20:23]
  ds_read_b128 v[60:63], v79 offset:17152
  v_mfma_f32_16x16x32_bf16 v[28:31], v[36:39], a[112:115], v[28:31]
  s_waitcnt lgkmcnt(5)
  v_mfma_f32_16x16x32_bf16 v[16:19], v[40:43], a[52:55], v[16:19]
  v_add_u32 v76, s23, v72
  v_mfma_f32_16x16x32_bf16 v[24:27], v[40:43], a[116:119], v[24:27]
  s_waitcnt lgkmcnt(4)
  v_mfma_f32_16x16x32_bf16 v[20:23], v[44:47], a[52:55], v[20:23]
  v_add_u32 v77, s23, v73
  v_mfma_f32_16x16x32_bf16 v[28:31], v[44:47], a[116:119], v[28:31]
  s_waitcnt lgkmcnt(3)
  v_mfma_f32_16x16x32_bf16 v[16:19], v[48:51], a[56:59], v[16:19]
  v_add_u32 v78, s23, v74
  v_mfma_f32_16x16x32_bf16 v[24:27], v[48:51], a[120:123], v[24:27]
  s_add_u32 m0, s50, 7168
  s_nop 0
  buffer_load_dwordx4 v71, s[28:31], s38 offen sc1 lds
  s_waitcnt lgkmcnt(2)
  v_mfma_f32_16x16x32_bf16 v[20:23], v[52:55], a[56:59], v[20:23]
  v_add_u32 v79, s23, v75
  v_mfma_f32_16x16x32_bf16 v[28:31], v[52:55], a[120:123], v[28:31]
  s_waitcnt lgkmcnt(1)
  v_mfma_f32_16x16x32_bf16 v[16:19], v[56:59], a[60:63], v[16:19]
  v_mfma_f32_16x16x32_bf16 v[24:27], v[56:59], a[124:127], v[24:27]
  s_waitcnt lgkmcnt(0)
  v_mfma_f32_16x16x32_bf16 v[20:23], v[60:63], a[60:63], v[20:23]
  v_mfma_f32_16x16x32_bf16 v[28:31], v[60:63], a[124:127], v[28:31]
  s_and_b32 s20, s42, s52
  s_add_u32 s40, s40, s20
  s_mov_b64 s[52:53], -1
  s_cmp_lt_u32 s49, s44
  s_cbranch_scc1 G_loopV
  s_add_u32 s51, s40, s41
  v_cvt_pk_bf16_f32 v16, v16, v17
  v_cvt_pk_bf16_f32 v17, v18, v19
  v_cvt_pk_bf16_f32 v18, v20, v21
  v_cvt_pk_bf16_f32 v19, v22, v23
  v_cvt_pk_bf16_f32 v24, v24, v25
  v_cvt_pk_bf16_f32 v25, v26, v27
  v_cvt_pk_bf16_f32 v26, v28, v29
  v_cvt_pk_bf16_f32 v27, v30, v31
  buffer_store_dwordx4 v[16:19], v80, s[32:35], s40 offen sc1
  buffer_store_dwordx4 v[24:27], v80, s[32:35], s51 offen sc1
G_end:
  s_waitcnt vmcnt(0)
  s_barrier
  s_cmp_eq_u32 s16, 0
  v_mov_b32 v88, s44
  s_cselect_b64 exec, 1, 0
  buffer_store_dword v88, off, s[4:7], s45 sc1
  s_mov_b64 exec, -1
  s_cmp_eq_u32 s48, 3
  s_cbranch_scc0 W_next
  s_endpgm
        W_next:
  s_cmp_ge_u32 s3, 192
  s_cbranch_scc1 FA_entry
AT_entry:
  s_mul_i32 s24, s3, 10923
  s_lshr_b32 s24, s24, 16
  s_mul_i32 s20, s24, 6
  s_sub_u32 s25, s3, s20
  v_lshlrev_b32 v178, 2, v255
  v_cmp_gt_u32 vcc, 24, v255
  s_nop 1
  v_cndmask_b32 v179, 0, 32, vcc
  s_mov_b32 s20, 83890688
  s_cmp_eq_u32 s16, 0
  s_cbranch_scc0 AT_w_ok
AT_w:
  buffer_load_dword v180, v178, s[4:7], s20 offen sc1
  s_waitcnt vmcnt(0)
  v_cmp_gt_u32 vcc, v179, v180
  s_cbranch_vccz AT_w_ok
  s_sleep 16
  s_sub_u32 s18, s18, 1
  s_cbranch_scc0 AT_w
  s_endpgm
    AT_w_ok:
  v_lshlrev_b32 v176, 4, v255
  s_lshl_b32 s20, s24, 16
  s_lshl_b32 s21, s16, 10
  s_add_u32 s20, s20, s21
  s_add_u32 s22, s20, 94371840
  s_add_u32 s23, s20, 96468992
  s_barrier
  s_mov_b32 m0, s21
  s_nop 0
  buffer_load_dwordx4 v176, s[4:7], s22 offen sc1 lds
  s_add_u32 m0, s21, 65536
  s_add_u32 s22, s22, 4096
  buffer_load_dwordx4 v176, s[4:7], s23 offen sc1 lds
  s_add_u32 s23, s23, 4096
  s_add_u32 s21, s21, 4096
  s_mov_b32 m0, s21
  s_nop 0
  buffer_load_dwordx4 v176, s[4:7], s22 offen sc1 lds
  s_add_u32 m0, s21, 65536
  s_add_u32 s22, s22, 4096
  buffer_load_dwordx4 v176, s[4:7], s23 offen sc1 lds
  s_add_u32 s23, s23, 4096
  s_add_u32 s21, s21, 4096
  s_mov_b32 m0, s21
  s_nop 0
  buffer_load_dwordx4 v176, s[4:7], s22 offen sc1 lds
  s_add_u32 m0, s21, 65536
  s_add_u32 s22, s22, 4096
  buffer_load_dwordx4 v176, s[4:7], s23 offen sc1 lds
  s_add_u32 s23, s23, 4096
  s_add_u32 s21, s21, 4096
  s_mov_b32 m0, s21
  s_nop 0
  buffer_load_dwordx4 v176, s[4:7], s22 offen sc1 lds
  s_add_u32 m0, s21, 65536
  s_add_u32 s22, s22, 4096
  buffer_load_dwordx4 v176, s[4:7], s23 offen sc1 lds
  s_add_u32 s23, s23, 4096
  s_add_u32 s21, s21, 4096
  s_mov_b32 m0, s21
  s_nop 0
  buffer_load_dwordx4 v176, s[4:7], s22 offen sc1 lds
  s_add_u32 m0, s21, 65536
  s_add_u32 s22, s22, 4096
  buffer_load_dwordx4 v176, s[4:7], s23 offen sc1 lds
  s_add_u32 s23, s23, 4096
  s_add_u32 s21, s21, 4096
  s_mov_b32 m0, s21
  s_nop 0
  buffer_load_dwordx4 v176, s[4:7], s22 offen sc1 lds
  s_add_u32 m0, s21, 65536
  s_add_u32 s22, s22, 4096
  buffer_load_dwordx4 v176, s[4:7], s23 offen sc1 lds
  s_add_u32 s23, s23, 4096
  s_add_u32 s21, s21, 4096
  s_mov_b32 m0, s21
  s_nop 0
  buffer_load_dwordx4 v176, s[4:7], s22 offen sc1 lds
  s_add_u32 m0, s21, 65536
  s_add_u32 s22, s22, 4096
  buffer_load_dwordx4 v176, s[4:7], s23 offen sc1 lds
  s_add_u32 s23, s23, 4096
  s_add_u32 s21, s21, 4096
  s_mov_b32 m0, s21
  s_nop 0
  buffer_load_dwordx4 v176, s[4:7], s22 offen sc1 lds
  s_add_u32 m0, s21, 65536
  s_add_u32 s22, s22, 4096
  buffer_load_dwordx4 v176, s[4:7], s23 offen sc1 lds
  s_add_u32 s23, s23, 4096
  s_add_u32 s21, s21, 4096
  s_mov_b32 m0, s21
  s_nop 0
  buffer_load_dwordx4 v176, s[4:7], s22 offen sc1 lds
  s_add_u32 m0, s21, 65536
  s_add_u32 s22, s22, 4096
  buffer_load_dwordx4 v176, s[4:7], s23 offen sc1 lds
  s_add_u32 s23, s23, 4096
  s_add_u32 s21, s21, 4096
  s_mov_b32 m0, s21
  s_nop 0
  buffer_load_dwordx4 v176, s[4:7], s22 offen sc1 lds
  s_add_u32 m0, s21, 65536
  s_add_u32 s22, s22, 4096
  buffer_load_dwordx4 v176, s[4:7], s23 offen sc1 lds
  s_add_u32 s23, s23, 4096
  s_add_u32 s21, s21, 4096
  s_mov_b32 m0, s21
  s_nop 0
  buffer_load_dwordx4 v176, s[4:7], s22 offen sc1 lds
  s_add_u32 m0, s21, 65536
  s_add_u32 s22, s22, 4096
  buffer_load_dwordx4 v176, s[4:7], s23 offen sc1 lds
  s_add_u32 s23, s23, 4096
  s_add_u32 s21, s21, 4096
  s_mov_b32 m0, s21
  s_nop 0
  buffer_load_dwordx4 v176, s[4:7], s22 offen sc1 lds
  s_add_u32 m0, s21, 65536
  s_add_u32 s22, s22, 4096
  buffer_load_dwordx4 v176, s[4:7], s23 offen sc1 lds
  s_add_u32 s23, s23, 4096
  s_add_u32 s21, s21, 4096
  s_mov_b32 m0, s21
  s_nop 0
  buffer_load_dwordx4 v176, s[4:7], s22 offen sc1 lds
  s_add_u32 m0, s21, 65536
  s_add_u32 s22, s22, 4096
  buffer_load_dwordx4 v176, s[4:7], s23 offen sc1 lds
  s_add_u32 s23, s23, 4096
  s_add_u32 s21, s21, 4096
  s_mov_b32 m0, s21
  s_nop 0
  buffer_load_dwordx4 v176, s[4:7], s22 offen sc1 lds
  s_add_u32 m0, s21, 65536
  s_add_u32 s22, s22, 4096
  buffer_load_dwordx4 v176, s[4:7], s23 offen sc1 lds
  s_add_u32 s23, s23, 4096
  s_add_u32 s21, s21, 4096
  s_mov_b32 m0, s21
  s_nop 0
  buffer_load_dwordx4 v176, s[4:7], s22 offen sc1 lds
  s_add_u32 m0, s21, 65536
  s_add_u32 s22, s22, 4096
  buffer_load_dwordx4 v176, s[4:7], s23 offen sc1 lds
  s_add_u32 s23, s23, 4096
  s_add_u32 s21, s21, 4096
  s_mov_b32 m0, s21
  s_nop 0
  buffer_load_dwordx4 v176, s[4:7], s22 offen sc1 lds
  s_add_u32 m0, s21, 65536
  s_add_u32 s22, s22, 4096
  buffer_load_dwordx4 v176, s[4:7], s23 offen sc1 lds
  s_add_u32 s23, s23, 4096
  s_add_u32 s21, s21, 4096
  s_lshl_b32 s20, s25, 2
  s_add_u32 s20, s20, s16
  s_mul_i32 s21, s20, 3
  s_lshl_b32 s22, s20, 1
  s_add_u32 s22, s22, 16
  s_cmp_lt_u32 s25, 4
  s_cselect_b32 s26, s21, s22
  s_lshl_b32 s20, s24, 16
  s_lshl_b32 s21, s26, 10
  s_add_u32 s20, s20, s21
  s_add_u32 s20, s20, 92274688
  buffer_load_dwordx4 v[0:3], v176, s[4:7], s20 offen offset:0 sc1
  buffer_load_dwordx4 v[4:7], v176, s[4:7], s20 offen offset:1024 sc1
  buffer_load_dwordx4 v[8:11], v176, s[4:7], s20 offen offset:2048 sc1
  v_mov_b32 v20, 0x3f803f80
  v_mov_b32 v21, 0x3f803f80
  v_mov_b32 v22, 0x3f803f80
  v_mov_b32 v23, 0x3f803f80
  v_mov_b32 v24, 0x3f803f80
  v_mov_b32 v25, 0x3f803f80
  v_mov_b32 v26, 0x3f803f80
  v_mov_b32 v27, 0x3f803f80
  v_mov_b32 v28, 0x3f803f80
  v_mov_b32 v29, 0x3f803f80
  v_mov_b32 v30, 0x3f803f80
  v_mov_b32 v31, 0x3f803f80
  v_mov_b32 v32, 0x3f803f80
  v_mov_b32 v33, 0x3f803f80
  v_mov_b32 v34, 0x3f803f80
  v_mov_b32 v35, 0x3f803f80
  v_mov_b64 v[128:129], 0
  v_mov_b64 v[130:131], 0
  v_mov_b64 v[132:133], 0
  v_mov_b64 v[134:135], 0
  v_mov_b64 v[136:137], 0
  v_mov_b64 v[138:139], 0
  v_mov_b64 v[140:141], 0
  v_mov_b64 v[142:143], 0
  v_mov_b64 v[144:145], 0
  v_mov_b64 v[146:147], 0
  v_mov_b64 v[148:149], 0
  v_mov_b64 v[150:151], 0
  v_mov_b64 v[152:153], 0
  v_mov_b64 v[154:155], 0
  v_mov_b64 v[156:157], 0
  v_mov_b64 v[158:159], 0
  v_mov_b64 v[160:161], 0
  v_mov_b64 v[162:163], 0
  v_mov_b64 v[164:165], 0
  v_mov_b64 v[166:167], 0
  v_mov_b64 v[168:169], 0
  v_mov_b64 v[170:171], 0
  v_mov_b64 v[172:173], 0
  v_mov_b64 v[174:175], 0
  s_mov_b32 s30, 0xffff
  s_mov_b32 s31, 0xffff
  s_mov_b32 s28, 0
  s_waitcnt vmcnt(0)
  s_barrier
  s_cmp_lt_u32 s25, 4
  s_cbranch_scc0 AT2_run
AT3_run:
  v_lshlrev_b32 v176, 4, v255
  v_lshrrev_b32 v178, 5, v255
  v_and_b32 v179, 15, v255
  v_lshlrev_b32 v177, 8, v178
  v_lshl_add_u32 v177, v179, 4, v177
  v_add_u32 v177, 0x10000, v177
  v_mov_b64 v[80:81], 0
  v_mov_b64 v[82:83], 0
  v_mov_b64 v[84:85], 0
  v_mov_b64 v[86:87], 0
  v_mov_b64 v[88:89], 0
  v_mov_b64 v[90:91], 0
  v_mov_b64 v[92:93], 0
  v_mov_b64 v[94:95], 0
  v_mov_b64 v[96:97], 0
  v_mov_b64 v[98:99], 0
  v_mov_b64 v[100:101], 0
  v_mov_b64 v[102:103], 0
  v_mov_b64 v[104:105], 0
  v_mov_b64 v[106:107], 0
  v_mov_b64 v[108:109], 0
  v_mov_b64 v[110:111], 0
  v_mov_b64 v[112:113], 0
  v_mov_b64 v[114:115], 0
  v_mov_b64 v[116:117], 0
  v_mov_b64 v[118:119], 0
  v_mov_b64 v[120:121], 0
  v_mov_b64 v[122:123], 0
  v_mov_b64 v[124:125], 0
  v_mov_b64 v[126:127], 0
  v_mov_b64 v[40:41], 0
  v_mov_b64 v[42:43], 0
  ds_read_b128 v[12:15], v176 offset:0
  s_mov_b64 exec, s[30:31]
  ds_read_b128 v[20:23], v177 offset:0
  ds_read_b128 v[24:27], v177 offset:512
  s_mov_b64 exec, -1
  s_mov_b64 exec, s[30:31]
  ds_read_b128 v[28:31], v177 offset:0
  ds_read_b128 v[32:35], v177 offset:512
  s_mov_b64 exec, -1
  s_mov_b32 s27, 0
  s_waitcnt lgkmcnt(0)
  v_mfma_f32_32x32x16_bf16 v[48:63], v[12:15], v[0:3], v[128:143]
AT3_loop:
  v_mfma_f32_32x32x16_bf16 v[112:127], v[32:35], v[40:43], v[112:127]
  ds_read_b128 v[16:19], v176 offset:1024
  s_mov_b64 exec, s[30:31]
  ds_read_b128 v[28:31], v177 offset:1024
  ds_read_b128 v[32:35], v177 offset:1536
  s_mov_b64 exec, -1
  v_exp_f32 v48, v48
  v_exp_f32 v49, v49
  v_exp_f32 v50, v50
  v_exp_f32 v51, v51
  v_mfma_f32_32x32x16_bf16 v[64:79], v[12:15], v[4:7], v[144:159]
  v_exp_f32 v52, v52
  v_exp_f32 v53, v53
  v_exp_f32 v54, v54
  v_exp_f32 v55, v55
  v_exp_f32 v56, v56
  v_cvt_pk_bf16_f32 v36, v48, v49
  v_cvt_pk_bf16_f32 v37, v50, v51
  v_cvt_pk_bf16_f32 v38, v52, v53
  v_cvt_pk_bf16_f32 v39, v54, v55
  v_exp_f32 v57, v57
  v_exp_f32 v58, v58
  v_mfma_f32_32x32x16_bf16 v[80:95], v[20:23], v[36:39], v[80:95]
  v_exp_f32 v59, v59
  v_exp_f32 v60, v60
  v_exp_f32 v61, v61
  v_exp_f32 v62, v62
  v_exp_f32 v63, v63
  v_cvt_pk_bf16_f32 v40, v56, v57
  v_cvt_pk_bf16_f32 v41, v58, v59
  v_cvt_pk_bf16_f32 v42, v60, v61
  v_cvt_pk_bf16_f32 v43, v62, v63
  s_nop 1
  v_mfma_f32_32x32x16_bf16 v[80:95], v[24:27], v[40:43], v[80:95]
  v_exp_f32 v64, v64
  v_exp_f32 v65, v65
  v_exp_f32 v66, v66
  v_exp_f32 v67, v67
  v_mfma_f32_32x32x16_bf16 v[48:63], v[12:15], v[8:11], v[160:175]
  v_exp_f32 v68, v68
  v_exp_f32 v69, v69
  v_exp_f32 v70, v70
  v_exp_f32 v71, v71
  v_exp_f32 v72, v72
  v_cvt_pk_bf16_f32 v36, v64, v65
  v_cvt_pk_bf16_f32 v37, v66, v67
  v_cvt_pk_bf16_f32 v38, v68, v69
  v_cvt_pk_bf16_f32 v39, v70, v71
  v_exp_f32 v73, v73
  v_exp_f32 v74, v74
  v_mfma_f32_32x32x16_bf16 v[96:111], v[20:23], v[36:39], v[96:111]
  v_exp_f32 v75, v75
  v_exp_f32 v76, v76
  v_exp_f32 v77, v77
  v_exp_f32 v78, v78
  v_exp_f32 v79, v79
  v_cvt_pk_bf16_f32 v40, v72, v73
  v_cvt_pk_bf16_f32 v41, v74, v75
  v_cvt_pk_bf16_f32 v42, v76, v77
  v_cvt_pk_bf16_f32 v43, v78, v79
  s_nop 1
  v_mfma_f32_32x32x16_bf16 v[96:111], v[24:27], v[40:43], v[96:111]
  v_exp_f32 v48, v48
  v_exp_f32 v49, v49
  v_exp_f32 v50, v50
  v_exp_f32 v51, v51
  s_waitcnt lgkmcnt(0)
  v_mfma_f32_32x32x16_bf16 v[64:79], v[16:19], v[0:3], v[128:143]
  v_exp_f32 v52, v52
  v_exp_f32 v53, v53
  v_exp_f32 v54, v54
  v_exp_f32 v55, v55
  v_exp_f32 v56, v56
  v_cvt_pk_bf16_f32 v36, v48, v49
  v_cvt_pk_bf16_f32 v37, v50, v51
  v_cvt_pk_bf16_f32 v38, v52, v53
  v_cvt_pk_bf16_f32 v39, v54, v55
  v_exp_f32 v57, v57
  v_exp_f32 v58, v58
  v_mfma_f32_32x32x16_bf16 v[112:127], v[20:23], v[36:39], v[112:127]
  v_exp_f32 v59, v59
  v_exp_f32 v60, v60
  v_exp_f32 v61, v61
  v_exp_f32 v62, v62
  v_exp_f32 v63, v63
  v_cvt_pk_bf16_f32 v40, v56, v57
  v_cvt_pk_bf16_f32 v41, v58, v59
  v_cvt_pk_bf16_f32 v42, v60, v61
  v_cvt_pk_bf16_f32 v43, v62, v63
  s_nop 1
  v_mfma_f32_32x32x16_bf16 v[112:127], v[24:27], v[40:43], v[112:127]
  ds_read_b128 v[12:15], v176 offset:2048
  s_mov_b64 exec, s[30:31]
  ds_read_b128 v[20:23], v177 offset:2048
  ds_read_b128 v[24:27], v177 offset:2560
  s_mov_b64 exec, -1
  v_exp_f32 v64, v64
  v_exp_f32 v65, v65
  v_exp_f32 v66, v66
  v_exp_f32 v67, v67
  v_mfma_f32_32x32x16_bf16 v[48:63], v[16:19], v[4:7], v[144:159]
  v_exp_f32 v68, v68
  v_exp_f32 v69, v69
  v_exp_f32 v70, v70
  v_exp_f32 v71, v71
  v_exp_f32 v72, v72
  v_cvt_pk_bf16_f32 v36, v64, v65
  v_cvt_pk_bf16_f32 v37, v66, v67
  v_cvt_pk_bf16_f32 v38, v68, v69
  v_cvt_pk_bf16_f32 v39, v70, v71
  v_exp_f32 v73, v73
  v_exp_f32 v74, v74
  v_mfma_f32_32x32x16_bf16 v[80:95], v[28:31], v[36:39], v[80:95]
  v_exp_f32 v75, v75
  v_exp_f32 v76, v76
  v_exp_f32 v77, v77
  v_exp_f32 v78, v78
  v_exp_f32 v79, v79
  v_cvt_pk_bf16_f32 v40, v72, v73
  v_cvt_pk_bf16_f32 v41, v74, v75
  v_cvt_pk_bf16_f32 v42, v76, v77
  v_cvt_pk_bf16_f32 v43, v78, v79
  s_nop 1
  v_mfma_f32_32x32x16_bf16 v[80:95], v[32:35], v[40:43], v[80:95]
  v_exp_f32 v48, v48
  v_exp_f32 v49, v49
  v_exp_f32 v50, v50
  v_exp_f32 v51, v51
  v_mfma_f32_32x32x16_bf16 v[64:79], v[16:19], v[8:11], v[160:175]
  v_exp_f32 v52, v52
  v_exp_f32 v53, v53
  v_exp_f32 v54, v54
  v_exp_f32 v55, v55
  v_exp_f32 v56, v56
  v_cvt_pk_bf16_f32 v36, v48, v49
  v_cvt_pk_bf16_f32 v37, v50, v51
  v_cvt_pk_bf16_f32 v38, v52, v53
  v_cvt_pk_bf16_f32 v39, v54, v55
  v_exp_f32 v57, v57
  v_exp_f32 v58, v58
  v_mfma_f32_32x32x16_bf16 v[96:111], v[28:31], v[36:39], v[96:111]
  v_exp_f32 v59, v59
  v_exp_f32 v60, v60
  v_exp_f32 v61, v61
  v_exp_f32 v62, v62
  v_exp_f32 v63, v63
  v_cvt_pk_bf16_f32 v40, v56, v57
  v_cvt_pk_bf16_f32 v41, v58, v59
  v_cvt_pk_bf16_f32 v42, v60, v61
  v_cvt_pk_bf16_f32 v43, v62, v63
  s_nop 1
  v_mfma_f32_32x32x16_bf16 v[96:111], v[32:35], v[40:43], v[96:111]
  v_exp_f32 v64, v64
  v_exp_f32 v65, v65
  v_exp_f32 v66, v66
  v_exp_f32 v67, v67
  s_waitcnt lgkmcnt(0)
  v_mfma_f32_32x32x16_bf16 v[48:63], v[12:15], v[0:3], v[128:143]
  v_exp_f32 v68, v68
  v_exp_f32 v69, v69
  v_exp_f32 v70, v70
  v_exp_f32 v71, v71
  v_exp_f32 v72, v72
  v_cvt_pk_bf16_f32 v36, v64, v65
  v_cvt_pk_bf16_f32 v37, v66, v67
  v_cvt_pk_bf16_f32 v38, v68, v69
  v_cvt_pk_bf16_f32 v39, v70, v71
  v_exp_f32 v73, v73
  v_exp_f32 v74, v74
  v_mfma_f32_32x32x16_bf16 v[112:127], v[28:31], v[36:39], v[112:127]
  v_exp_f32 v75, v75
  v_exp_f32 v76, v76
  v_exp_f32 v77, v77
  v_exp_f32 v78, v78
  v_exp_f32 v79, v79
  v_cvt_pk_bf16_f32 v40, v72, v73
  v_cvt_pk_bf16_f32 v41, v74, v75
  v_cvt_pk_bf16_f32 v42, v76, v77
  v_cvt_pk_bf16_f32 v43, v78, v79
  v_add_u32 v176, 2048, v176
  v_add_u32 v177, 2048, v177
  s_add_u32 s27, s27, 1
  s_cmp_lt_u32 s27, 32
  s_cbranch_scc1 AT3_loop
  v_mfma_f32_32x32x16_bf16 v[112:127], v[32:35], v[40:43], v[112:127]
  s_cmp_eq_u32 s28, 0
  s_cbranch_scc0 AT3_fin
  v_subrev_u32 v178, 813694976, v88
  v_subrev_u32 v179, 813694976, v104
  v_max_u32 v178, v178, v179
  s_nop 6
  v_subrev_u32 v179, 813694976, v120
  v_max_u32 v178, v178, v179
  v_cmp_le_u32 vcc, 754974720, v178
  s_cbranch_vccz AT3_fin
  s_mov_b32 s28, 1
  s_mov_b32 s27, 0
  v_lshlrev_b32 v176, 4, v255
  v_mov_b32 v80, 0xff800000
  v_mov_b32 v81, 0xff800000
  v_mov_b32 v82, 0xff800000
AT3_max:
  ds_read_b128 v[12:15], v176 offset:0
  v_add_u32 v176, 1024, v176
  s_waitcnt lgkmcnt(0)
  v_mfma_f32_32x32x16_bf16 v[48:63], v[12:15], v[0:3], 0
  s_nop 11
  v_max3_f32 v80, v80, v48, v49
  v_max3_f32 v80, v80, v50, v51
  v_max3_f32 v80, v80, v52, v53
  v_max3_f32 v80, v80, v54, v55
  v_max3_f32 v80, v80, v56, v57
  v_max3_f32 v80, v80, v58, v59
  v_max3_f32 v80, v80, v60, v61
  v_max3_f32 v80, v80, v62, v63
  v_mfma_f32_32x32x16_bf16 v[48:63], v[12:15], v[4:7], 0
  s_nop 11
  v_max3_f32 v81, v81, v48, v49
  v_max3_f32 v81, v81, v50, v51
  v_max3_f32 v81, v81, v52, v53
  v_max3_f32 v81, v81, v54, v55
  v_max3_f32 v81, v81, v56, v57
  v_max3_f32 v81, v81, v58, v59
  v_max3_f32 v81, v81, v60, v61
  v_max3_f32 v81, v81, v62, v63
  v_mfma_f32_32x32x16_bf16 v[48:63], v[12:15], v[8:11], 0
  s_nop 11
  v_max3_f32 v82, v82, v48, v49
  v_max3_f32 v82, v82, v50, v51
  v_max3_f32 v82, v82, v52, v53
  v_max3_f32 v82, v82, v54, v55
  v_max3_f32 v82, v82, v56, v57
  v_max3_f32 v82, v82, v58, v59
  v_max3_f32 v82, v82, v60, v61
  v_max3_f32 v82, v82, v62, v63
  s_add_u32 s27, s27, 1
  s_cmp_lt_u32 s27, 64
  s_cbranch_scc1 AT3_max
  v_mov_b32 v178, v80
  s_nop 1
  v_permlane32_swap_b32 v80, v178
  v_max_f32 v178, v178, v80
  v_sub_f32 v128, 0, v178
  v_sub_f32 v129, 0, v178
  v_sub_f32 v130, 0, v178
  v_sub_f32 v131, 0, v178
  v_sub_f32 v132, 0, v178
  v_sub_f32 v133, 0, v178
  v_sub_f32 v134, 0, v178
  v_sub_f32 v135, 0, v178
  v_sub_f32 v136, 0, v178
  v_sub_f32 v137, 0, v178
  v_sub_f32 v138, 0, v178
  v_sub_f32 v139, 0, v178
  v_sub_f32 v140, 0, v178
  v_sub_f32 v141, 0, v178
  v_sub_f32 v142, 0, v178
  v_sub_f32 v143, 0, v178
  v_mov_b32 v178, v81
  s_nop 1
  v_permlane32_swap_b32 v81, v178
  v_max_f32 v178, v178, v81
  v_sub_f32 v144, 0, v178
  v_sub_f32 v145, 0, v178
  v_sub_f32 v146, 0, v178
  v_sub_f32 v147, 0, v178
  v_sub_f32 v148, 0, v178
  v_sub_f32 v149, 0, v178
  v_sub_f32 v150, 0, v178
  v_sub_f32 v151, 0, v178
  v_sub_f32 v152, 0, v178
  v_sub_f32 v153, 0, v178
  v_sub_f32 v154, 0, v178
  v_sub_f32 v155, 0, v178
  v_sub_f32 v156, 0, v178
  v_sub_f32 v157, 0, v178
  v_sub_f32 v158, 0, v178
  v_sub_f32 v159, 0, v178
  v_mov_b32 v178, v82
  s_nop 1
  v_permlane32_swap_b32 v82, v178
  v_max_f32 v178, v178, v82
  v_sub_f32 v160, 0, v178
  v_sub_f32 v161, 0, v178
  v_sub_f32 v162, 0, v178
  v_sub_f32 v163, 0, v178
  v_sub_f32 v164, 0, v178
  v_sub_f32 v165, 0, v178
  v_sub_f32 v166, 0, v178
  v_sub_f32 v167, 0, v178
  v_sub_f32 v168, 0, v178
  v_sub_f32 v169, 0, v178
  v_sub_f32 v170, 0, v178
  v_sub_f32 v171, 0, v178
  v_sub_f32 v172, 0, v178
  v_sub_f32 v173, 0, v178
  v_sub_f32 v174, 0, v178
  v_sub_f32 v175, 0, v178
  s_branch AT3_run
AT3_fin:
  v_bfe_u32 v178, v255, 3, 1
  v_lshlrev_b32 v179, 14, v178
  v_bfe_u32 v178, v255, 4, 1
  v_lshl_add_u32 v179, v178, 13, v179
  v_and_b32 v178, 7, v255
  v_lshl_add_u32 v179, v178, 10, v179
  v_lshrrev_b32 v178, 5, v255
  v_lshl_add_u32 v179, v178, 4, v179
  s_lshl_b32 s20, s26, 15
  s_lshl_b32 s21, s24, 5
  s_add_u32 s20, s20, s21
  s_add_u32 s20, s20, 98566144
  v_rcp_f32 v178, v88
  s_nop 0
  v_mul_f32 v80, v178, v80
  v_mul_f32 v81, v178, v81
  v_mul_f32 v82, v178, v82
  v_mul_f32 v83, v178, v83
  v_mul_f32 v84, v178, v84
  v_mul_f32 v85, v178, v85
  v_mul_f32 v86, v178, v86
  v_mul_f32 v87, v178, v87
  v_cvt_pk_bf16_f32 v80, v80, v81
  v_cvt_pk_bf16_f32 v81, v82, v83
  v_cvt_pk_bf16_f32 v82, v84, v85
  v_cvt_pk_bf16_f32 v83, v86, v87
  s_nop 0
  v_permlane32_swap_b32 v80, v82
  v_permlane32_swap_b32 v81, v83
  buffer_store_dwordx4 v[80:83], v179, s[4:7], s20 offen sc1
  s_add_u32 s20, s20, 32768
  v_rcp_f32 v178, v104
  s_nop 0
  v_mul_f32 v96, v178, v96
  v_mul_f32 v97, v178, v97
  v_mul_f32 v98, v178, v98
  v_mul_f32 v99, v178, v99
  v_mul_f32 v100, v178, v100
  v_mul_f32 v101, v178, v101
  v_mul_f32 v102, v178, v102
  v_mul_f32 v103, v178, v103
  v_cvt_pk_bf16_f32 v96, v96, v97
  v_cvt_pk_bf16_f32 v97, v98, v99
  v_cvt_pk_bf16_f32 v98, v100, v101
  v_cvt_pk_bf16_f32 v99, v102, v103
  s_nop 0
  v_permlane32_swap_b32 v96, v98
  v_permlane32_swap_b32 v97, v99
  buffer_store_dwordx4 v[96:99], v179, s[4:7], s20 offen sc1
  s_add_u32 s20, s20, 32768
  v_rcp_f32 v178, v120
  s_nop 0
  v_mul_f32 v112, v178, v112
  v_mul_f32 v113, v178, v113
  v_mul_f32 v114, v178, v114
  v_mul_f32 v115, v178, v115
  v_mul_f32 v116, v178, v116
  v_mul_f32 v117, v178, v117
  v_mul_f32 v118, v178, v118
  v_mul_f32 v119, v178, v119
  v_cvt_pk_bf16_f32 v112, v112, v113
  v_cvt_pk_bf16_f32 v113, v114, v115
  v_cvt_pk_bf16_f32 v114, v116, v117
  v_cvt_pk_bf16_f32 v115, v118, v119
  s_nop 0
  v_permlane32_swap_b32 v112, v114
  v_permlane32_swap_b32 v113, v115
  buffer_store_dwordx4 v[112:115], v179, s[4:7], s20 offen sc1
  s_add_u32 s20, s20, 32768
  s_branch AT_end
AT2_run:
  v_lshlrev_b32 v176, 4, v255
  v_lshrrev_b32 v178, 5, v255
  v_and_b32 v179, 15, v255
  v_lshlrev_b32 v177, 8, v178
  v_lshl_add_u32 v177, v179, 4, v177
  v_add_u32 v177, 0x10000, v177
  v_mov_b64 v[80:81], 0
  v_mov_b64 v[82:83], 0
  v_mov_b64 v[84:85], 0
  v_mov_b64 v[86:87], 0
  v_mov_b64 v[88:89], 0
  v_mov_b64 v[90:91], 0
  v_mov_b64 v[92:93], 0
  v_mov_b64 v[94:95], 0
  v_mov_b64 v[96:97], 0
  v_mov_b64 v[98:99], 0
  v_mov_b64 v[100:101], 0
  v_mov_b64 v[102:103], 0
  v_mov_b64 v[104:105], 0
  v_mov_b64 v[106:107], 0
  v_mov_b64 v[108:109], 0
  v_mov_b64 v[110:111], 0
  v_mov_b64 v[40:41], 0
  v_mov_b64 v[42:43], 0
  ds_read_b128 v[12:15], v176 offset:0
  s_mov_b64 exec, s[30:31]
  ds_read_b128 v[20:23], v177 offset:0
  ds_read_b128 v[24:27], v177 offset:512
  s_mov_b64 exec, -1
  s_mov_b64 exec, s[30:31]
  ds_read_b128 v[28:31], v177 offset:0
  ds_read_b128 v[32:35], v177 offset:512
  s_mov_b64 exec, -1
  s_mov_b32 s27, 0
  s_waitcnt lgkmcnt(0)
  v_mfma_f32_32x32x16_bf16 v[48:63], v[12:15], v[0:3], v[128:143]
AT2_loop:
  v_mfma_f32_32x32x16_bf16 v[96:111], v[32:35], v[40:43], v[96:111]
  ds_read_b128 v[16:19], v176 offset:1024
  s_mov_b64 exec, s[30:31]
  ds_read_b128 v[28:31], v177 offset:1024
  ds_read_b128 v[32:35], v177 offset:1536
  s_mov_b64 exec, -1
  v_exp_f32 v48, v48
  v_exp_f32 v49, v49
  v_exp_f32 v50, v50
  v_exp_f32 v51, v51
  v_mfma_f32_32x32x16_bf16 v[64:79], v[12:15], v[4:7], v[144:159]
  v_exp_f32 v52, v52
  v_exp_f32 v53, v53
  v_exp_f32 v54, v54
  v_exp_f32 v55, v55
  v_exp_f32 v56, v56
  v_cvt_pk_bf16_f32 v36, v48, v49
  v_cvt_pk_bf16_f32 v37, v50, v51
  v_cvt_pk_bf16_f32 v38, v52, v53
  v_cvt_pk_bf16_f32 v39, v54, v55
  v_exp_f32 v57, v57
  v_exp_f32 v58, v58
  v_mfma_f32_32x32x16_bf16 v[80:95], v[20:23], v[36:39], v[80:95]
  v_exp_f32 v59, v59
  v_exp_f32 v60, v60
  v_exp_f32 v61, v61
  v_exp_f32 v62, v62
  v_exp_f32 v63, v63
  v_cvt_pk_bf16_f32 v40, v56, v57
  v_cvt_pk_bf16_f32 v41, v58, v59
  v_cvt_pk_bf16_f32 v42, v60, v61
  v_cvt_pk_bf16_f32 v43, v62, v63
  s_nop 1
  v_mfma_f32_32x32x16_bf16 v[80:95], v[24:27], v[40:43], v[80:95]
  v_exp_f32 v64, v64
  v_exp_f32 v65, v65
  v_exp_f32 v66, v66
  v_exp_f32 v67, v67
  s_waitcnt lgkmcnt(0)
  v_mfma_f32_32x32x16_bf16 v[48:63], v[16:19], v[0:3], v[128:143]
  v_exp_f32 v68, v68
  v_exp_f32 v69, v69
  v_exp_f32 v70, v70
  v_exp_f32 v71, v71
  v_exp_f32 v72, v72
  v_cvt_pk_bf16_f32 v36, v64, v65
  v_cvt_pk_bf16_f32 v37, v66, v67
  v_cvt_pk_bf16_f32 v38, v68, v69
  v_cvt_pk_bf16_f32 v39, v70, v71
  v_exp_f32 v73, v73
  v_exp_f32 v74, v74
  v_mfma_f32_32x32x16_bf16 v[96:111], v[20:23], v[36:39], v[96:111]
  v_exp_f32 v75, v75
  v_exp_f32 v76, v76
  v_exp_f32 v77, v77
  v_exp_f32 v78, v78
  v_exp_f32 v79, v79
  v_cvt_pk_bf16_f32 v40, v72, v73
  v_cvt_pk_bf16_f32 v41, v74, v75
  v_cvt_pk_bf16_f32 v42, v76, v77
  v_cvt_pk_bf16_f32 v43, v78, v79
  s_nop 1
  v_mfma_f32_32x32x16_bf16 v[96:111], v[24:27], v[40:43], v[96:111]
  ds_read_b128 v[12:15], v176 offset:2048
  s_mov_b64 exec, s[30:31]
  ds_read_b128 v[20:23], v177 offset:2048
  ds_read_b128 v[24:27], v177 offset:2560
  s_mov_b64 exec, -1
  v_exp_f32 v48, v48
  v_exp_f32 v49, v49
  v_exp_f32 v50, v50
  v_exp_f32 v51, v51
  v_mfma_f32_32x32x16_bf16 v[64:79], v[16:19], v[4:7], v[144:159]
  v_exp_f32 v52, v52
  v_exp_f32 v53, v53
  v_exp_f32 v54, v54
  v_exp_f32 v55, v55
  v_exp_f32 v56, v56
  v_cvt_pk_bf16_f32 v36, v48, v49
  v_cvt_pk_bf16_f32 v37, v50, v51
  v_cvt_pk_bf16_f32 v38, v52, v53
  v_cvt_pk_bf16_f32 v39, v54, v55
  v_exp_f32 v57, v57
  v_exp_f32 v58, v58
  v_mfma_f32_32x32x16_bf16 v[80:95], v[28:31], v[36:39], v[80:95]
  v_exp_f32 v59, v59
  v_exp_f32 v60, v60
  v_exp_f32 v61, v61
  v_exp_f32 v62, v62
  v_exp_f32 v63, v63
  v_cvt_pk_bf16_f32 v40, v56, v57
  v_cvt_pk_bf16_f32 v41, v58, v59
  v_cvt_pk_bf16_f32 v42, v60, v61
  v_cvt_pk_bf16_f32 v43, v62, v63
  s_nop 1
  v_mfma_f32_32x32x16_bf16 v[80:95], v[32:35], v[40:43], v[80:95]
  v_exp_f32 v64, v64
  v_exp_f32 v65, v65
  v_exp_f32 v66, v66
  v_exp_f32 v67, v67
  s_waitcnt lgkmcnt(0)
  v_mfma_f32_32x32x16_bf16 v[48:63], v[12:15], v[0:3], v[128:143]
  v_exp_f32 v68, v68
  v_exp_f32 v69, v69
  v_exp_f32 v70, v70
  v_exp_f32 v71, v71
  v_exp_f32 v72, v72
  v_cvt_pk_bf16_f32 v36, v64, v65
  v_cvt_pk_bf16_f32 v37, v66, v67
  v_cvt_pk_bf16_f32 v38, v68, v69
  v_cvt_pk_bf16_f32 v39, v70, v71
  v_exp_f32 v73, v73
  v_exp_f32 v74, v74
  v_mfma_f32_32x32x16_bf16 v[96:111], v[28:31], v[36:39], v[96:111]
  v_exp_f32 v75, v75
  v_exp_f32 v76, v76
  v_exp_f32 v77, v77
  v_exp_f32 v78, v78
  v_exp_f32 v79, v79
  v_cvt_pk_bf16_f32 v40, v72, v73
  v_cvt_pk_bf16_f32 v41, v74, v75
  v_cvt_pk_bf16_f32 v42, v76, v77
  v_cvt_pk_bf16_f32 v43, v78, v79
  v_add_u32 v176, 2048, v176
  v_add_u32 v177, 2048, v177
  s_add_u32 s27, s27, 1
  s_cmp_lt_u32 s27, 32
  s_cbranch_scc1 AT2_loop
  v_mfma_f32_32x32x16_bf16 v[96:111], v[32:35], v[40:43], v[96:111]
  s_cmp_eq_u32 s28, 0
  s_cbranch_scc0 AT2_fin
  v_subrev_u32 v178, 813694976, v88
  s_nop 8
  v_subrev_u32 v179, 813694976, v104
  v_max_u32 v178, v178, v179
  v_cmp_le_u32 vcc, 754974720, v178
  s_cbranch_vccz AT2_fin
  s_mov_b32 s28, 1
  s_mov_b32 s27, 0
  v_lshlrev_b32 v176, 4, v255
  v_mov_b32 v80, 0xff800000
  v_mov_b32 v81, 0xff800000
AT2_max:
  ds_read_b128 v[12:15], v176 offset:0
  v_add_u32 v176, 1024, v176
  s_waitcnt lgkmcnt(0)
  v_mfma_f32_32x32x16_bf16 v[48:63], v[12:15], v[0:3], 0
  s_nop 11
  v_max3_f32 v80, v80, v48, v49
  v_max3_f32 v80, v80, v50, v51
  v_max3_f32 v80, v80, v52, v53
  v_max3_f32 v80, v80, v54, v55
  v_max3_f32 v80, v80, v56, v57
  v_max3_f32 v80, v80, v58, v59
  v_max3_f32 v80, v80, v60, v61
  v_max3_f32 v80, v80, v62, v63
  v_mfma_f32_32x32x16_bf16 v[48:63], v[12:15], v[4:7], 0
  s_nop 11
  v_max3_f32 v81, v81, v48, v49
  v_max3_f32 v81, v81, v50, v51
  v_max3_f32 v81, v81, v52, v53
  v_max3_f32 v81, v81, v54, v55
  v_max3_f32 v81, v81, v56, v57
  v_max3_f32 v81, v81, v58, v59
  v_max3_f32 v81, v81, v60, v61
  v_max3_f32 v81, v81, v62, v63
  s_add_u32 s27, s27, 1
  s_cmp_lt_u32 s27, 64
  s_cbranch_scc1 AT2_max
  v_mov_b32 v178, v80
  s_nop 1
  v_permlane32_swap_b32 v80, v178
  v_max_f32 v178, v178, v80
  v_sub_f32 v128, 0, v178
  v_sub_f32 v129, 0, v178
  v_sub_f32 v130, 0, v178
  v_sub_f32 v131, 0, v178
  v_sub_f32 v132, 0, v178
  v_sub_f32 v133, 0, v178
  v_sub_f32 v134, 0, v178
  v_sub_f32 v135, 0, v178
  v_sub_f32 v136, 0, v178
  v_sub_f32 v137, 0, v178
  v_sub_f32 v138, 0, v178
  v_sub_f32 v139, 0, v178
  v_sub_f32 v140, 0, v178
  v_sub_f32 v141, 0, v178
  v_sub_f32 v142, 0, v178
  v_sub_f32 v143, 0, v178
  v_mov_b32 v178, v81
  s_nop 1
  v_permlane32_swap_b32 v81, v178
  v_max_f32 v178, v178, v81
  v_sub_f32 v144, 0, v178
  v_sub_f32 v145, 0, v178
  v_sub_f32 v146, 0, v178
  v_sub_f32 v147, 0, v178
  v_sub_f32 v148, 0, v178
  v_sub_f32 v149, 0, v178
  v_sub_f32 v150, 0, v178
  v_sub_f32 v151, 0, v178
  v_sub_f32 v152, 0, v178
  v_sub_f32 v153, 0, v178
  v_sub_f32 v154, 0, v178
  v_sub_f32 v155, 0, v178
  v_sub_f32 v156, 0, v178
  v_sub_f32 v157, 0, v178
  v_sub_f32 v158, 0, v178
  v_sub_f32 v159, 0, v178
  s_branch AT2_run
AT2_fin:
  v_bfe_u32 v178, v255, 3, 1
  v_lshlrev_b32 v179, 14, v178
  v_bfe_u32 v178, v255, 4, 1
  v_lshl_add_u32 v179, v178, 13, v179
  v_and_b32 v178, 7, v255
  v_lshl_add_u32 v179, v178, 10, v179
  v_lshrrev_b32 v178, 5, v255
  v_lshl_add_u32 v179, v178, 4, v179
  s_lshl_b32 s20, s26, 15
  s_lshl_b32 s21, s24, 5
  s_add_u32 s20, s20, s21
  s_add_u32 s20, s20, 98566144
  v_rcp_f32 v178, v88
  s_nop 0
  v_mul_f32 v80, v178, v80
  v_mul_f32 v81, v178, v81
  v_mul_f32 v82, v178, v82
  v_mul_f32 v83, v178, v83
  v_mul_f32 v84, v178, v84
  v_mul_f32 v85, v178, v85
  v_mul_f32 v86, v178, v86
  v_mul_f32 v87, v178, v87
  v_cvt_pk_bf16_f32 v80, v80, v81
  v_cvt_pk_bf16_f32 v81, v82, v83
  v_cvt_pk_bf16_f32 v82, v84, v85
  v_cvt_pk_bf16_f32 v83, v86, v87
  s_nop 0
  v_permlane32_swap_b32 v80, v82
  v_permlane32_swap_b32 v81, v83
  buffer_store_dwordx4 v[80:83], v179, s[4:7], s20 offen sc1
  s_add_u32 s20, s20, 32768
  v_rcp_f32 v178, v104
  s_nop 0
  v_mul_f32 v96, v178, v96
  v_mul_f32 v97, v178, v97
  v_mul_f32 v98, v178, v98
  v_mul_f32 v99, v178, v99
  v_mul_f32 v100, v178, v100
  v_mul_f32 v101, v178, v101
  v_mul_f32 v102, v178, v102
  v_mul_f32 v103, v178, v103
  v_cvt_pk_bf16_f32 v96, v96, v97
  v_cvt_pk_bf16_f32 v97, v98, v99
  v_cvt_pk_bf16_f32 v98, v100, v101
  v_cvt_pk_bf16_f32 v99, v102, v103
  s_nop 0
  v_permlane32_swap_b32 v96, v98
  v_permlane32_swap_b32 v97, v99
  buffer_store_dwordx4 v[96:99], v179, s[4:7], s20 offen sc1
  s_add_u32 s20, s20, 32768
AT_end:
  s_waitcnt vmcnt(0)
  s_barrier
  s_lshl_b32 s20, s3, 2
  s_add_u32 s20, s20, 83890816
  s_cmp_eq_u32 s16, 0
  v_mov_b32 v178, 1
  s_cselect_b64 exec, 1, 0
  buffer_store_dword v178, off, s[4:7], s20 sc1
  s_mov_b64 exec, -1
  s_cmp_ge_u32 s3, 128
  s_cbranch_scc1 W_a3
FG_entry:
  s_load_dwordx2 s[24:25], s[0:1], 64
  s_mov_b32 s26, 4194304
  s_mov_b32 s27, 0x20000
  s_load_dwordx2 s[28:29], s[0:1], 80
  s_mov_b32 s30, 4194304
  s_mov_b32 s31, 0x20000
  s_and_b32 s33, s3, 15
  s_lshr_b32 s32, s3, 4
  v_lshrrev_b32 v165, 2, v255
  v_and_b32 v166, 3, v255
  v_lshlrev_b32 v167, 10, v165
  v_lshl_add_u32 v167, v166, 4, v167
  v_lshlrev_b32 v160, 4, v255
  s_lshl_b32 s23, s16, 15
  v_add_u32 v165, s23, v160
  s_lshl_b32 s20, s16, 20
  s_lshl_b32 s21, s33, 6
  s_add_u32 s20, s20, s21
  s_waitcnt lgkmcnt(0)
  s_barrier
  s_add_u32 m0, s23, 0
  s_nop 0
  buffer_load_dwordx4 v167, s[24:27], s20 offen lds
  s_add_u32 s20, s20, 16384
  s_add_u32 m0, s23, 1024
  s_nop 0
  buffer_load_dwordx4 v167, s[24:27], s20 offen lds
  s_add_u32 s20, s20, 16384
  s_add_u32 m0, s23, 2048
  s_nop 0
  buffer_load_dwordx4 v167, s[24:27], s20 offen lds
  s_add_u32 s20, s20, 16384
  s_add_u32 m0, s23, 3072
  s_nop 0
  buffer_load_dwordx4 v167, s[24:27], s20 offen lds
  s_add_u32 s20, s20, 16384
  s_add_u32 m0, s23, 4096
  s_nop 0
  buffer_load_dwordx4 v167, s[24:27], s20 offen lds
  s_add_u32 s20, s20, 16384
  s_add_u32 m0, s23, 5120
  s_nop 0
  buffer_load_dwordx4 v167, s[24:27], s20 offen lds
  s_add_u32 s20, s20, 16384
  s_add_u32 m0, s23, 6144
  s_nop 0
  buffer_load_dwordx4 v167, s[24:27], s20 offen lds
  s_add_u32 s20, s20, 16384
  s_add_u32 m0, s23, 7168
  s_nop 0
  buffer_load_dwordx4 v167, s[24:27], s20 offen lds
  s_add_u32 s20, s20, 16384
  s_add_u32 m0, s23, 8192
  s_nop 0
  buffer_load_dwordx4 v167, s[24:27], s20 offen lds
  s_add_u32 s20, s20, 16384
  s_add_u32 m0, s23, 9216
  s_nop 0
  buffer_load_dwordx4 v167, s[24:27], s20 offen lds
  s_add_u32 s20, s20, 16384
  s_add_u32 m0, s23, 10240
  s_nop 0
  buffer_load_dwordx4 v167, s[24:27], s20 offen lds
  s_add_u32 s20, s20, 16384
  s_add_u32 m0, s23, 11264
  s_nop 0
  buffer_load_dwordx4 v167, s[24:27], s20 offen lds
  s_add_u32 s20, s20, 16384
  s_add_u32 m0, s23, 12288
  s_nop 0
  buffer_load_dwordx4 v167, s[24:27], s20 offen lds
  s_add_u32 s20, s20, 16384
  s_add_u32 m0, s23, 13312
  s_nop 0
  buffer_load_dwordx4 v167, s[24:27], s20 offen lds
  s_add_u32 s20, s20, 16384
  s_add_u32 m0, s23, 14336
  s_nop 0
  buffer_load_dwordx4 v167, s[24:27], s20 offen lds
  s_add_u32 s20, s20, 16384
  s_add_u32 m0, s23, 15360
  s_nop 0
  buffer_load_dwordx4 v167, s[24:27], s20 offen lds
  s_add_u32 s20, s20, 16384
  s_add_u32 m0, s23, 16384
  s_nop 0
  buffer_load_dwordx4 v167, s[24:27], s20 offen lds
  s_add_u32 s20, s20, 16384
  s_add_u32 m0, s23, 17408
  s_nop 0
  buffer_load_dwordx4 v167, s[24:27], s20 offen lds
  s_add_u32 s20, s20, 16384
  s_add_u32 m0, s23, 18432
  s_nop 0
  buffer_load_dwordx4 v167, s[24:27], s20 offen lds
  s_add_u32 s20, s20, 16384
  s_add_u32 m0, s23, 19456
  s_nop 0
  buffer_load_dwordx4 v167, s[24:27], s20 offen lds
  s_add_u32 s20, s20, 16384
  s_add_u32 m0, s23, 20480
  s_nop 0
  buffer_load_dwordx4 v167, s[24:27], s20 offen lds
  s_add_u32 s20, s20, 16384
  s_add_u32 m0, s23, 21504
  s_nop 0
  buffer_load_dwordx4 v167, s[24:27], s20 offen lds
  s_add_u32 s20, s20, 16384
  s_add_u32 m0, s23, 22528
  s_nop 0
  buffer_load_dwordx4 v167, s[24:27], s20 offen lds
  s_add_u32 s20, s20, 16384
  s_add_u32 m0, s23, 23552
  s_nop 0
  buffer_load_dwordx4 v167, s[24:27], s20 offen lds
  s_add_u32 s20, s20, 16384
  s_add_u32 m0, s23, 24576
  s_nop 0
  buffer_load_dwordx4 v167, s[24:27], s20 offen lds
  s_add_u32 s20, s20, 16384
  s_add_u32 m0, s23, 25600
  s_nop 0
  buffer_load_dwordx4 v167, s[24:27], s20 offen lds
  s_add_u32 s20, s20, 16384
  s_add_u32 m0, s23, 26624
  s_nop 0
  buffer_load_dwordx4 v167, s[24:27], s20 offen lds
  s_add_u32 s20, s20, 16384
  s_add_u32 m0, s23, 27648
  s_nop 0
  buffer_load_dwordx4 v167, s[24:27], s20 offen lds
  s_add_u32 s20, s20, 16384
  s_add_u32 m0, s23, 28672
  s_nop 0
  buffer_load_dwordx4 v167, s[24:27], s20 offen lds
  s_add_u32 s20, s20, 16384
  s_add_u32 m0, s23, 29696
  s_nop 0
  buffer_load_dwordx4 v167, s[24:27], s20 offen lds
  s_add_u32 s20, s20, 16384
  s_add_u32 m0, s23, 30720
  s_nop 0
  buffer_load_dwordx4 v167, s[24:27], s20 offen lds
  s_add_u32 s20, s20, 16384
  s_add_u32 m0, s23, 31744
  s_nop 0
  buffer_load_dwordx4 v167, s[24:27], s20 offen lds
  s_add_u32 s20, s20, 16384
  s_waitcnt vmcnt(0)
  ds_read_b64_tr_b16 a[0:1], v165 offset:0
  ds_read_b64_tr_b16 a[2:3], v165 offset:1024
  ds_read_b64_tr_b16 a[4:5], v165 offset:8
  ds_read_b64_tr_b16 a[6:7], v165 offset:1032
  ds_read_b64_tr_b16 a[8:9], v165 offset:2048
  ds_read_b64_tr_b16 a[10:11], v165 offset:3072
  ds_read_b64_tr_b16 a[12:13], v165 offset:2056
  ds_read_b64_tr_b16 a[14:15], v165 offset:3080
  s_waitcnt lgkmcnt(0)
  ds_read_b64_tr_b16 a[16:17], v165 offset:4096
  ds_read_b64_tr_b16 a[18:19], v165 offset:5120
  ds_read_b64_tr_b16 a[20:21], v165 offset:4104
  ds_read_b64_tr_b16 a[22:23], v165 offset:5128
  ds_read_b64_tr_b16 a[24:25], v165 offset:6144
  ds_read_b64_tr_b16 a[26:27], v165 offset:7168
  ds_read_b64_tr_b16 a[28:29], v165 offset:6152
  ds_read_b64_tr_b16 a[30:31], v165 offset:7176
  s_waitcnt lgkmcnt(0)
  ds_read_b64_tr_b16 a[32:33], v165 offset:8192
  ds_read_b64_tr_b16 a[34:35], v165 offset:9216
  ds_read_b64_tr_b16 a[36:37], v165 offset:8200
  ds_read_b64_tr_b16 a[38:39], v165 offset:9224
  ds_read_b64_tr_b16 a[40:41], v165 offset:10240
  ds_read_b64_tr_b16 a[42:43], v165 offset:11264
  ds_read_b64_tr_b16 a[44:45], v165 offset:10248
  ds_read_b64_tr_b16 a[46:47], v165 offset:11272
  s_waitcnt lgkmcnt(0)
  ds_read_b64_tr_b16 a[48:49], v165 offset:12288
  ds_read_b64_tr_b16 a[50:51], v165 offset:13312
  ds_read_b64_tr_b16 a[52:53], v165 offset:12296
  ds_read_b64_tr_b16 a[54:55], v165 offset:13320
  ds_read_b64_tr_b16 a[56:57], v165 offset:14336
  ds_read_b64_tr_b16 a[58:59], v165 offset:15360
  ds_read_b64_tr_b16 a[60:61], v165 offset:14344
  ds_read_b64_tr_b16 a[62:63], v165 offset:15368
  s_waitcnt lgkmcnt(0)
  ds_read_b64_tr_b16 a[64:65], v165 offset:16384
  ds_read_b64_tr_b16 a[66:67], v165 offset:17408
  ds_read_b64_tr_b16 a[68:69], v165 offset:16392
  ds_read_b64_tr_b16 a[70:71], v165 offset:17416
  ds_read_b64_tr_b16 a[72:73], v165 offset:18432
  ds_read_b64_tr_b16 a[74:75], v165 offset:19456
  ds_read_b64_tr_b16 a[76:77], v165 offset:18440
  ds_read_b64_tr_b16 a[78:79], v165 offset:19464
  s_waitcnt lgkmcnt(0)
  ds_read_b64_tr_b16 a[80:81], v165 offset:20480
  ds_read_b64_tr_b16 a[82:83], v165 offset:21504
  ds_read_b64_tr_b16 a[84:85], v165 offset:20488
  ds_read_b64_tr_b16 a[86:87], v165 offset:21512
  ds_read_b64_tr_b16 a[88:89], v165 offset:22528
  ds_read_b64_tr_b16 a[90:91], v165 offset:23552
  ds_read_b64_tr_b16 a[92:93], v165 offset:22536
  ds_read_b64_tr_b16 a[94:95], v165 offset:23560
  s_waitcnt lgkmcnt(0)
  ds_read_b64_tr_b16 a[96:97], v165 offset:24576
  ds_read_b64_tr_b16 a[98:99], v165 offset:25600
  ds_read_b64_tr_b16 a[100:101], v165 offset:24584
  ds_read_b64_tr_b16 a[102:103], v165 offset:25608
  ds_read_b64_tr_b16 a[104:105], v165 offset:26624
  ds_read_b64_tr_b16 a[106:107], v165 offset:27648
  ds_read_b64_tr_b16 a[108:109], v165 offset:26632
  ds_read_b64_tr_b16 a[110:111], v165 offset:27656
  s_waitcnt lgkmcnt(0)
  ds_read_b64_tr_b16 a[112:113], v165 offset:28672
  ds_read_b64_tr_b16 a[114:115], v165 offset:29696
  ds_read_b64_tr_b16 a[116:117], v165 offset:28680
  ds_read_b64_tr_b16 a[118:119], v165 offset:29704
  ds_read_b64_tr_b16 a[120:121], v165 offset:30720
  ds_read_b64_tr_b16 a[122:123], v165 offset:31744
  ds_read_b64_tr_b16 a[124:125], v165 offset:30728
  ds_read_b64_tr_b16 a[126:127], v165 offset:31752
  s_waitcnt lgkmcnt(0)
  s_add_u32 m0, s23, 0
  s_nop 0
  buffer_load_dwordx4 v167, s[24:27], s20 offen lds
  s_add_u32 s20, s20, 16384
  s_add_u32 m0, s23, 1024
  s_nop 0
  buffer_load_dwordx4 v167, s[24:27], s20 offen lds
  s_add_u32 s20, s20, 16384
  s_add_u32 m0, s23, 2048
  s_nop 0
  buffer_load_dwordx4 v167, s[24:27], s20 offen lds
  s_add_u32 s20, s20, 16384
  s_add_u32 m0, s23, 3072
  s_nop 0
  buffer_load_dwordx4 v167, s[24:27], s20 offen lds
  s_add_u32 s20, s20, 16384
  s_add_u32 m0, s23, 4096
  s_nop 0
  buffer_load_dwordx4 v167, s[24:27], s20 offen lds
  s_add_u32 s20, s20, 16384
  s_add_u32 m0, s23, 5120
  s_nop 0
  buffer_load_dwordx4 v167, s[24:27], s20 offen lds
  s_add_u32 s20, s20, 16384
  s_add_u32 m0, s23, 6144
  s_nop 0
  buffer_load_dwordx4 v167, s[24:27], s20 offen lds
  s_add_u32 s20, s20, 16384
  s_add_u32 m0, s23, 7168
  s_nop 0
  buffer_load_dwordx4 v167, s[24:27], s20 offen lds
  s_add_u32 s20, s20, 16384
  s_add_u32 m0, s23, 8192
  s_nop 0
  buffer_load_dwordx4 v167, s[24:27], s20 offen lds
  s_add_u32 s20, s20, 16384
  s_add_u32 m0, s23, 9216
  s_nop 0
  buffer_load_dwordx4 v167, s[24:27], s20 offen lds
  s_add_u32 s20, s20, 16384
  s_add_u32 m0, s23, 10240
  s_nop 0
  buffer_load_dwordx4 v167, s[24:27], s20 offen lds
  s_add_u32 s20, s20, 16384
  s_add_u32 m0, s23, 11264
  s_nop 0
  buffer_load_dwordx4 v167, s[24:27], s20 offen lds
  s_add_u32 s20, s20, 16384
  s_add_u32 m0, s23, 12288
  s_nop 0
  buffer_load_dwordx4 v167, s[24:27], s20 offen lds
  s_add_u32 s20, s20, 16384
  s_add_u32 m0, s23, 13312
  s_nop 0
  buffer_load_dwordx4 v167, s[24:27], s20 offen lds
  s_add_u32 s20, s20, 16384
  s_add_u32 m0, s23, 14336
  s_nop 0
  buffer_load_dwordx4 v167, s[24:27], s20 offen lds
  s_add_u32 s20, s20, 16384
  s_add_u32 m0, s23, 15360
  s_nop 0
  buffer_load_dwordx4 v167, s[24:27], s20 offen lds
  s_add_u32 s20, s20, 16384
  s_add_u32 m0, s23, 16384
  s_nop 0
  buffer_load_dwordx4 v167, s[24:27], s20 offen lds
  s_add_u32 s20, s20, 16384
  s_add_u32 m0, s23, 17408
  s_nop 0
  buffer_load_dwordx4 v167, s[24:27], s20 offen lds
  s_add_u32 s20, s20, 16384
  s_add_u32 m0, s23, 18432
  s_nop 0
  buffer_load_dwordx4 v167, s[24:27], s20 offen lds
  s_add_u32 s20, s20, 16384
  s_add_u32 m0, s23, 19456
  s_nop 0
  buffer_load_dwordx4 v167, s[24:27], s20 offen lds
  s_add_u32 s20, s20, 16384
  s_add_u32 m0, s23, 20480
  s_nop 0
  buffer_load_dwordx4 v167, s[24:27], s20 offen lds
  s_add_u32 s20, s20, 16384
  s_add_u32 m0, s23, 21504
  s_nop 0
  buffer_load_dwordx4 v167, s[24:27], s20 offen lds
  s_add_u32 s20, s20, 16384
  s_add_u32 m0, s23, 22528
  s_nop 0
  buffer_load_dwordx4 v167, s[24:27], s20 offen lds
  s_add_u32 s20, s20, 16384
  s_add_u32 m0, s23, 23552
  s_nop 0
  buffer_load_dwordx4 v167, s[24:27], s20 offen lds
  s_add_u32 s20, s20, 16384
  s_add_u32 m0, s23, 24576
  s_nop 0
  buffer_load_dwordx4 v167, s[24:27], s20 offen lds
  s_add_u32 s20, s20, 16384
  s_add_u32 m0, s23, 25600
  s_nop 0
  buffer_load_dwordx4 v167, s[24:27], s20 offen lds
  s_add_u32 s20, s20, 16384
  s_add_u32 m0, s23, 26624
  s_nop 0
  buffer_load_dwordx4 v167, s[24:27], s20 offen lds
  s_add_u32 s20, s20, 16384
  s_add_u32 m0, s23, 27648
  s_nop 0
  buffer_load_dwordx4 v167, s[24:27], s20 offen lds
  s_add_u32 s20, s20, 16384
  s_add_u32 m0, s23, 28672
  s_nop 0
  buffer_load_dwordx4 v167, s[24:27], s20 offen lds
  s_add_u32 s20, s20, 16384
  s_add_u32 m0, s23, 29696
  s_nop 0
  buffer_load_dwordx4 v167, s[24:27], s20 offen lds
  s_add_u32 s20, s20, 16384
  s_add_u32 m0, s23, 30720
  s_nop 0
  buffer_load_dwordx4 v167, s[24:27], s20 offen lds
  s_add_u32 s20, s20, 16384
  s_add_u32 m0, s23, 31744
  s_nop 0
  buffer_load_dwordx4 v167, s[24:27], s20 offen lds
  s_add_u32 s20, s20, 16384
  s_waitcnt vmcnt(0)
  ds_read_b64_tr_b16 a[128:129], v165 offset:0
  ds_read_b64_tr_b16 a[130:131], v165 offset:1024
  ds_read_b64_tr_b16 a[132:133], v165 offset:8
  ds_read_b64_tr_b16 a[134:135], v165 offset:1032
  ds_read_b64_tr_b16 a[136:137], v165 offset:2048
  ds_read_b64_tr_b16 a[138:139], v165 offset:3072
  ds_read_b64_tr_b16 a[140:141], v165 offset:2056
  ds_read_b64_tr_b16 a[142:143], v165 offset:3080
  s_waitcnt lgkmcnt(0)
  ds_read_b64_tr_b16 a[144:145], v165 offset:4096
  ds_read_b64_tr_b16 a[146:147], v165 offset:5120
  ds_read_b64_tr_b16 a[148:149], v165 offset:4104
  ds_read_b64_tr_b16 a[150:151], v165 offset:5128
  ds_read_b64_tr_b16 a[152:153], v165 offset:6144
  ds_read_b64_tr_b16 a[154:155], v165 offset:7168
  ds_read_b64_tr_b16 a[156:157], v165 offset:6152
  ds_read_b64_tr_b16 a[158:159], v165 offset:7176
  s_waitcnt lgkmcnt(0)
  ds_read_b64_tr_b16 a[160:161], v165 offset:8192
  ds_read_b64_tr_b16 a[162:163], v165 offset:9216
  ds_read_b64_tr_b16 a[164:165], v165 offset:8200
  ds_read_b64_tr_b16 a[166:167], v165 offset:9224
  ds_read_b64_tr_b16 a[168:169], v165 offset:10240
  ds_read_b64_tr_b16 a[170:171], v165 offset:11264
  ds_read_b64_tr_b16 a[172:173], v165 offset:10248
  ds_read_b64_tr_b16 a[174:175], v165 offset:11272
  s_waitcnt lgkmcnt(0)
  ds_read_b64_tr_b16 a[176:177], v165 offset:12288
  ds_read_b64_tr_b16 a[178:179], v165 offset:13312
  ds_read_b64_tr_b16 a[180:181], v165 offset:12296
  ds_read_b64_tr_b16 a[182:183], v165 offset:13320
  ds_read_b64_tr_b16 a[184:185], v165 offset:14336
  ds_read_b64_tr_b16 a[186:187], v165 offset:15360
  ds_read_b64_tr_b16 a[188:189], v165 offset:14344
  ds_read_b64_tr_b16 a[190:191], v165 offset:15368
  s_waitcnt lgkmcnt(0)
  ds_read_b64_tr_b16 a[192:193], v165 offset:16384
  ds_read_b64_tr_b16 a[194:195], v165 offset:17408
  ds_read_b64_tr_b16 a[196:197], v165 offset:16392
  ds_read_b64_tr_b16 a[198:199], v165 offset:17416
  ds_read_b64_tr_b16 a[200:201], v165 offset:18432
  ds_read_b64_tr_b16 a[202:203], v165 offset:19456
  ds_read_b64_tr_b16 a[204:205], v165 offset:18440
  ds_read_b64_tr_b16 a[206:207], v165 offset:19464
  s_waitcnt lgkmcnt(0)
  ds_read_b64_tr_b16 a[208:209], v165 offset:20480
  ds_read_b64_tr_b16 a[210:211], v165 offset:21504
  ds_read_b64_tr_b16 a[212:213], v165 offset:20488
  ds_read_b64_tr_b16 a[214:215], v165 offset:21512
  ds_read_b64_tr_b16 a[216:217], v165 offset:22528
  ds_read_b64_tr_b16 a[218:219], v165 offset:23552
  ds_read_b64_tr_b16 a[220:221], v165 offset:22536
  ds_read_b64_tr_b16 a[222:223], v165 offset:23560
  s_waitcnt lgkmcnt(0)
  ds_read_b64_tr_b16 a[224:225], v165 offset:24576
  ds_read_b64_tr_b16 a[226:227], v165 offset:25600
  ds_read_b64_tr_b16 a[228:229], v165 offset:24584
  ds_read_b64_tr_b16 a[230:231], v165 offset:25608
  ds_read_b64_tr_b16 a[232:233], v165 offset:26624
  ds_read_b64_tr_b16 a[234:235], v165 offset:27648
  ds_read_b64_tr_b16 a[236:237], v165 offset:26632
  ds_read_b64_tr_b16 a[238:239], v165 offset:27656
  s_waitcnt lgkmcnt(0)
  ds_read_b64_tr_b16 a[240:241], v165 offset:28672
  ds_read_b64_tr_b16 a[242:243], v165 offset:29696
  ds_read_b64_tr_b16 a[244:245], v165 offset:28680
  ds_read_b64_tr_b16 a[246:247], v165 offset:29704
  ds_read_b64_tr_b16 a[248:249], v165 offset:30720
  ds_read_b64_tr_b16 a[250:251], v165 offset:31744
  ds_read_b64_tr_b16 a[252:253], v165 offset:30728
  ds_read_b64_tr_b16 a[254:255], v165 offset:31752
  s_waitcnt lgkmcnt(0)
  v_and_b32 v165, 7, v255
  s_lshl_b32 s20, s16, 3
  v_add_u32 v165, s20, v165
  v_lshlrev_b32 v161, 2, v165
  v_and_b32 v165, 15, v255
  v_lshrrev_b32 v166, 4, v255
  v_lshlrev_b32 v163, 11, v165
  v_lshl_add_u32 v163, v166, 4, v163
  s_lshl_b32 s20, s16, 11
  v_add_u32 v164, s20, v160
  s_mov_b32 s34, 0
  s_barrier
FG_loop:
  s_lshr_b32 s20, s32, 3
  s_add_u32 s20, s20, 1
  v_mov_b32 v162, s20
  s_lshr_b32 s20, s32, 1
  s_and_b32 s20, s20, 3
  s_lshl_b32 s20, s20, 7
  s_add_u32 s20, s20, 83890176
FG_w:
  buffer_load_dword v165, v161, s[4:7], s20 offen sc1
  s_waitcnt vmcnt(0)
  v_cmp_gt_u32 vcc, v162, v165
  s_cbranch_vccz FG_w_ok
  s_sleep 2
  s_sub_u32 s18, s18, 1
  s_cbranch_scc0 FG_w
  s_endpgm
    FG_w_ok:
  s_lshl_b32 s20, s32, 17
  s_lshl_b32 s21, s16, 15
  s_add_u32 s20, s20, s21
  s_add_u32 s20, s20, 50331648
  buffer_load_dwordx4 v[0:3], v160, s[4:7], s20 offen offset:0 sc1
  buffer_load_dwordx4 v[4:7], v160, s[4:7], s20 offen offset:1024 sc1
  buffer_load_dwordx4 v[8:11], v160, s[4:7], s20 offen offset:2048 sc1
  buffer_load_dwordx4 v[12:15], v160, s[4:7], s20 offen offset:3072 sc1
  s_add_u32 s20, s20, 4096
  buffer_load_dwordx4 v[16:19], v160, s[4:7], s20 offen offset:0 sc1
  buffer_load_dwordx4 v[20:23], v160, s[4:7], s20 offen offset:1024 sc1
  buffer_load_dwordx4 v[24:27], v160, s[4:7], s20 offen offset:2048 sc1
  buffer_load_dwordx4 v[28:31], v160, s[4:7], s20 offen offset:3072 sc1
  s_add_u32 s20, s20, 4096
  buffer_load_dwordx4 v[32:35], v160, s[4:7], s20 offen offset:0 sc1
  buffer_load_dwordx4 v[36:39], v160, s[4:7], s20 offen offset:1024 sc1
  buffer_load_dwordx4 v[40:43], v160, s[4:7], s20 offen offset:2048 sc1
  buffer_load_dwordx4 v[44:47], v160, s[4:7], s20 offen offset:3072 sc1
  s_add_u32 s20, s20, 4096
  buffer_load_dwordx4 v[48:51], v160, s[4:7], s20 offen offset:0 sc1
  buffer_load_dwordx4 v[52:55], v160, s[4:7], s20 offen offset:1024 sc1
  buffer_load_dwordx4 v[56:59], v160, s[4:7], s20 offen offset:2048 sc1
  buffer_load_dwordx4 v[60:63], v160, s[4:7], s20 offen offset:3072 sc1
  s_add_u32 s20, s20, 4096
  buffer_load_dwordx4 v[64:67], v160, s[4:7], s20 offen offset:0 sc1
  buffer_load_dwordx4 v[68:71], v160, s[4:7], s20 offen offset:1024 sc1
  buffer_load_dwordx4 v[72:75], v160, s[4:7], s20 offen offset:2048 sc1
  buffer_load_dwordx4 v[76:79], v160, s[4:7], s20 offen offset:3072 sc1
  s_add_u32 s20, s20, 4096
  buffer_load_dwordx4 v[80:83], v160, s[4:7], s20 offen offset:0 sc1
  buffer_load_dwordx4 v[84:87], v160, s[4:7], s20 offen offset:1024 sc1
  buffer_load_dwordx4 v[88:91], v160, s[4:7], s20 offen offset:2048 sc1
  buffer_load_dwordx4 v[92:95], v160, s[4:7], s20 offen offset:3072 sc1
  s_add_u32 s20, s20, 4096
  buffer_load_dwordx4 v[96:99], v160, s[4:7], s20 offen offset:0 sc1
  buffer_load_dwordx4 v[100:103], v160, s[4:7], s20 offen offset:1024 sc1
  buffer_load_dwordx4 v[104:107], v160, s[4:7], s20 offen offset:2048 sc1
  buffer_load_dwordx4 v[108:111], v160, s[4:7], s20 offen offset:3072 sc1
  s_add_u32 s20, s20, 4096
  buffer_load_dwordx4 v[112:115], v160, s[4:7], s20 offen offset:0 sc1
  buffer_load_dwordx4 v[116:119], v160, s[4:7], s20 offen offset:1024 sc1
  buffer_load_dwordx4 v[120:123], v160, s[4:7], s20 offen offset:2048 sc1
  buffer_load_dwordx4 v[124:127], v160, s[4:7], s20 offen offset:3072 sc1
  s_add_u32 s20, s20, 4096
  s_waitcnt vmcnt(31)
  v_mfma_f32_16x16x32_bf16 v[128:131], a[0:3], v[0:3], 0
  v_mfma_f32_16x16x32_bf16 v[132:135], a[4:7], v[0:3], 0
  s_waitcnt vmcnt(30)
  v_mfma_f32_16x16x32_bf16 v[128:131], a[8:11], v[4:7], v[128:131]
  v_mfma_f32_16x16x32_bf16 v[132:135], a[12:15], v[4:7], v[132:135]
  s_waitcnt vmcnt(29)
  v_mfma_f32_16x16x32_bf16 v[128:131], a[16:19], v[8:11], v[128:131]
  v_mfma_f32_16x16x32_bf16 v[132:135], a[20:23], v[8:11], v[132:135]
  s_waitcnt vmcnt(28)
  v_mfma_f32_16x16x32_bf16 v[128:131], a[24:27], v[12:15], v[128:131]
  v_mfma_f32_16x16x32_bf16 v[132:135], a[28:31], v[12:15], v[132:135]
  s_waitcnt vmcnt(27)
  v_mfma_f32_16x16x32_bf16 v[128:131], a[32:35], v[16:19], v[128:131]
  v_mfma_f32_16x16x32_bf16 v[132:135], a[36:39], v[16:19], v[132:135]
  s_waitcnt vmcnt(26)
  v_mfma_f32_16x16x32_bf16 v[128:131], a[40:43], v[20:23], v[128:131]
  v_mfma_f32_16x16x32_bf16 v[132:135], a[44:47], v[20:23], v[132:135]
  s_waitcnt vmcnt(25)
  v_mfma_f32_16x16x32_bf16 v[128:131], a[48:51], v[24:27], v[128:131]
  v_mfma_f32_16x16x32_bf16 v[132:135], a[52:55], v[24:27], v[132:135]
  s_waitcnt vmcnt(24)
  v_mfma_f32_16x16x32_bf16 v[128:131], a[56:59], v[28:31], v[128:131]
  v_mfma_f32_16x16x32_bf16 v[132:135], a[60:63], v[28:31], v[132:135]
  s_waitcnt vmcnt(23)
  v_mfma_f32_16x16x32_bf16 v[128:131], a[64:67], v[32:35], v[128:131]
  v_mfma_f32_16x16x32_bf16 v[132:135], a[68:71], v[32:35], v[132:135]
  s_waitcnt vmcnt(22)
  v_mfma_f32_16x16x32_bf16 v[128:131], a[72:75], v[36:39], v[128:131]
  v_mfma_f32_16x16x32_bf16 v[132:135], a[76:79], v[36:39], v[132:135]
  s_waitcnt vmcnt(21)
  v_mfma_f32_16x16x32_bf16 v[128:131], a[80:83], v[40:43], v[128:131]
  v_mfma_f32_16x16x32_bf16 v[132:135], a[84:87], v[40:43], v[132:135]
  s_waitcnt vmcnt(20)
  v_mfma_f32_16x16x32_bf16 v[128:131], a[88:91], v[44:47], v[128:131]
  v_mfma_f32_16x16x32_bf16 v[132:135], a[92:95], v[44:47], v[132:135]
  s_waitcnt vmcnt(19)
  v_mfma_f32_16x16x32_bf16 v[128:131], a[96:99], v[48:51], v[128:131]
  v_mfma_f32_16x16x32_bf16 v[132:135], a[100:103], v[48:51], v[132:135]
  s_waitcnt vmcnt(18)
  v_mfma_f32_16x16x32_bf16 v[128:131], a[104:107], v[52:55], v[128:131]
  v_mfma_f32_16x16x32_bf16 v[132:135], a[108:111], v[52:55], v[132:135]
  s_waitcnt vmcnt(17)
  v_mfma_f32_16x16x32_bf16 v[128:131], a[112:115], v[56:59], v[128:131]
  v_mfma_f32_16x16x32_bf16 v[132:135], a[116:119], v[56:59], v[132:135]
  s_waitcnt vmcnt(16)
  v_mfma_f32_16x16x32_bf16 v[128:131], a[120:123], v[60:63], v[128:131]
  v_mfma_f32_16x16x32_bf16 v[132:135], a[124:127], v[60:63], v[132:135]
  s_waitcnt vmcnt(15)
  v_mfma_f32_16x16x32_bf16 v[128:131], a[128:131], v[64:67], v[128:131]
  v_mfma_f32_16x16x32_bf16 v[132:135], a[132:135], v[64:67], v[132:135]
  s_waitcnt vmcnt(14)
  v_mfma_f32_16x16x32_bf16 v[128:131], a[136:139], v[68:71], v[128:131]
  v_mfma_f32_16x16x32_bf16 v[132:135], a[140:143], v[68:71], v[132:135]
  s_waitcnt vmcnt(13)
  v_mfma_f32_16x16x32_bf16 v[128:131], a[144:147], v[72:75], v[128:131]
  v_mfma_f32_16x16x32_bf16 v[132:135], a[148:151], v[72:75], v[132:135]
  s_waitcnt vmcnt(12)
  v_mfma_f32_16x16x32_bf16 v[128:131], a[152:155], v[76:79], v[128:131]
  v_mfma_f32_16x16x32_bf16 v[132:135], a[156:159], v[76:79], v[132:135]
  s_waitcnt vmcnt(11)
  v_mfma_f32_16x16x32_bf16 v[128:131], a[160:163], v[80:83], v[128:131]
  v_mfma_f32_16x16x32_bf16 v[132:135], a[164:167], v[80:83], v[132:135]
  s_waitcnt vmcnt(10)
  v_mfma_f32_16x16x32_bf16 v[128:131], a[168:171], v[84:87], v[128:131]
  v_mfma_f32_16x16x32_bf16 v[132:135], a[172:175], v[84:87], v[132:135]
  s_waitcnt vmcnt(9)
  v_mfma_f32_16x16x32_bf16 v[128:131], a[176:179], v[88:91], v[128:131]
  v_mfma_f32_16x16x32_bf16 v[132:135], a[180:183], v[88:91], v[132:135]
  s_waitcnt vmcnt(8)
  v_mfma_f32_16x16x32_bf16 v[128:131], a[184:187], v[92:95], v[128:131]
  v_mfma_f32_16x16x32_bf16 v[132:135], a[188:191], v[92:95], v[132:135]
  s_waitcnt vmcnt(7)
  v_mfma_f32_16x16x32_bf16 v[128:131], a[192:195], v[96:99], v[128:131]
  v_mfma_f32_16x16x32_bf16 v[132:135], a[196:199], v[96:99], v[132:135]
  s_waitcnt vmcnt(6)
  v_mfma_f32_16x16x32_bf16 v[128:131], a[200:203], v[100:103], v[128:131]
  v_mfma_f32_16x16x32_bf16 v[132:135], a[204:207], v[100:103], v[132:135]
  s_waitcnt vmcnt(5)
  v_mfma_f32_16x16x32_bf16 v[128:131], a[208:211], v[104:107], v[128:131]
  v_mfma_f32_16x16x32_bf16 v[132:135], a[212:215], v[104:107], v[132:135]
  s_waitcnt vmcnt(4)
  v_mfma_f32_16x16x32_bf16 v[128:131], a[216:219], v[108:111], v[128:131]
  v_mfma_f32_16x16x32_bf16 v[132:135], a[220:223], v[108:111], v[132:135]
  s_waitcnt vmcnt(3)
  v_mfma_f32_16x16x32_bf16 v[128:131], a[224:227], v[112:115], v[128:131]
  v_mfma_f32_16x16x32_bf16 v[132:135], a[228:231], v[112:115], v[132:135]
  s_waitcnt vmcnt(2)
  v_mfma_f32_16x16x32_bf16 v[128:131], a[232:235], v[116:119], v[128:131]
  v_mfma_f32_16x16x32_bf16 v[132:135], a[236:239], v[116:119], v[132:135]
  s_waitcnt vmcnt(1)
  v_mfma_f32_16x16x32_bf16 v[128:131], a[240:243], v[120:123], v[128:131]
  v_mfma_f32_16x16x32_bf16 v[132:135], a[244:247], v[120:123], v[132:135]
  s_waitcnt vmcnt(0)
  v_mfma_f32_16x16x32_bf16 v[128:131], a[248:251], v[124:127], v[128:131]
  v_mfma_f32_16x16x32_bf16 v[132:135], a[252:255], v[124:127], v[132:135]
  v_add_u32 v165, s34, v164
  v_add_u32 v166, s34, v160
  ds_write_b128 v165, v[128:131]
  s_nop 1
  ds_write_b128 v165, v[132:135] offset:1024
  s_waitcnt lgkmcnt(0)
  s_barrier
  s_cmp_eq_u32 s16, 0
  s_cbranch_scc0 FG_next
  ds_read_b128 v[136:139], v166 offset:2048
  ds_read_b128 v[140:143], v166 offset:3072
  ds_read_b128 v[144:147], v166 offset:4096
  ds_read_b128 v[148:151], v166 offset:5120
  ds_read_b128 v[152:155], v166 offset:6144
  ds_read_b128 v[156:159], v166 offset:7168
  s_lshl_b32 s20, s32, 15
  s_lshl_b32 s21, s33, 6
  s_add_u32 s20, s20, s21
  s_waitcnt lgkmcnt(0)
  v_add_f32 v128, v128, v136
  v_add_f32 v129, v129, v137
  v_add_f32 v130, v130, v138
  v_add_f32 v131, v131, v139
  v_add_f32 v132, v132, v140
  v_add_f32 v133, v133, v141
  v_add_f32 v134, v134, v142
  v_add_f32 v135, v135, v143
  v_add_f32 v128, v128, v144
  v_add_f32 v129, v129, v145
  v_add_f32 v130, v130, v146
  v_add_f32 v131, v131, v147
  v_add_f32 v132, v132, v148
  v_add_f32 v133, v133, v149
  v_add_f32 v134, v134, v150
  v_add_f32 v135, v135, v151
  v_add_f32 v128, v128, v152
  v_add_f32 v129, v129, v153
  v_add_f32 v130, v130, v154
  v_add_f32 v131, v131, v155
  v_add_f32 v132, v132, v156
  v_add_f32 v133, v133, v157
  v_add_f32 v134, v134, v158
  v_add_f32 v135, v135, v159
  v_cvt_pk_bf16_f32 v136, v128, v129
  v_cvt_pk_bf16_f32 v137, v130, v131
  v_cvt_pk_bf16_f32 v138, v132, v133
  v_cvt_pk_bf16_f32 v139, v134, v135
  buffer_store_dwordx4 v[136:139], v163, s[28:31], s20 offen offset:1024
FG_next:
  s_xor_b32 s34, s34, 8192
  s_add_u32 s32, s32, 8
  s_cmp_lt_u32 s32, 128
  s_cbranch_scc1 FG_loop
  s_endpgm
FA_entry:
  v_mov_b32 v207, 4
  v_mov_b32 v208, 32
  s_cmp_eq_u32 s16, 0
  s_cbranch_scc0 FA_init_ok
FA_init:
  buffer_load_dword v209, v207, s[12:15], 0 offen sc1
  s_waitcnt vmcnt(0)
  v_cmp_gt_u32 vcc, v208, v209
  s_cbranch_vccz FA_init_ok
  s_sleep 8
  s_sub_u32 s18, s18, 1
  s_cbranch_scc0 FA_init
  s_endpgm
    FA_init_ok:
  s_sub_u32 s17, s3, 192
  v_and_b32 v208, 15, v255
  v_lshrrev_b32 v209, 4, v255
  v_bfe_u32 v207, v255, 3, 1
  v_lshlrev_b32 v200, 9, v207
  v_lshl_add_u32 v200, v209, 7, v200
  v_and_b32 v207, 7, v255
  v_lshl_add_u32 v200, v207, 4, v200
  v_lshlrev_b32 v201, 2, v208
  v_lshlrev_b32 v204, 4, v255
  v_and_b32 v207, 1, v209
  v_mul_u32_u24 v206, 1088, v207
  v_lshl_add_u32 v206, v208, 3, v206
  v_and_b32 v207, 1, v255
  v_mul_u32_u24 v205, 1088, v207
  v_lshl_add_u32 v205, v209, 5, v205
  v_bfe_u32 v207, v255, 2, 2
  v_lshl_add_u32 v205, v207, 3, v205
  s_lshl_b32 s20, s16, 12
  v_add_u32 v205, s20, v205
  v_mov_b32 v212, 0xf149f2ca
  v_cmp_lt_u32 vcc, 1, v209
  v_lshlrev_b32 v207, 2, v209
  s_nop 0
  v_cndmask_b32 v176, 0, v212, vcc
  v_cndmask_b32 v177, 0, v212, vcc
  v_cndmask_b32 v178, 0, v212, vcc
  v_cndmask_b32 v179, 0, v212, vcc
  v_cmp_gt_u32 vcc, v207, v208
  s_nop 1
  v_cndmask_b32 v172, 0, v212, vcc
  v_add_u32 v207, 1, v207
  v_mov_b32 v168, 0x3f803f80
  v_cmp_gt_u32 vcc, v207, v208
  s_nop 1
  v_cndmask_b32 v173, 0, v212, vcc
  v_add_u32 v207, 1, v207
  v_mov_b32 v169, 0x3f803f80
  v_cmp_gt_u32 vcc, v207, v208
  s_nop 1
  v_cndmask_b32 v174, 0, v212, vcc
  v_add_u32 v207, 1, v207
  v_mov_b32 v170, 0x3f803f80
  v_cmp_gt_u32 vcc, v207, v208
  s_nop 1
  v_cndmask_b32 v175, 0, v212, vcc
  v_add_u32 v207, 1, v207
  v_mov_b32 v171, 0x3f803f80
  v_mov_b64 v[150:151], 0
  s_and_b32 s20, s16, 1
  s_lshl_b32 s30, 0x15, s20
  s_mov_b32 s31, 0
  s_mov_b64 s[32:33], 0x100
  s_lshl_b32 s26, s17, 7
  s_add_u32 s26, s26, 83886080
  s_lshl_b32 s28, s16, 7
  s_lshl_b32 s20, s17, 2
  s_add_u32 s28, s28, s20
  s_add_u32 s28, s28, 83890176
  s_mov_b32 s24, s16
  s_mov_b32 s29, 0
  s_barrier
FA_loop:
  s_lshr_b32 s20, s24, 1
  s_add_u32 s20, s20, 1
  v_mov_b32 v207, s20
  v_cndmask_b32 v202, 0, v207, s[30:31]
  s_add_u32 s20, s24, 1
  v_mov_b32 v207, s20
  v_cndmask_b32 v203, 0, v207, s[32:33]
  s_lshl_b32 s25, s24, 18
  s_lshl_b32 s20, s17, 12
  s_add_u32 s27, s25, s20
  s_add_u32 s25, s27, s20
  s_add_u32 s27, s27, 50331648
FA_w1:
  buffer_load_dword v207, v201, s[4:7], s26 offen sc1
  s_waitcnt vmcnt(0)
  v_cmp_gt_u32 vcc, v202, v207
  s_cbranch_vccz FA_w1_ok
  s_sleep 2
  s_sub_u32 s18, s18, 1
  s_cbranch_scc0 FA_w1
  s_endpgm
    FA_w1_ok:
  s_add_u32 s20, s25, 0
  s_add_u32 s21, s20, 4096
  buffer_load_dwordx4 v[0:3], v200, s[4:7], s20 offen offset:0 sc1
  buffer_load_dwordx4 v[4:7], v200, s[4:7], s20 offen offset:1024 sc1
  buffer_load_dwordx4 v[8:11], v200, s[4:7], s20 offen offset:2048 sc1
  buffer_load_dwordx4 v[12:15], v200, s[4:7], s20 offen offset:3072 sc1
  buffer_load_dwordx4 v[16:19], v200, s[4:7], s21 offen offset:0 sc1
  buffer_load_dwordx4 v[20:23], v200, s[4:7], s21 offen offset:1024 sc1
  buffer_load_dwordx4 v[24:27], v200, s[4:7], s21 offen offset:2048 sc1
  buffer_load_dwordx4 v[28:31], v200, s[4:7], s21 offen offset:3072 sc1
  s_add_u32 s20, s25, 16777216
  s_add_u32 s21, s20, 4096
  buffer_load_dwordx4 v[32:35], v200, s[4:7], s20 offen offset:0 sc1
  buffer_load_dwordx4 v[36:39], v200, s[4:7], s20 offen offset:1024 sc1
  buffer_load_dwordx4 v[40:43], v200, s[4:7], s20 offen offset:2048 sc1
  buffer_load_dwordx4 v[44:47], v200, s[4:7], s20 offen offset:3072 sc1
  buffer_load_dwordx4 v[48:51], v200, s[4:7], s21 offen offset:0 sc1
  buffer_load_dwordx4 v[52:55], v200, s[4:7], s21 offen offset:1024 sc1
  buffer_load_dwordx4 v[56:59], v200, s[4:7], s21 offen offset:2048 sc1
  buffer_load_dwordx4 v[60:63], v200, s[4:7], s21 offen offset:3072 sc1
  s_add_u32 s20, s25, 33554432
  s_add_u32 s21, s20, 4096
  buffer_load_dwordx4 v[64:67], v200, s[4:7], s20 offen offset:0 sc1
  buffer_load_dwordx4 v[68:71], v200, s[4:7], s20 offen offset:1024 sc1
  buffer_load_dwordx4 v[72:75], v200, s[4:7], s20 offen offset:2048 sc1
  buffer_load_dwordx4 v[76:79], v200, s[4:7], s20 offen offset:3072 sc1
  buffer_load_dwordx4 v[80:83], v200, s[4:7], s21 offen offset:0 sc1
  buffer_load_dwordx4 v[84:87], v200, s[4:7], s21 offen offset:1024 sc1
  buffer_load_dwordx4 v[88:91], v200, s[4:7], s21 offen offset:2048 sc1
  buffer_load_dwordx4 v[92:95], v200, s[4:7], s21 offen offset:3072 sc1
  s_waitcnt vmcnt(8)
  v_mfma_f32_16x16x32_bf16 v[128:131], v[32:35], v[0:3], v[172:175]
  v_mfma_f32_16x16x32_bf16 v[128:131], v[36:39], v[4:7], v[128:131]
  v_mfma_f32_16x16x32_bf16 v[128:131], v[40:43], v[8:11], v[128:131]
  v_mfma_f32_16x16x32_bf16 v[128:131], v[44:47], v[12:15], v[128:131]
  v_mfma_f32_16x16x32_bf16 v[132:135], v[32:35], v[16:19], 0
  v_mfma_f32_16x16x32_bf16 v[132:135], v[36:39], v[20:23], v[132:135]
  v_mfma_f32_16x16x32_bf16 v[132:135], v[40:43], v[24:27], v[132:135]
  v_mfma_f32_16x16x32_bf16 v[132:135], v[44:47], v[28:31], v[132:135]
  v_mfma_f32_16x16x32_bf16 v[136:139], v[48:51], v[16:19], v[172:175]
  v_mfma_f32_16x16x32_bf16 v[136:139], v[52:55], v[20:23], v[136:139]
  v_mfma_f32_16x16x32_bf16 v[136:139], v[56:59], v[24:27], v[136:139]
  v_mfma_f32_16x16x32_bf16 v[136:139], v[60:63], v[28:31], v[136:139]
FA_w2:
  buffer_load_dword v207, v201, s[4:7], s26 offen sc1
  s_waitcnt vmcnt(0)
  v_cmp_gt_u32 vcc, v203, v207
  s_cbranch_vccz FA_w2_ok
  s_sleep 2
  s_sub_u32 s18, s18, 1
  s_cbranch_scc0 FA_w2
  s_endpgm
    FA_w2_ok:
  s_add_u32 s20, s25, 67108864
  buffer_load_dwordx4 v[212:215], v204, s[4:7], s20 offen sc1
  buffer_load_dwordx4 v[216:219], v204, s[4:7], s20 offen offset:1088 sc1
  buffer_load_dwordx2 v[112:113], v206, s[4:7], s20 offen offset:2176 sc1
  buffer_load_dwordx2 v[114:115], v206, s[4:7], s20 offen offset:2304 sc1
  buffer_load_dwordx2 v[116:117], v206, s[4:7], s20 offen offset:2432 sc1
  buffer_load_dwordx2 v[118:119], v206, s[4:7], s20 offen offset:2560 sc1
  buffer_load_dwordx2 v[120:121], v206, s[4:7], s20 offen offset:2688 sc1
  buffer_load_dwordx2 v[122:123], v206, s[4:7], s20 offen offset:2816 sc1
  buffer_load_dwordx2 v[124:125], v206, s[4:7], s20 offen offset:2944 sc1
  buffer_load_dwordx2 v[126:127], v206, s[4:7], s20 offen offset:3072 sc1
  s_lshl_b32 s20, s16, 12
  v_add_u32 v207, s20, v204
  s_waitcnt vmcnt(8)
  ds_write_b128 v207, v[212:215]
  ds_write_b128 v207, v[216:219] offset:1088
  s_waitcnt lgkmcnt(0)
  ds_read_b64_tr_b16 v[96:97], v205 offset:0
  ds_read_b64_tr_b16 v[98:99], v205 offset:128
  ds_read_b64_tr_b16 v[100:101], v205 offset:256
  ds_read_b64_tr_b16 v[102:103], v205 offset:384
  ds_read_b64_tr_b16 v[104:105], v205 offset:512
  ds_read_b64_tr_b16 v[106:107], v205 offset:640
  ds_read_b64_tr_b16 v[108:109], v205 offset:768
  ds_read_b64_tr_b16 v[110:111], v205 offset:896
  s_waitcnt lgkmcnt(0)
  v_mfma_f32_16x16x32_bf16 v[140:143], v[96:99], v[0:3], v[176:179]
  v_mfma_f32_16x16x32_bf16 v[140:143], v[100:103], v[4:7], v[140:143]
  v_mfma_f32_16x16x32_bf16 v[140:143], v[104:107], v[8:11], v[140:143]
  v_mfma_f32_16x16x32_bf16 v[140:143], v[108:111], v[12:15], v[140:143]
  v_mfma_f32_16x16x32_bf16 v[144:147], v[96:99], v[16:19], v[176:179]
  v_mfma_f32_16x16x32_bf16 v[144:147], v[100:103], v[20:23], v[144:147]
  v_mfma_f32_16x16x32_bf16 v[144:147], v[104:107], v[24:27], v[144:147]
  v_mfma_f32_16x16x32_bf16 v[144:147], v[108:111], v[28:31], v[144:147]
  v_max3_f32 v207, v128, v129, v130
  v_max3_f32 v207, v207, v131, v140
  v_max3_f32 v207, v207, v141, v142
  v_max_f32 v207, v207, v143
  v_mov_b32 v208, v207
  s_nop 1
  v_permlane32_swap_b32 v207, v208
  v_max_f32 v207, v207, v208
  v_mov_b32 v208, v207
  s_nop 1
  v_permlane16_swap_b32 v207, v208
  v_max_f32 v207, v207, v208
  v_sub_f32 v128, v128, v207
  v_sub_f32 v129, v129, v207
  v_sub_f32 v130, v130, v207
  v_sub_f32 v131, v131, v207
  v_sub_f32 v140, v140, v207
  v_sub_f32 v141, v141, v207
  v_sub_f32 v142, v142, v207
  v_sub_f32 v143, v143, v207
  v_exp_f32 v128, v128
  v_exp_f32 v129, v129
  v_exp_f32 v130, v130
  v_exp_f32 v131, v131
  v_exp_f32 v140, v140
  v_exp_f32 v141, v141
  v_exp_f32 v142, v142
  v_exp_f32 v143, v143
  v_cvt_pk_bf16_f32 v148, v128, v129
  v_cvt_pk_bf16_f32 v149, v130, v131
  v_cvt_pk_bf16_f32 v156, v140, v141
  v_cvt_pk_bf16_f32 v157, v142, v143
  v_mfma_f32_16x16x32_bf16 v[160:163], v[168:171], v[148:151], 0
  s_nop 5
  v_mfma_f32_16x16x16_bf16 v[160:163], v[168:169], v[156:157], v[160:163]
  v_max3_f32 v207, v132, v133, v134
  v_max3_f32 v207, v207, v135, v136
  v_max3_f32 v207, v207, v137, v138
  v_max3_f32 v207, v207, v139, v144
  v_max3_f32 v207, v207, v145, v146
  v_max_f32 v207, v207, v147
  v_mov_b32 v208, v207
  s_nop 1
  v_permlane32_swap_b32 v207, v208
  v_max_f32 v207, v207, v208
  v_mov_b32 v208, v207
  s_nop 1
  v_permlane16_swap_b32 v207, v208
  v_max_f32 v207, v207, v208
  v_sub_f32 v132, v132, v207
  v_sub_f32 v133, v133, v207
  v_sub_f32 v134, v134, v207
  v_sub_f32 v135, v135, v207
  v_sub_f32 v136, v136, v207
  v_sub_f32 v137, v137, v207
  v_sub_f32 v138, v138, v207
  v_sub_f32 v139, v139, v207
  v_sub_f32 v144, v144, v207
  v_sub_f32 v145, v145, v207
  v_sub_f32 v146, v146, v207
  v_sub_f32 v147, v147, v207
  v_exp_f32 v132, v132
  v_exp_f32 v133, v133
  v_exp_f32 v134, v134
  v_exp_f32 v135, v135
  v_exp_f32 v136, v136
  v_exp_f32 v137, v137
  v_exp_f32 v138, v138
  v_exp_f32 v139, v139
  v_exp_f32 v144, v144
  v_exp_f32 v145, v145
  v_exp_f32 v146, v146
  v_exp_f32 v147, v147
  v_cvt_pk_bf16_f32 v152, v132, v133
  v_cvt_pk_bf16_f32 v153, v134, v135
  v_cvt_pk_bf16_f32 v154, v136, v137
  v_cvt_pk_bf16_f32 v155, v138, v139
  v_cvt_pk_bf16_f32 v158, v144, v145
  v_cvt_pk_bf16_f32 v159, v146, v147
  v_mfma_f32_16x16x32_bf16 v[164:167], v[168:171], v[152:155], 0
  s_nop 5
  v_mfma_f32_16x16x16_bf16 v[164:167], v[168:169], v[158:159], v[164:167]
  s_waitcnt vmcnt(0)
  v_rcp_f32 v160, v160
  s_nop 4
  v_rcp_f32 v164, v164
  v_mfma_f32_16x16x32_bf16 v[180:183], v[64:67], v[148:151], 0
  v_mfma_f32_16x16x32_bf16 v[184:187], v[68:71], v[148:151], 0
  v_mfma_f32_16x16x16_bf16 v[180:183], v[112:113], v[156:157], v[180:183]
  v_mfma_f32_16x16x16_bf16 v[184:187], v[114:115], v[156:157], v[184:187]
  v_mfma_f32_16x16x32_bf16 v[188:191], v[72:75], v[148:151], 0
  v_mfma_f32_16x16x32_bf16 v[192:195], v[76:79], v[148:151], 0
  v_mfma_f32_16x16x16_bf16 v[188:191], v[116:117], v[156:157], v[188:191]
  v_mfma_f32_16x16x16_bf16 v[192:195], v[118:119], v[156:157], v[192:195]
  v_mul_f32 v180, v160, v180
  v_mul_f32 v181, v160, v181
  v_mul_f32 v182, v160, v182
  v_mul_f32 v183, v160, v183
  v_mul_f32 v184, v160, v184
  v_mul_f32 v185, v160, v185
  v_mul_f32 v186, v160, v186
  v_mul_f32 v187, v160, v187
  v_cvt_pk_bf16_f32 v0, v180, v181
  v_cvt_pk_bf16_f32 v1, v182, v183
  v_cvt_pk_bf16_f32 v2, v184, v185
  v_cvt_pk_bf16_f32 v3, v186, v187
  buffer_store_dwordx4 v[0:3], v204, s[4:7], s27 offen offset:0 sc1
  v_mfma_f32_16x16x32_bf16 v[180:183], v[80:83], v[148:151], 0
  v_mfma_f32_16x16x32_bf16 v[184:187], v[84:87], v[148:151], 0
  v_mfma_f32_16x16x16_bf16 v[180:183], v[120:121], v[156:157], v[180:183]
  v_mfma_f32_16x16x16_bf16 v[184:187], v[122:123], v[156:157], v[184:187]
  v_mul_f32 v188, v160, v188
  v_mul_f32 v189, v160, v189
  v_mul_f32 v190, v160, v190
  v_mul_f32 v191, v160, v191
  v_mul_f32 v192, v160, v192
  v_mul_f32 v193, v160, v193
  v_mul_f32 v194, v160, v194
  v_mul_f32 v195, v160, v195
  v_cvt_pk_bf16_f32 v4, v188, v189
  v_cvt_pk_bf16_f32 v5, v190, v191
  v_cvt_pk_bf16_f32 v6, v192, v193
  v_cvt_pk_bf16_f32 v7, v194, v195
  buffer_store_dwordx4 v[4:7], v204, s[4:7], s27 offen offset:1024 sc1
  v_mfma_f32_16x16x32_bf16 v[188:191], v[88:91], v[148:151], 0
  v_mfma_f32_16x16x32_bf16 v[192:195], v[92:95], v[148:151], 0
  v_mfma_f32_16x16x16_bf16 v[188:191], v[124:125], v[156:157], v[188:191]
  v_mfma_f32_16x16x16_bf16 v[192:195], v[126:127], v[156:157], v[192:195]
  v_mul_f32 v180, v160, v180
  v_mul_f32 v181, v160, v181
  v_mul_f32 v182, v160, v182
  v_mul_f32 v183, v160, v183
  v_mul_f32 v184, v160, v184
  v_mul_f32 v185, v160, v185
  v_mul_f32 v186, v160, v186
  v_mul_f32 v187, v160, v187
  v_cvt_pk_bf16_f32 v8, v180, v181
  v_cvt_pk_bf16_f32 v9, v182, v183
  v_cvt_pk_bf16_f32 v10, v184, v185
  v_cvt_pk_bf16_f32 v11, v186, v187
  buffer_store_dwordx4 v[8:11], v204, s[4:7], s27 offen offset:2048 sc1
  v_mfma_f32_16x16x32_bf16 v[180:183], v[64:67], v[152:155], 0
  v_mfma_f32_16x16x32_bf16 v[184:187], v[68:71], v[152:155], 0
  v_mfma_f32_16x16x16_bf16 v[180:183], v[112:113], v[158:159], v[180:183]
  v_mfma_f32_16x16x16_bf16 v[184:187], v[114:115], v[158:159], v[184:187]
  v_mul_f32 v188, v160, v188
  v_mul_f32 v189, v160, v189
  v_mul_f32 v190, v160, v190
  v_mul_f32 v191, v160, v191
  v_mul_f32 v192, v160, v192
  v_mul_f32 v193, v160, v193
  v_mul_f32 v194, v160, v194
  v_mul_f32 v195, v160, v195
  v_cvt_pk_bf16_f32 v12, v188, v189
  v_cvt_pk_bf16_f32 v13, v190, v191
  v_cvt_pk_bf16_f32 v14, v192, v193
  v_cvt_pk_bf16_f32 v15, v194, v195
  buffer_store_dwordx4 v[12:15], v204, s[4:7], s27 offen offset:3072 sc1
  v_mfma_f32_16x16x32_bf16 v[188:191], v[72:75], v[152:155], 0
  v_mfma_f32_16x16x32_bf16 v[192:195], v[76:79], v[152:155], 0
  v_mfma_f32_16x16x16_bf16 v[188:191], v[116:117], v[158:159], v[188:191]
  v_mfma_f32_16x16x16_bf16 v[192:195], v[118:119], v[158:159], v[192:195]
  v_mul_f32 v180, v164, v180
  v_mul_f32 v181, v164, v181
  v_mul_f32 v182, v164, v182
  v_mul_f32 v183, v164, v183
  v_mul_f32 v184, v164, v184
  v_mul_f32 v185, v164, v185
  v_mul_f32 v186, v164, v186
  v_mul_f32 v187, v164, v187
  v_cvt_pk_bf16_f32 v16, v180, v181
  v_cvt_pk_bf16_f32 v17, v182, v183
  v_cvt_pk_bf16_f32 v18, v184, v185
  v_cvt_pk_bf16_f32 v19, v186, v187
  s_add_u32 s27, s27, 131072
  buffer_store_dwordx4 v[16:19], v204, s[4:7], s27 offen offset:0 sc1
  v_mfma_f32_16x16x32_bf16 v[180:183], v[80:83], v[152:155], 0
  v_mfma_f32_16x16x32_bf16 v[184:187], v[84:87], v[152:155], 0
  v_mfma_f32_16x16x16_bf16 v[180:183], v[120:121], v[158:159], v[180:183]
  v_mfma_f32_16x16x16_bf16 v[184:187], v[122:123], v[158:159], v[184:187]
  v_mul_f32 v188, v164, v188
  v_mul_f32 v189, v164, v189
  v_mul_f32 v190, v164, v190
  v_mul_f32 v191, v164, v191
  v_mul_f32 v192, v164, v192
  v_mul_f32 v193, v164, v193
  v_mul_f32 v194, v164, v194
  v_mul_f32 v195, v164, v195
  v_cvt_pk_bf16_f32 v20, v188, v189
  v_cvt_pk_bf16_f32 v21, v190, v191
  v_cvt_pk_bf16_f32 v22, v192, v193
  v_cvt_pk_bf16_f32 v23, v194, v195
  buffer_store_dwordx4 v[20:23], v204, s[4:7], s27 offen offset:1024 sc1
  v_mfma_f32_16x16x32_bf16 v[188:191], v[88:91], v[152:155], 0
  v_mfma_f32_16x16x32_bf16 v[192:195], v[92:95], v[152:155], 0
  v_mfma_f32_16x16x16_bf16 v[188:191], v[124:125], v[158:159], v[188:191]
  v_mfma_f32_16x16x16_bf16 v[192:195], v[126:127], v[158:159], v[192:195]
  v_mul_f32 v180, v164, v180
  v_mul_f32 v181, v164, v181
  v_mul_f32 v182, v164, v182
  v_mul_f32 v183, v164, v183
  v_mul_f32 v184, v164, v184
  v_mul_f32 v185, v164, v185
  v_mul_f32 v186, v164, v186
  v_mul_f32 v187, v164, v187
  v_cvt_pk_bf16_f32 v24, v180, v181
  v_cvt_pk_bf16_f32 v25, v182, v183
  v_cvt_pk_bf16_f32 v26, v184, v185
  v_cvt_pk_bf16_f32 v27, v186, v187
  buffer_store_dwordx4 v[24:27], v204, s[4:7], s27 offen offset:2048 sc1
  v_mul_f32 v188, v164, v188
  v_mul_f32 v189, v164, v189
  v_mul_f32 v190, v164, v190
  v_mul_f32 v191, v164, v191
  v_mul_f32 v192, v164, v192
  v_mul_f32 v193, v164, v193
  v_mul_f32 v194, v164, v194
  v_mul_f32 v195, v164, v195
  v_cvt_pk_bf16_f32 v28, v188, v189
  v_cvt_pk_bf16_f32 v29, v190, v191
  v_cvt_pk_bf16_f32 v30, v192, v193
  v_cvt_pk_bf16_f32 v31, v194, v195
  buffer_store_dwordx4 v[28:31], v204, s[4:7], s27 offen offset:3072 sc1
  s_add_u32 s29, s29, 1
  s_add_u32 s24, s24, 4
  s_waitcnt vmcnt(0)
  v_mov_b32 v207, s29
  s_mov_b64 exec, 1
  buffer_store_dword v207, off, s[4:7], s28 sc1
  s_mov_b64 exec, -1
  s_cmp_lt_u32 s29, 16
  s_cbranch_scc1 FA_loop
  s_endpgm
R_entry:
  s_load_dwordx2 s[52:53], s[0:1], 40
  s_mov_b32 s54, 4194304
  s_mov_b32 s55, 0x20000
  s_load_dwordx2 s[56:57], s[0:1], 48
  s_mov_b32 s58, 4194304
  s_mov_b32 s59, 0x20000
  s_load_dwordx2 s[60:61], s[0:1], 56
  s_mov_b32 s62, 4194304
  s_mov_b32 s63, 0x20000
  s_load_dwordx2 s[64:65], s[0:1], 64
  s_mov_b32 s66, 4194304
  s_mov_b32 s67, 0x20000
  s_load_dwordx2 s[8:9], s[0:1], 32
  s_mov_b32 s10, 8192
  s_mov_b32 s11, 0x20000
  v_and_b32 v64, 63, v0
  v_and_b32 v65, 15, v0
  v_lshrrev_b32 v66, 4, v64
  v_lshrrev_b32 v67, 2, v65
  v_and_b32 v68, 3, v0
  s_and_b32 s20, s16, 1
  s_lshl_b32 s20, s20, 3
  v_and_b32 v73, 1, v66
  v_lshlrev_b32 v73, 2, v73
  v_or_b32 v73, s20, v73
  v_xor_b32 v73, v73, v65
  v_lshlrev_b32 v73, 4, v73
  v_lshl_add_u32 v69, v66, 13, v73
  s_lshl_b32 s20, s16, 15
  v_add_u32 v69, s20, v69
  s_and_b32 s20, s16, 1
  s_lshr_b32 s21, s16, 1
  s_lshl_b32 s21, s21, 4
  s_add_u32 s23, s20, s21
  s_lshl_b32 s23, s23, 10
  s_lshl_b32 s20, s16, 2
  v_xor_b32 v70, s20, v64
  v_lshlrev_b32 v70, 4, v70
  v_add_u32 v70, s23, v70
  s_and_b32 s20, s16, 1
  s_lshr_b32 s21, s16, 1
  s_lshl_b32 s21, s21, 2
  s_add_u32 s23, s20, s21
  s_lshl_b32 s23, s23, 10
  s_waitcnt lgkmcnt(0)
  v_mov_b64 v[92:93], 0
  v_mov_b64 v[94:95], 0
  v_lshlrev_b32 v73, 4, v64
  s_lshl_b32 s20, s17, 8
  s_add_u32 s20, s20, 83886080
  s_cmp_eq_u32 s16, 0
  s_cselect_b64 exec, 0xffff, 0
  buffer_store_dwordx4 v[92:95], v73, s[4:7], s20 offen sc1
  s_mov_b64 exec, -1
  s_lshl_b32 s20, s17, 17
  s_add_u32 s20, s20, 0
  s_add_u32 s21, s23, 32768
  s_mov_b32 m0, s21
  s_add_u32 s21, s21, 2048
  buffer_load_dwordx4 v70, s[64:67], s20 offen lds
  s_add_u32 s20, s20, 4096
  s_mov_b32 m0, s21
  s_add_u32 s21, s21, 6144
  buffer_load_dwordx4 v70, s[64:67], s20 offen lds
  s_add_u32 s20, s20, 28672
  s_mov_b32 m0, s21
  s_add_u32 s21, s21, 2048
  buffer_load_dwordx4 v70, s[64:67], s20 offen lds
  s_add_u32 s20, s20, 4096
  s_mov_b32 m0, s21
  s_add_u32 s21, s21, 6144
  buffer_load_dwordx4 v70, s[64:67], s20 offen lds
  s_add_u32 s20, s20, 28672
  s_mov_b32 m0, s21
  s_add_u32 s21, s21, 2048
  buffer_load_dwordx4 v70, s[64:67], s20 offen lds
  s_add_u32 s20, s20, 4096
  s_mov_b32 m0, s21
  s_add_u32 s21, s21, 6144
  buffer_load_dwordx4 v70, s[64:67], s20 offen lds
  s_add_u32 s20, s20, 28672
  s_mov_b32 m0, s21
  s_add_u32 s21, s21, 2048
  buffer_load_dwordx4 v70, s[64:67], s20 offen lds
  s_add_u32 s20, s20, 4096
  s_mov_b32 m0, s21
  s_add_u32 s21, s21, 6144
  buffer_load_dwordx4 v70, s[64:67], s20 offen lds
  s_add_u32 s20, s20, 28672
  v_lshrrev_b32 v81, 3, v65
  v_and_b32 v82, 7, v65
  v_lshrrev_b32 v83, 1, v66
  v_and_b32 v84, 1, v66
  v_lshlrev_b32 v5, 4, v64
  v_lshlrev_b32 v73, 4, v82
  v_lshl_add_u32 v2, v66, 7, v73
  v_lshl_add_u32 v0, v81, 9, v2
  s_lshl_b32 s20, s16, 11
  v_add_u32 v0, s20, v0
  v_cmp_gt_u32 s[48:49], 8, v65
  v_mov_b32 v73, 0xeeeeeeee
  v_mov_b32 v74, 0x44444444
  v_cndmask_b32 v1, v73, v74, s[48:49]
  v_lshl_add_u32 v6, v81, 3, v2
  s_lshl_b32 s20, s16, 9
  v_add_u32 v6, s20, v6
  v_lshl_add_u32 v3, v83, 4, v65
  v_lshlrev_b32 v3, 3, v3
  v_mul_u32_u24 v73, 1088, v84
  v_add_u32 v3, v3, v73
  s_lshl_b32 s20, s16, 8
  v_add_u32 v3, s20, v3
  v_mul_u32_u24 v9, 32768, v83
  v_mul_u32_u24 v73, 16384, v81
  v_add_u32 v9, v73, v9
  v_mul_u32_u24 v73, 8192, v84
  v_add_u32 v9, v73, v9
  v_lshl_add_u32 v9, v82, 3, v9
  s_mul_i32 s20, s16, 65536
  v_add_u32 v9, s20, v9
  s_mul_i32 s3, s17, 8192
  v_lshlrev_b32 v10, 4, v66
  v_lshl_add_u32 v10, v68, 2, v10
  s_lshl_b32 s20, s16, 11
  v_add_u32 v10, s20, v10
  v_lshl_add_u32 v4, v66, 2, v67
  v_lshlrev_b32 v4, 3, v4
  v_mul_u32_u24 v73, 1088, v68
  v_add_u32 v4, v4, v73
  s_lshl_b32 s20, s16, 13
  s_add_u32 s20, s20, 32768
  v_add_u32 v7, s20, v5
  v_mov_b32 v73, 0xf149f2ca
  v_cmp_gt_u32 vcc, 2, v66
  s_nop 1
  v_cndmask_b32 v11, 0, v73, vcc
  v_and_b32 v73, 1, v67
  v_cmp_eq_u32 s[38:39], 1, v73
  v_lshrrev_b32 v73, 1, v67
  v_lshl_add_u32 v73, v68, 1, v73
  v_cmp_eq_u32 s[40:41], 0, v73
  v_cmp_eq_u32 s[42:43], 1, v73
  v_cmp_eq_u32 s[44:45], 2, v73
  v_cmp_eq_u32 s[46:47], 3, v73
  s_add_u32 s34, s16, 1
  s_and_b32 s34, s34, 3
  s_lshl_b32 s34, s34, 9
  s_add_u32 s35, s16, 2
  s_and_b32 s35, s35, 3
  s_lshl_b32 s35, s35, 9
  s_add_u32 s36, s16, 3
  s_and_b32 s36, s36, 3
  s_lshl_b32 s36, s36, 9
  s_mov_b32 s50, 0x3e0293ee
  s_lshl_b32 s51, s17, 6
  s_lshl_b32 s37, s17, 6
  v_and_b32 v73, 1, v67
  v_lshl_add_u32 v75, v84, 1, v73
  v_lshrrev_b32 v80, 1, v67
  v_lshlrev_b32 v71, 5, v80
  v_lshl_add_u32 v71, v68, 3, v71
  v_xor_b32 v75, s16, v75
  v_lshl_add_u32 v71, v75, 6, v71
  v_lshl_add_u32 v72, v73, 10, v71
  v_lshl_add_u32 v71, v73, 8, v71
  v_lshl_add_u32 v71, v66, 10, v71
  v_lshl_add_u32 v72, v84, 12, v72
  v_lshl_add_u32 v72, v83, 11, v72
  s_lshl_b32 s20, s16, 13
  v_add_u32 v72, s20, v72
  v_mov_b32 v74, 1
  s_cmp_eq_u32 s16, 0
  s_cselect_b64 exec, 1, 0
  s_waitcnt vmcnt(8)
  buffer_atomic_add v74, off, s[12:15], 0 offset:4
  s_mov_b64 exec, -1
  v_mov_b32 v76, -1
  s_add_u32 s20, s3, 90177536
  v_not_b32 v88, v67
  v_not_b32 v89, v67
  v_not_b32 v90, v67
  v_not_b32 v91, v67
  buffer_store_dwordx4 v[88:91], v0, s[4:7], s20 offen offset:0
  buffer_store_dwordx4 v[88:91], v0, s[4:7], s20 offen offset:1024
  s_add_u32 s20, s37, 84934656
  buffer_store_dword v76, v10, s[4:7], s20 offen
  s_add_u32 s20, s20, 8192
  buffer_store_dword v76, v10, s[4:7], s20 offen
  s_add_u32 s20, s20, 8192
  buffer_store_dword v76, v10, s[4:7], s20 offen
  s_add_u32 s20, s20, 8192
  buffer_store_dword v76, v10, s[4:7], s20 offen
  s_add_u32 s20, s20, 8192
  v_lshl_add_u32 v73, v81, 2, v66
  v_lshlrev_b32 v73, 4, v73
  v_lshl_add_u32 v73, v82, 10, v73
  s_lshl_b32 s20, s16, 8
  buffer_load_dwordx4 v[12:15], v73, s[8:11], s20 offen
  buffer_load_dwordx4 v[16:19], v73, s[8:11], s20 offen offset:128
  s_lshl_b32 s20, s17, 17
  s_add_u32 s20, s20, 2048
  s_add_u32 s21, s23, 65536
  s_mov_b32 m0, s21
  s_add_u32 s21, s21, 2048
  buffer_load_dwordx4 v70, s[64:67], s20 offen lds
  s_add_u32 s20, s20, 4096
  s_mov_b32 m0, s21
  s_add_u32 s21, s21, 6144
  buffer_load_dwordx4 v70, s[64:67], s20 offen lds
  s_add_u32 s20, s20, 28672
  s_mov_b32 m0, s21
  s_add_u32 s21, s21, 2048
  buffer_load_dwordx4 v70, s[64:67], s20 offen lds
  s_add_u32 s20, s20, 4096
  s_mov_b32 m0, s21
  s_add_u32 s21, s21, 6144
  buffer_load_dwordx4 v70, s[64:67], s20 offen lds
  s_add_u32 s20, s20, 28672
  s_mov_b32 m0, s21
  s_add_u32 s21, s21, 2048
  buffer_load_dwordx4 v70, s[64:67], s20 offen lds
  s_add_u32 s20, s20, 4096
  s_mov_b32 m0, s21
  s_add_u32 s21, s21, 6144
  buffer_load_dwordx4 v70, s[64:67], s20 offen lds
  s_add_u32 s20, s20, 28672
  s_mov_b32 m0, s21
  s_add_u32 s21, s21, 2048
  buffer_load_dwordx4 v70, s[64:67], s20 offen lds
  s_add_u32 s20, s20, 4096
  s_mov_b32 m0, s21
  s_add_u32 s21, s21, 6144
  buffer_load_dwordx4 v70, s[64:67], s20 offen lds
  s_add_u32 s20, s20, 28672
  s_lshl_b32 s20, s17, 17
  s_add_u32 s20, s20, 8192
  s_add_u32 s21, s23, 98304
  s_mov_b32 m0, s21
  s_add_u32 s21, s21, 2048
  buffer_load_dwordx4 v70, s[64:67], s20 offen lds
  s_add_u32 s20, s20, 4096
  s_mov_b32 m0, s21
  s_add_u32 s21, s21, 6144
  buffer_load_dwordx4 v70, s[64:67], s20 offen lds
  s_add_u32 s20, s20, 28672
  s_mov_b32 m0, s21
  s_add_u32 s21, s21, 2048
  buffer_load_dwordx4 v70, s[64:67], s20 offen lds
  s_add_u32 s20, s20, 4096
  s_mov_b32 m0, s21
  s_add_u32 s21, s21, 6144
  buffer_load_dwordx4 v70, s[64:67], s20 offen lds
  s_add_u32 s20, s20, 28672
  s_mov_b32 m0, s21
  s_add_u32 s21, s21, 2048
  buffer_load_dwordx4 v70, s[64:67], s20 offen lds
  s_add_u32 s20, s20, 4096
  s_mov_b32 m0, s21
  s_add_u32 s21, s21, 6144
  buffer_load_dwordx4 v70, s[64:67], s20 offen lds
  s_add_u32 s20, s20, 28672
  s_mov_b32 m0, s21
  s_add_u32 s21, s21, 2048
  buffer_load_dwordx4 v70, s[64:67], s20 offen lds
  s_add_u32 s20, s20, 4096
  s_mov_b32 m0, s21
  s_add_u32 s21, s21, 6144
  buffer_load_dwordx4 v70, s[64:67], s20 offen lds
  s_add_u32 s20, s20, 28672
  s_add_u32 s37, s37, 84934656
  s_add_u32 s3, s3, 90177536
  s_add_u32 s51, s51, 90177536
  s_waitcnt vmcnt(16)
  s_barrier
  s_cmp_eq_u32 s16, 0
  s_cbranch_scc0 R_noinit
  v_mov_b32 v73, 8
  v_mov_b32 v74, 1
  s_mov_b64 exec, 1
  buffer_atomic_add v74, v73, s[12:15], 0 offen
  s_mov_b64 exec, -1
            R_noinit:
  v_mul_u32_u24 v73, 4224, v80
  v_xor_b32 v73, v73, v72
  v_add_u32 v73, 32768, v73
  ds_read_b64_tr_b16 v[192:193], v73 offset:0
  ds_read_b64_tr_b16 v[200:201], v73 offset:256
  ds_read_b64_tr_b16 v[208:209], v73 offset:512
  ds_read_b64_tr_b16 v[216:217], v73 offset:768
  v_xor_b32 v73, 8192, v72
  v_add_u32 v73, 32768, v73
  ds_read_b64_tr_b16 v[224:225], v73 offset:0
  ds_read_b64_tr_b16 v[232:233], v73 offset:256
  ds_read_b64_tr_b16 v[240:241], v73 offset:512
  ds_read_b64_tr_b16 v[248:249], v73 offset:768
  s_waitcnt lgkmcnt(0)
  v_xor_b32 v73, 16384, v72
  v_add_u32 v73, 32768, v73
  ds_read_b64_tr_b16 v[32:33], v73 offset:0
  ds_read_b64_tr_b16 v[40:41], v73 offset:256
  ds_read_b64_tr_b16 v[48:49], v73 offset:512
  ds_read_b64_tr_b16 v[56:57], v73 offset:768
  v_xor_b32 v73, 24576, v72
  v_add_u32 v73, 32768, v73
  ds_read_b64_tr_b16 v[96:97], v73 offset:0
  ds_read_b64_tr_b16 v[104:105], v73 offset:256
  ds_read_b64_tr_b16 v[112:113], v73 offset:512
  ds_read_b64_tr_b16 v[120:121], v73 offset:768
  s_waitcnt lgkmcnt(0)
  s_barrier
  s_lshl_b32 s20, s17, 17
  s_add_u32 s20, s20, 10240
  s_add_u32 s21, s23, 131072
  s_mov_b32 m0, s21
  s_add_u32 s21, s21, 2048
  buffer_load_dwordx4 v70, s[64:67], s20 offen lds
  s_add_u32 s20, s20, 4096
  s_mov_b32 m0, s21
  s_add_u32 s21, s21, 6144
  buffer_load_dwordx4 v70, s[64:67], s20 offen lds
  s_add_u32 s20, s20, 28672
  s_mov_b32 m0, s21
  s_add_u32 s21, s21, 2048
  buffer_load_dwordx4 v70, s[64:67], s20 offen lds
  s_add_u32 s20, s20, 4096
  s_mov_b32 m0, s21
  s_add_u32 s21, s21, 6144
  buffer_load_dwordx4 v70, s[64:67], s20 offen lds
  s_add_u32 s20, s20, 28672
  s_mov_b32 m0, s21
  s_add_u32 s21, s21, 2048
  buffer_load_dwordx4 v70, s[64:67], s20 offen lds
  s_add_u32 s20, s20, 4096
  s_mov_b32 m0, s21
  s_add_u32 s21, s21, 6144
  buffer_load_dwordx4 v70, s[64:67], s20 offen lds
  s_add_u32 s20, s20, 28672
  s_mov_b32 m0, s21
  s_add_u32 s21, s21, 2048
  buffer_load_dwordx4 v70, s[64:67], s20 offen lds
  s_add_u32 s20, s20, 4096
  s_mov_b32 m0, s21
  s_add_u32 s21, s21, 6144
  buffer_load_dwordx4 v70, s[64:67], s20 offen lds
  s_add_u32 s20, s20, 28672
  s_waitcnt vmcnt(16)
  s_barrier
  v_mul_u32_u24 v73, 4224, v80
  v_xor_b32 v73, v73, v72
  v_add_u32 v73, 65536, v73
  ds_read_b64_tr_b16 v[194:195], v73 offset:0
  ds_read_b64_tr_b16 v[202:203], v73 offset:256
  ds_read_b64_tr_b16 v[210:211], v73 offset:512
  ds_read_b64_tr_b16 v[218:219], v73 offset:768
  v_xor_b32 v73, 8192, v72
  v_add_u32 v73, 65536, v73
  ds_read_b64_tr_b16 v[226:227], v73 offset:0
  ds_read_b64_tr_b16 v[234:235], v73 offset:256
  ds_read_b64_tr_b16 v[242:243], v73 offset:512
  ds_read_b64_tr_b16 v[250:251], v73 offset:768
  s_waitcnt lgkmcnt(0)
  v_xor_b32 v73, 16384, v72
  v_add_u32 v73, 65536, v73
  ds_read_b64_tr_b16 v[34:35], v73 offset:0
  ds_read_b64_tr_b16 v[42:43], v73 offset:256
  ds_read_b64_tr_b16 v[50:51], v73 offset:512
  ds_read_b64_tr_b16 v[58:59], v73 offset:768
  v_xor_b32 v73, 24576, v72
  v_add_u32 v73, 65536, v73
  ds_read_b64_tr_b16 v[98:99], v73 offset:0
  ds_read_b64_tr_b16 v[106:107], v73 offset:256
  ds_read_b64_tr_b16 v[114:115], v73 offset:512
  ds_read_b64_tr_b16 v[122:123], v73 offset:768
  s_waitcnt lgkmcnt(0)
  s_barrier
  s_lshl_b32 s20, s17, 8
  s_add_u32 s20, s20, 0
  s_lshl_b32 s21, s16, 10
  s_add_u32 s21, s21, 0
  s_mov_b32 m0, s21
  s_add_u32 s21, s21, 4096
  buffer_load_dwordx4 v69, s[52:55], s20 offen lds
  s_add_u32 s20, s20, 262144
  s_mov_b32 m0, s21
  s_add_u32 s21, s21, 4096
  buffer_load_dwordx4 v69, s[52:55], s20 offen lds
  s_add_u32 s20, s20, 786432
  s_mov_b32 m0, s21
  s_add_u32 s21, s21, 4096
  buffer_load_dwordx4 v69, s[52:55], s20 offen lds
  s_add_u32 s20, s20, 262144
  s_mov_b32 m0, s21
  s_add_u32 s21, s21, 4096
  buffer_load_dwordx4 v69, s[52:55], s20 offen lds
  s_add_u32 s20, s20, 786432
  s_mov_b32 m0, s21
  s_add_u32 s21, s21, 4096
  buffer_load_dwordx4 v69, s[52:55], s20 offen lds
  s_add_u32 s20, s20, 262144
  s_mov_b32 m0, s21
  s_add_u32 s21, s21, 4096
  buffer_load_dwordx4 v69, s[52:55], s20 offen lds
  s_add_u32 s20, s20, 786432
  s_mov_b32 m0, s21
  s_add_u32 s21, s21, 4096
  buffer_load_dwordx4 v69, s[52:55], s20 offen lds
  s_add_u32 s20, s20, 262144
  s_mov_b32 m0, s21
  s_add_u32 s21, s21, 4096
  buffer_load_dwordx4 v69, s[52:55], s20 offen lds
  s_add_u32 s20, s20, 786432
  s_waitcnt vmcnt(16)
  s_barrier
  v_mul_u32_u24 v73, 4224, v80
  v_xor_b32 v73, v73, v72
  v_add_u32 v73, 98304, v73
  ds_read_b64_tr_b16 v[196:197], v73 offset:0
  ds_read_b64_tr_b16 v[204:205], v73 offset:256
  ds_read_b64_tr_b16 v[212:213], v73 offset:512
  ds_read_b64_tr_b16 v[220:221], v73 offset:768
  v_xor_b32 v73, 8192, v72
  v_add_u32 v73, 98304, v73
  ds_read_b64_tr_b16 v[228:229], v73 offset:0
  ds_read_b64_tr_b16 v[236:237], v73 offset:256
  ds_read_b64_tr_b16 v[244:245], v73 offset:512
  ds_read_b64_tr_b16 v[252:253], v73 offset:768
  s_waitcnt lgkmcnt(0)
  v_xor_b32 v73, 16384, v72
  v_add_u32 v73, 98304, v73
  ds_read_b64_tr_b16 v[36:37], v73 offset:0
  ds_read_b64_tr_b16 v[44:45], v73 offset:256
  ds_read_b64_tr_b16 v[52:53], v73 offset:512
  ds_read_b64_tr_b16 v[60:61], v73 offset:768
  v_xor_b32 v73, 24576, v72
  v_add_u32 v73, 98304, v73
  ds_read_b64_tr_b16 v[100:101], v73 offset:0
  ds_read_b64_tr_b16 v[108:109], v73 offset:256
  ds_read_b64_tr_b16 v[116:117], v73 offset:512
  ds_read_b64_tr_b16 v[124:125], v73 offset:768
  s_waitcnt lgkmcnt(0)
  s_barrier
  s_lshl_b32 s20, s17, 8
  s_add_u32 s20, s20, 131072
  s_lshl_b32 s21, s16, 10
  s_add_u32 s21, s21, 32768
  s_mov_b32 m0, s21
  s_add_u32 s21, s21, 4096
  buffer_load_dwordx4 v69, s[52:55], s20 offen lds
  s_add_u32 s20, s20, 262144
  s_mov_b32 m0, s21
  s_add_u32 s21, s21, 4096
  buffer_load_dwordx4 v69, s[52:55], s20 offen lds
  s_add_u32 s20, s20, 786432
  s_mov_b32 m0, s21
  s_add_u32 s21, s21, 4096
  buffer_load_dwordx4 v69, s[52:55], s20 offen lds
  s_add_u32 s20, s20, 262144
  s_mov_b32 m0, s21
  s_add_u32 s21, s21, 4096
  buffer_load_dwordx4 v69, s[52:55], s20 offen lds
  s_add_u32 s20, s20, 786432
  s_mov_b32 m0, s21
  s_add_u32 s21, s21, 4096
  buffer_load_dwordx4 v69, s[52:55], s20 offen lds
  s_add_u32 s20, s20, 262144
  s_mov_b32 m0, s21
  s_add_u32 s21, s21, 4096
  buffer_load_dwordx4 v69, s[52:55], s20 offen lds
  s_add_u32 s20, s20, 786432
  s_mov_b32 m0, s21
  s_add_u32 s21, s21, 4096
  buffer_load_dwordx4 v69, s[52:55], s20 offen lds
  s_add_u32 s20, s20, 262144
  s_mov_b32 m0, s21
  s_add_u32 s21, s21, 4096
  buffer_load_dwordx4 v69, s[52:55], s20 offen lds
  s_add_u32 s20, s20, 786432
  s_waitcnt vmcnt(16)
  s_barrier
  v_mul_u32_u24 v73, 4224, v80
  v_xor_b32 v73, v73, v72
  v_add_u32 v73, 131072, v73
  ds_read_b64_tr_b16 v[198:199], v73 offset:0
  ds_read_b64_tr_b16 v[206:207], v73 offset:256
  ds_read_b64_tr_b16 v[214:215], v73 offset:512
  ds_read_b64_tr_b16 v[222:223], v73 offset:768
  v_xor_b32 v73, 8192, v72
  v_add_u32 v73, 131072, v73
  ds_read_b64_tr_b16 v[230:231], v73 offset:0
  ds_read_b64_tr_b16 v[238:239], v73 offset:256
  ds_read_b64_tr_b16 v[246:247], v73 offset:512
  ds_read_b64_tr_b16 v[254:255], v73 offset:768
  s_waitcnt lgkmcnt(0)
  v_xor_b32 v73, 16384, v72
  v_add_u32 v73, 131072, v73
  ds_read_b64_tr_b16 v[38:39], v73 offset:0
  ds_read_b64_tr_b16 v[46:47], v73 offset:256
  ds_read_b64_tr_b16 v[54:55], v73 offset:512
  ds_read_b64_tr_b16 v[62:63], v73 offset:768
  v_xor_b32 v73, 24576, v72
  v_add_u32 v73, 131072, v73
  ds_read_b64_tr_b16 v[102:103], v73 offset:0
  ds_read_b64_tr_b16 v[110:111], v73 offset:256
  ds_read_b64_tr_b16 v[118:119], v73 offset:512
  ds_read_b64_tr_b16 v[126:127], v73 offset:768
  s_waitcnt lgkmcnt(0)
  s_barrier
  s_lshl_b32 s20, s17, 8
  s_add_u32 s20, s20, 524288
  s_lshl_b32 s21, s16, 10
  s_add_u32 s21, s21, 65536
  s_mov_b32 m0, s21
  s_add_u32 s21, s21, 4096
  buffer_load_dwordx4 v69, s[52:55], s20 offen lds
  s_add_u32 s20, s20, 262144
  s_mov_b32 m0, s21
  s_add_u32 s21, s21, 4096
  buffer_load_dwordx4 v69, s[52:55], s20 offen lds
  s_add_u32 s20, s20, 786432
  s_mov_b32 m0, s21
  s_add_u32 s21, s21, 4096
  buffer_load_dwordx4 v69, s[52:55], s20 offen lds
  s_add_u32 s20, s20, 262144
  s_mov_b32 m0, s21
  s_add_u32 s21, s21, 4096
  buffer_load_dwordx4 v69, s[52:55], s20 offen lds
  s_add_u32 s20, s20, 786432
  s_mov_b32 m0, s21
  s_add_u32 s21, s21, 4096
  buffer_load_dwordx4 v69, s[52:55], s20 offen lds
  s_add_u32 s20, s20, 262144
  s_mov_b32 m0, s21
  s_add_u32 s21, s21, 4096
  buffer_load_dwordx4 v69, s[52:55], s20 offen lds
  s_add_u32 s20, s20, 786432
  s_mov_b32 m0, s21
  s_add_u32 s21, s21, 4096
  buffer_load_dwordx4 v69, s[52:55], s20 offen lds
  s_add_u32 s20, s20, 262144
  s_mov_b32 m0, s21
  s_add_u32 s21, s21, 4096
  buffer_load_dwordx4 v69, s[52:55], s20 offen lds
  s_add_u32 s20, s20, 786432
  v_add_u32 v73, 65536, v7
  ds_write_b128 v73, v[32:35] offset:0
  ds_write_b128 v73, v[36:39] offset:1024
  ds_write_b128 v73, v[40:43] offset:2048
  ds_write_b128 v73, v[44:47] offset:3072
  ds_write_b128 v73, v[48:51] offset:4096
  ds_write_b128 v73, v[52:55] offset:5120
  ds_write_b128 v73, v[56:59] offset:6144
  ds_write_b128 v73, v[60:63] offset:7168
  s_waitcnt lgkmcnt(0)
  v_add_u32 v73, 98304, v7
  ds_write_b128 v73, v[96:99] offset:0
  ds_write_b128 v73, v[100:103] offset:1024
  ds_write_b128 v73, v[104:107] offset:2048
  ds_write_b128 v73, v[108:111] offset:3072
  ds_write_b128 v73, v[112:115] offset:4096
  ds_write_b128 v73, v[116:119] offset:5120
  ds_write_b128 v73, v[120:123] offset:6144
  ds_write_b128 v73, v[124:127] offset:7168
  s_waitcnt lgkmcnt(0)
  s_waitcnt vmcnt(16)
  s_barrier
  s_lshl_b32 s20, s16, 13
  s_add_u32 s20, s20, 0
  v_add_u32 v73, s20, v71
  v_lshl_add_u32 v73, v80, 12, v73
  v_xor_b32 v74, 4096, v73
  ds_read_b64_tr_b16 v[32:33], v73 offset:0
  ds_read_b64_tr_b16 v[34:35], v73 offset:512
  ds_read_b64_tr_b16 v[40:41], v74 offset:0
  ds_read_b64_tr_b16 v[42:43], v74 offset:512
  s_lshl_b32 s20, s34, 4
  s_add_u32 s20, s20, 0
  v_add_u32 v73, s20, v71
  ds_read_b64_tr_b16 a[0:1], v73 offset:0
  ds_read_b64_tr_b16 a[2:3], v73 offset:512
  ds_read_b64_tr_b16 a[8:9], v73 offset:4096
  ds_read_b64_tr_b16 a[10:11], v73 offset:4608
  s_waitcnt lgkmcnt(0)
  s_lshl_b32 s20, s35, 4
  s_add_u32 s20, s20, 0
  v_add_u32 v73, s20, v71
  ds_read_b64_tr_b16 a[32:33], v73 offset:0
  ds_read_b64_tr_b16 a[34:35], v73 offset:512
  ds_read_b64_tr_b16 a[40:41], v73 offset:4096
  ds_read_b64_tr_b16 a[42:43], v73 offset:4608
  s_lshl_b32 s20, s36, 4
  s_add_u32 s20, s20, 0
  v_add_u32 v73, s20, v71
  ds_read_b64_tr_b16 a[64:65], v73 offset:0
  ds_read_b64_tr_b16 a[66:67], v73 offset:512
  ds_read_b64_tr_b16 a[72:73], v73 offset:4096
  ds_read_b64_tr_b16 a[74:75], v73 offset:4608
  s_waitcnt lgkmcnt(0)
  s_barrier
  s_lshl_b32 s20, s17, 8
  s_add_u32 s20, s20, 655360
  s_lshl_b32 s21, s16, 10
  s_add_u32 s21, s21, 0
  s_mov_b32 m0, s21
  s_add_u32 s21, s21, 4096
  buffer_load_dwordx4 v69, s[52:55], s20 offen lds
  s_add_u32 s20, s20, 262144
  s_mov_b32 m0, s21
  s_add_u32 s21, s21, 4096
  buffer_load_dwordx4 v69, s[52:55], s20 offen lds
  s_add_u32 s20, s20, 786432
  s_mov_b32 m0, s21
  s_add_u32 s21, s21, 4096
  buffer_load_dwordx4 v69, s[52:55], s20 offen lds
  s_add_u32 s20, s20, 262144
  s_mov_b32 m0, s21
  s_add_u32 s21, s21, 4096
  buffer_load_dwordx4 v69, s[52:55], s20 offen lds
  s_add_u32 s20, s20, 786432
  s_mov_b32 m0, s21
  s_add_u32 s21, s21, 4096
  buffer_load_dwordx4 v69, s[52:55], s20 offen lds
  s_add_u32 s20, s20, 262144
  s_mov_b32 m0, s21
  s_add_u32 s21, s21, 4096
  buffer_load_dwordx4 v69, s[52:55], s20 offen lds
  s_add_u32 s20, s20, 786432
  s_mov_b32 m0, s21
  s_add_u32 s21, s21, 4096
  buffer_load_dwordx4 v69, s[52:55], s20 offen lds
  s_add_u32 s20, s20, 262144
  s_mov_b32 m0, s21
  s_add_u32 s21, s21, 4096
  buffer_load_dwordx4 v69, s[52:55], s20 offen lds
  s_add_u32 s20, s20, 786432
  s_waitcnt vmcnt(16)
  s_barrier
  s_lshl_b32 s20, s16, 13
  s_add_u32 s20, s20, 32768
  v_add_u32 v73, s20, v71
  v_lshl_add_u32 v73, v80, 12, v73
  v_xor_b32 v74, 4096, v73
  ds_read_b64_tr_b16 v[36:37], v73 offset:0
  ds_read_b64_tr_b16 v[38:39], v73 offset:512
  ds_read_b64_tr_b16 v[44:45], v74 offset:0
  ds_read_b64_tr_b16 v[46:47], v74 offset:512
  s_lshl_b32 s20, s34, 4
  s_add_u32 s20, s20, 32768
  v_add_u32 v73, s20, v71
  ds_read_b64_tr_b16 a[4:5], v73 offset:0
  ds_read_b64_tr_b16 a[6:7], v73 offset:512
  ds_read_b64_tr_b16 a[12:13], v73 offset:4096
  ds_read_b64_tr_b16 a[14:15], v73 offset:4608
  s_waitcnt lgkmcnt(0)
  s_lshl_b32 s20, s35, 4
  s_add_u32 s20, s20, 32768
  v_add_u32 v73, s20, v71
  ds_read_b64_tr_b16 a[36:37], v73 offset:0
  ds_read_b64_tr_b16 a[38:39], v73 offset:512
  ds_read_b64_tr_b16 a[44:45], v73 offset:4096
  ds_read_b64_tr_b16 a[46:47], v73 offset:4608
  s_lshl_b32 s20, s36, 4
  s_add_u32 s20, s20, 32768
  v_add_u32 v73, s20, v71
  ds_read_b64_tr_b16 a[68:69], v73 offset:0
  ds_read_b64_tr_b16 a[70:71], v73 offset:512
  ds_read_b64_tr_b16 a[76:77], v73 offset:4096
  ds_read_b64_tr_b16 a[78:79], v73 offset:4608
  s_waitcnt lgkmcnt(0)
  s_barrier
  s_lshl_b32 s20, s17, 8
  s_add_u32 s20, s20, 0
  s_lshl_b32 s21, s16, 10
  s_add_u32 s21, s21, 32768
  s_mov_b32 m0, s21
  s_add_u32 s21, s21, 4096
  buffer_load_dwordx4 v69, s[56:59], s20 offen lds
  s_add_u32 s20, s20, 262144
  s_mov_b32 m0, s21
  s_add_u32 s21, s21, 4096
  buffer_load_dwordx4 v69, s[56:59], s20 offen lds
  s_add_u32 s20, s20, 786432
  s_mov_b32 m0, s21
  s_add_u32 s21, s21, 4096
  buffer_load_dwordx4 v69, s[56:59], s20 offen lds
  s_add_u32 s20, s20, 262144
  s_mov_b32 m0, s21
  s_add_u32 s21, s21, 4096
  buffer_load_dwordx4 v69, s[56:59], s20 offen lds
  s_add_u32 s20, s20, 786432
  s_mov_b32 m0, s21
  s_add_u32 s21, s21, 4096
  buffer_load_dwordx4 v69, s[56:59], s20 offen lds
  s_add_u32 s20, s20, 262144
  s_mov_b32 m0, s21
  s_add_u32 s21, s21, 4096
  buffer_load_dwordx4 v69, s[56:59], s20 offen lds
  s_add_u32 s20, s20, 786432
  s_mov_b32 m0, s21
  s_add_u32 s21, s21, 4096
  buffer_load_dwordx4 v69, s[56:59], s20 offen lds
  s_add_u32 s20, s20, 262144
  s_mov_b32 m0, s21
  s_add_u32 s21, s21, 4096
  buffer_load_dwordx4 v69, s[56:59], s20 offen lds
  s_add_u32 s20, s20, 786432
  s_waitcnt vmcnt(16)
  s_barrier
  s_lshl_b32 s20, s16, 13
  s_add_u32 s20, s20, 65536
  v_add_u32 v73, s20, v71
  v_lshl_add_u32 v73, v80, 12, v73
  v_xor_b32 v74, 4096, v73
  ds_read_b64_tr_b16 v[48:49], v73 offset:0
  ds_read_b64_tr_b16 v[50:51], v73 offset:512
  ds_read_b64_tr_b16 v[56:57], v74 offset:0
  ds_read_b64_tr_b16 v[58:59], v74 offset:512
  s_lshl_b32 s20, s34, 4
  s_add_u32 s20, s20, 65536
  v_add_u32 v73, s20, v71
  ds_read_b64_tr_b16 a[16:17], v73 offset:0
  ds_read_b64_tr_b16 a[18:19], v73 offset:512
  ds_read_b64_tr_b16 a[24:25], v73 offset:4096
  ds_read_b64_tr_b16 a[26:27], v73 offset:4608
  s_waitcnt lgkmcnt(0)
  s_lshl_b32 s20, s35, 4
  s_add_u32 s20, s20, 65536
  v_add_u32 v73, s20, v71
  ds_read_b64_tr_b16 a[48:49], v73 offset:0
  ds_read_b64_tr_b16 a[50:51], v73 offset:512
  ds_read_b64_tr_b16 a[56:57], v73 offset:4096
  ds_read_b64_tr_b16 a[58:59], v73 offset:4608
  s_lshl_b32 s20, s36, 4
  s_add_u32 s20, s20, 65536
  v_add_u32 v73, s20, v71
  ds_read_b64_tr_b16 a[80:81], v73 offset:0
  ds_read_b64_tr_b16 a[82:83], v73 offset:512
  ds_read_b64_tr_b16 a[88:89], v73 offset:4096
  ds_read_b64_tr_b16 a[90:91], v73 offset:4608
  s_waitcnt lgkmcnt(0)
  s_barrier
  s_lshl_b32 s20, s17, 8
  s_add_u32 s20, s20, 131072
  s_lshl_b32 s21, s16, 10
  s_add_u32 s21, s21, 65536
  s_mov_b32 m0, s21
  s_add_u32 s21, s21, 4096
  buffer_load_dwordx4 v69, s[56:59], s20 offen lds
  s_add_u32 s20, s20, 262144
  s_mov_b32 m0, s21
  s_add_u32 s21, s21, 4096
  buffer_load_dwordx4 v69, s[56:59], s20 offen lds
  s_add_u32 s20, s20, 786432
  s_mov_b32 m0, s21
  s_add_u32 s21, s21, 4096
  buffer_load_dwordx4 v69, s[56:59], s20 offen lds
  s_add_u32 s20, s20, 262144
  s_mov_b32 m0, s21
  s_add_u32 s21, s21, 4096
  buffer_load_dwordx4 v69, s[56:59], s20 offen lds
  s_add_u32 s20, s20, 786432
  s_mov_b32 m0, s21
  s_add_u32 s21, s21, 4096
  buffer_load_dwordx4 v69, s[56:59], s20 offen lds
  s_add_u32 s20, s20, 262144
  s_mov_b32 m0, s21
  s_add_u32 s21, s21, 4096
  buffer_load_dwordx4 v69, s[56:59], s20 offen lds
  s_add_u32 s20, s20, 786432
  s_mov_b32 m0, s21
  s_add_u32 s21, s21, 4096
  buffer_load_dwordx4 v69, s[56:59], s20 offen lds
  s_add_u32 s20, s20, 262144
  s_mov_b32 m0, s21
  s_add_u32 s21, s21, 4096
  buffer_load_dwordx4 v69, s[56:59], s20 offen lds
  s_add_u32 s20, s20, 786432
  s_waitcnt vmcnt(16)
  s_barrier
  s_lshl_b32 s20, s16, 13
  s_add_u32 s20, s20, 0
  v_add_u32 v73, s20, v71
  v_lshl_add_u32 v73, v80, 12, v73
  v_xor_b32 v74, 4096, v73
  ds_read_b64_tr_b16 v[52:53], v73 offset:0
  ds_read_b64_tr_b16 v[54:55], v73 offset:512
  ds_read_b64_tr_b16 v[60:61], v74 offset:0
  ds_read_b64_tr_b16 v[62:63], v74 offset:512
  s_lshl_b32 s20, s34, 4
  s_add_u32 s20, s20, 0
  v_add_u32 v73, s20, v71
  ds_read_b64_tr_b16 a[20:21], v73 offset:0
  ds_read_b64_tr_b16 a[22:23], v73 offset:512
  ds_read_b64_tr_b16 a[28:29], v73 offset:4096
  ds_read_b64_tr_b16 a[30:31], v73 offset:4608
  s_waitcnt lgkmcnt(0)
  s_lshl_b32 s20, s35, 4
  s_add_u32 s20, s20, 0
  v_add_u32 v73, s20, v71
  ds_read_b64_tr_b16 a[52:53], v73 offset:0
  ds_read_b64_tr_b16 a[54:55], v73 offset:512
  ds_read_b64_tr_b16 a[60:61], v73 offset:4096
  ds_read_b64_tr_b16 a[62:63], v73 offset:4608
  s_lshl_b32 s20, s36, 4
  s_add_u32 s20, s20, 0
  v_add_u32 v73, s20, v71
  ds_read_b64_tr_b16 a[84:85], v73 offset:0
  ds_read_b64_tr_b16 a[86:87], v73 offset:512
  ds_read_b64_tr_b16 a[92:93], v73 offset:4096
  ds_read_b64_tr_b16 a[94:95], v73 offset:4608
  s_waitcnt lgkmcnt(0)
  s_barrier
  s_lshl_b32 s20, s17, 8
  s_add_u32 s20, s20, 524288
  s_lshl_b32 s21, s16, 10
  s_add_u32 s21, s21, 0
  s_mov_b32 m0, s21
  s_add_u32 s21, s21, 4096
  buffer_load_dwordx4 v69, s[56:59], s20 offen lds
  s_add_u32 s20, s20, 262144
  s_mov_b32 m0, s21
  s_add_u32 s21, s21, 4096
  buffer_load_dwordx4 v69, s[56:59], s20 offen lds
  s_add_u32 s20, s20, 786432
  s_mov_b32 m0, s21
  s_add_u32 s21, s21, 4096
  buffer_load_dwordx4 v69, s[56:59], s20 offen lds
  s_add_u32 s20, s20, 262144
  s_mov_b32 m0, s21
  s_add_u32 s21, s21, 4096
  buffer_load_dwordx4 v69, s[56:59], s20 offen lds
  s_add_u32 s20, s20, 786432
  s_mov_b32 m0, s21
  s_add_u32 s21, s21, 4096
  buffer_load_dwordx4 v69, s[56:59], s20 offen lds
  s_add_u32 s20, s20, 262144
  s_mov_b32 m0, s21
  s_add_u32 s21, s21, 4096
  buffer_load_dwordx4 v69, s[56:59], s20 offen lds
  s_add_u32 s20, s20, 786432
  s_mov_b32 m0, s21
  s_add_u32 s21, s21, 4096
  buffer_load_dwordx4 v69, s[56:59], s20 offen lds
  s_add_u32 s20, s20, 262144
  s_mov_b32 m0, s21
  s_add_u32 s21, s21, 4096
  buffer_load_dwordx4 v69, s[56:59], s20 offen lds
  s_add_u32 s20, s20, 786432
  s_waitcnt vmcnt(16)
  s_barrier
  s_lshl_b32 s20, s16, 13
  s_add_u32 s20, s20, 32768
  v_add_u32 v73, s20, v71
  v_lshl_add_u32 v73, v80, 12, v73
  v_xor_b32 v74, 4096, v73
  ds_read_b64_tr_b16 a[96:97], v73 offset:0
  ds_read_b64_tr_b16 a[98:99], v73 offset:512
  ds_read_b64_tr_b16 a[104:105], v74 offset:0
  ds_read_b64_tr_b16 a[106:107], v74 offset:512
  s_lshl_b32 s20, s34, 4
  s_add_u32 s20, s20, 32768
  v_add_u32 v73, s20, v71
  ds_read_b64_tr_b16 a[128:129], v73 offset:0
  ds_read_b64_tr_b16 a[130:131], v73 offset:512
  ds_read_b64_tr_b16 a[136:137], v73 offset:4096
  ds_read_b64_tr_b16 a[138:139], v73 offset:4608
  s_waitcnt lgkmcnt(0)
  s_lshl_b32 s20, s35, 4
  s_add_u32 s20, s20, 32768
  v_add_u32 v73, s20, v71
  ds_read_b64_tr_b16 a[160:161], v73 offset:0
  ds_read_b64_tr_b16 a[162:163], v73 offset:512
  ds_read_b64_tr_b16 a[168:169], v73 offset:4096
  ds_read_b64_tr_b16 a[170:171], v73 offset:4608
  s_lshl_b32 s20, s36, 4
  s_add_u32 s20, s20, 32768
  v_add_u32 v73, s20, v71
  ds_read_b64_tr_b16 v[96:97], v73 offset:0
  ds_read_b64_tr_b16 v[98:99], v73 offset:512
  ds_read_b64_tr_b16 v[104:105], v73 offset:4096
  ds_read_b64_tr_b16 v[106:107], v73 offset:4608
  s_waitcnt lgkmcnt(0)
  s_barrier
  s_lshl_b32 s20, s17, 8
  s_add_u32 s20, s20, 655360
  s_lshl_b32 s21, s16, 10
  s_add_u32 s21, s21, 32768
  s_mov_b32 m0, s21
  s_add_u32 s21, s21, 4096
  buffer_load_dwordx4 v69, s[56:59], s20 offen lds
  s_add_u32 s20, s20, 262144
  s_mov_b32 m0, s21
  s_add_u32 s21, s21, 4096
  buffer_load_dwordx4 v69, s[56:59], s20 offen lds
  s_add_u32 s20, s20, 786432
  s_mov_b32 m0, s21
  s_add_u32 s21, s21, 4096
  buffer_load_dwordx4 v69, s[56:59], s20 offen lds
  s_add_u32 s20, s20, 262144
  s_mov_b32 m0, s21
  s_add_u32 s21, s21, 4096
  buffer_load_dwordx4 v69, s[56:59], s20 offen lds
  s_add_u32 s20, s20, 786432
  s_mov_b32 m0, s21
  s_add_u32 s21, s21, 4096
  buffer_load_dwordx4 v69, s[56:59], s20 offen lds
  s_add_u32 s20, s20, 262144
  s_mov_b32 m0, s21
  s_add_u32 s21, s21, 4096
  buffer_load_dwordx4 v69, s[56:59], s20 offen lds
  s_add_u32 s20, s20, 786432
  s_mov_b32 m0, s21
  s_add_u32 s21, s21, 4096
  buffer_load_dwordx4 v69, s[56:59], s20 offen lds
  s_add_u32 s20, s20, 262144
  s_mov_b32 m0, s21
  s_add_u32 s21, s21, 4096
  buffer_load_dwordx4 v69, s[56:59], s20 offen lds
  s_add_u32 s20, s20, 786432
  s_waitcnt vmcnt(16)
  s_barrier
  s_lshl_b32 s20, s16, 13
  s_add_u32 s20, s20, 65536
  v_add_u32 v73, s20, v71
  v_lshl_add_u32 v73, v80, 12, v73
  v_xor_b32 v74, 4096, v73
  ds_read_b64_tr_b16 a[100:101], v73 offset:0
  ds_read_b64_tr_b16 a[102:103], v73 offset:512
  ds_read_b64_tr_b16 a[108:109], v74 offset:0
  ds_read_b64_tr_b16 a[110:111], v74 offset:512
  s_lshl_b32 s20, s34, 4
  s_add_u32 s20, s20, 65536
  v_add_u32 v73, s20, v71
  ds_read_b64_tr_b16 a[132:133], v73 offset:0
  ds_read_b64_tr_b16 a[134:135], v73 offset:512
  ds_read_b64_tr_b16 a[140:141], v73 offset:4096
  ds_read_b64_tr_b16 a[142:143], v73 offset:4608
  s_waitcnt lgkmcnt(0)
  s_lshl_b32 s20, s35, 4
  s_add_u32 s20, s20, 65536
  v_add_u32 v73, s20, v71
  ds_read_b64_tr_b16 a[164:165], v73 offset:0
  ds_read_b64_tr_b16 a[166:167], v73 offset:512
  ds_read_b64_tr_b16 a[172:173], v73 offset:4096
  ds_read_b64_tr_b16 a[174:175], v73 offset:4608
  s_lshl_b32 s20, s36, 4
  s_add_u32 s20, s20, 65536
  v_add_u32 v73, s20, v71
  ds_read_b64_tr_b16 v[100:101], v73 offset:0
  ds_read_b64_tr_b16 v[102:103], v73 offset:512
  ds_read_b64_tr_b16 v[108:109], v73 offset:4096
  ds_read_b64_tr_b16 v[110:111], v73 offset:4608
  s_waitcnt lgkmcnt(0)
  s_barrier
  v_mov_b32 v20, 8
  v_mov_b32 v21, 32
  buffer_load_dword v22, v20, s[12:15], 0 offen sc1
  s_lshl_b32 s20, s17, 8
  s_add_u32 s20, s20, 0
  s_lshl_b32 s21, s16, 10
  s_add_u32 s21, s21, 65536
  s_mov_b32 m0, s21
  s_add_u32 s21, s21, 4096
  buffer_load_dwordx4 v69, s[60:63], s20 offen lds
  s_add_u32 s20, s20, 262144
  s_mov_b32 m0, s21
  s_add_u32 s21, s21, 4096
  buffer_load_dwordx4 v69, s[60:63], s20 offen lds
  s_add_u32 s20, s20, 786432
  s_mov_b32 m0, s21
  s_add_u32 s21, s21, 4096
  buffer_load_dwordx4 v69, s[60:63], s20 offen lds
  s_add_u32 s20, s20, 262144
  s_mov_b32 m0, s21
  s_add_u32 s21, s21, 4096
  buffer_load_dwordx4 v69, s[60:63], s20 offen lds
  s_add_u32 s20, s20, 786432
  s_mov_b32 m0, s21
  s_add_u32 s21, s21, 4096
  buffer_load_dwordx4 v69, s[60:63], s20 offen lds
  s_add_u32 s20, s20, 262144
  s_mov_b32 m0, s21
  s_add_u32 s21, s21, 4096
  buffer_load_dwordx4 v69, s[60:63], s20 offen lds
  s_add_u32 s20, s20, 786432
  s_mov_b32 m0, s21
  s_add_u32 s21, s21, 4096
  buffer_load_dwordx4 v69, s[60:63], s20 offen lds
  s_add_u32 s20, s20, 262144
  s_mov_b32 m0, s21
  s_add_u32 s21, s21, 4096
  buffer_load_dwordx4 v69, s[60:63], s20 offen lds
  s_add_u32 s20, s20, 786432
  s_waitcnt vmcnt(16)
  s_barrier
  s_lshl_b32 s20, s16, 13
  s_add_u32 s20, s20, 0
  v_add_u32 v73, s20, v71
  v_lshl_add_u32 v73, v80, 12, v73
  v_xor_b32 v74, 4096, v73
  ds_read_b64_tr_b16 a[112:113], v73 offset:0
  ds_read_b64_tr_b16 a[114:115], v73 offset:512
  ds_read_b64_tr_b16 a[120:121], v74 offset:0
  ds_read_b64_tr_b16 a[122:123], v74 offset:512
  s_lshl_b32 s20, s34, 4
  s_add_u32 s20, s20, 0
  v_add_u32 v73, s20, v71
  ds_read_b64_tr_b16 a[144:145], v73 offset:0
  ds_read_b64_tr_b16 a[146:147], v73 offset:512
  ds_read_b64_tr_b16 a[152:153], v73 offset:4096
  ds_read_b64_tr_b16 a[154:155], v73 offset:4608
  s_waitcnt lgkmcnt(0)
  s_lshl_b32 s20, s35, 4
  s_add_u32 s20, s20, 0
  v_add_u32 v73, s20, v71
  ds_read_b64_tr_b16 a[176:177], v73 offset:0
  ds_read_b64_tr_b16 a[178:179], v73 offset:512
  ds_read_b64_tr_b16 a[184:185], v73 offset:4096
  ds_read_b64_tr_b16 a[186:187], v73 offset:4608
  s_lshl_b32 s20, s36, 4
  s_add_u32 s20, s20, 0
  v_add_u32 v73, s20, v71
  ds_read_b64_tr_b16 v[112:113], v73 offset:0
  ds_read_b64_tr_b16 v[114:115], v73 offset:512
  ds_read_b64_tr_b16 v[120:121], v73 offset:4096
  ds_read_b64_tr_b16 v[122:123], v73 offset:4608
  s_waitcnt lgkmcnt(0)
  s_barrier
  s_lshl_b32 s20, s17, 8
  s_add_u32 s20, s20, 131072
  s_lshl_b32 s21, s16, 10
  s_add_u32 s21, s21, 0
  s_mov_b32 m0, s21
  s_add_u32 s21, s21, 4096
  buffer_load_dwordx4 v69, s[60:63], s20 offen lds
  s_add_u32 s20, s20, 262144
  s_mov_b32 m0, s21
  s_add_u32 s21, s21, 4096
  buffer_load_dwordx4 v69, s[60:63], s20 offen lds
  s_add_u32 s20, s20, 786432
  s_mov_b32 m0, s21
  s_add_u32 s21, s21, 4096
  buffer_load_dwordx4 v69, s[60:63], s20 offen lds
  s_add_u32 s20, s20, 262144
  s_mov_b32 m0, s21
  s_add_u32 s21, s21, 4096
  buffer_load_dwordx4 v69, s[60:63], s20 offen lds
  s_add_u32 s20, s20, 786432
  s_mov_b32 m0, s21
  s_add_u32 s21, s21, 4096
  buffer_load_dwordx4 v69, s[60:63], s20 offen lds
  s_add_u32 s20, s20, 262144
  s_mov_b32 m0, s21
  s_add_u32 s21, s21, 4096
  buffer_load_dwordx4 v69, s[60:63], s20 offen lds
  s_add_u32 s20, s20, 786432
  s_mov_b32 m0, s21
  s_add_u32 s21, s21, 4096
  buffer_load_dwordx4 v69, s[60:63], s20 offen lds
  s_add_u32 s20, s20, 262144
  s_mov_b32 m0, s21
  s_add_u32 s21, s21, 4096
  buffer_load_dwordx4 v69, s[60:63], s20 offen lds
  s_add_u32 s20, s20, 786432
  s_waitcnt vmcnt(16)
  s_barrier
  s_lshl_b32 s20, s16, 13
  s_add_u32 s20, s20, 32768
  v_add_u32 v73, s20, v71
  v_lshl_add_u32 v73, v80, 12, v73
  v_xor_b32 v74, 4096, v73
  ds_read_b64_tr_b16 a[116:117], v73 offset:0
  ds_read_b64_tr_b16 a[118:119], v73 offset:512
  ds_read_b64_tr_b16 a[124:125], v74 offset:0
  ds_read_b64_tr_b16 a[126:127], v74 offset:512
  s_lshl_b32 s20, s34, 4
  s_add_u32 s20, s20, 32768
  v_add_u32 v73, s20, v71
  ds_read_b64_tr_b16 a[148:149], v73 offset:0
  ds_read_b64_tr_b16 a[150:151], v73 offset:512
  ds_read_b64_tr_b16 a[156:157], v73 offset:4096
  ds_read_b64_tr_b16 a[158:159], v73 offset:4608
  s_waitcnt lgkmcnt(0)
  s_lshl_b32 s20, s35, 4
  s_add_u32 s20, s20, 32768
  v_add_u32 v73, s20, v71
  ds_read_b64_tr_b16 a[180:181], v73 offset:0
  ds_read_b64_tr_b16 a[182:183], v73 offset:512
  ds_read_b64_tr_b16 a[188:189], v73 offset:4096
  ds_read_b64_tr_b16 a[190:191], v73 offset:4608
  s_lshl_b32 s20, s36, 4
  s_add_u32 s20, s20, 32768
  v_add_u32 v73, s20, v71
  ds_read_b64_tr_b16 v[116:117], v73 offset:0
  ds_read_b64_tr_b16 v[118:119], v73 offset:512
  ds_read_b64_tr_b16 v[124:125], v73 offset:4096
  ds_read_b64_tr_b16 v[126:127], v73 offset:4608
  s_waitcnt lgkmcnt(0)
  s_barrier
  s_lshl_b32 s20, s17, 8
  s_add_u32 s20, s20, 524288
  s_lshl_b32 s21, s16, 10
  s_add_u32 s21, s21, 32768
  s_mov_b32 m0, s21
  s_add_u32 s21, s21, 4096
  buffer_load_dwordx4 v69, s[60:63], s20 offen lds
  s_add_u32 s20, s20, 262144
  s_mov_b32 m0, s21
  s_add_u32 s21, s21, 4096
  buffer_load_dwordx4 v69, s[60:63], s20 offen lds
  s_add_u32 s20, s20, 786432
  s_mov_b32 m0, s21
  s_add_u32 s21, s21, 4096
  buffer_load_dwordx4 v69, s[60:63], s20 offen lds
  s_add_u32 s20, s20, 262144
  s_mov_b32 m0, s21
  s_add_u32 s21, s21, 4096
  buffer_load_dwordx4 v69, s[60:63], s20 offen lds
  s_add_u32 s20, s20, 786432
  s_mov_b32 m0, s21
  s_add_u32 s21, s21, 4096
  buffer_load_dwordx4 v69, s[60:63], s20 offen lds
  s_add_u32 s20, s20, 262144
  s_mov_b32 m0, s21
  s_add_u32 s21, s21, 4096
  buffer_load_dwordx4 v69, s[60:63], s20 offen lds
  s_add_u32 s20, s20, 786432
  s_mov_b32 m0, s21
  s_add_u32 s21, s21, 4096
  buffer_load_dwordx4 v69, s[60:63], s20 offen lds
  s_add_u32 s20, s20, 262144
  s_mov_b32 m0, s21
  s_add_u32 s21, s21, 4096
  buffer_load_dwordx4 v69, s[60:63], s20 offen lds
  s_add_u32 s20, s20, 786432
  s_waitcnt vmcnt(16)
  s_barrier
  s_lshl_b32 s20, s16, 13
  s_add_u32 s20, s20, 65536
  v_add_u32 v73, s20, v71
  v_lshl_add_u32 v73, v80, 12, v73
  v_xor_b32 v74, 4096, v73
  ds_read_b64_tr_b16 a[192:193], v73 offset:0
  ds_read_b64_tr_b16 a[194:195], v73 offset:512
  ds_read_b64_tr_b16 a[200:201], v74 offset:0
  ds_read_b64_tr_b16 a[202:203], v74 offset:512
  s_lshl_b32 s20, s34, 4
  s_add_u32 s20, s20, 65536
  v_add_u32 v73, s20, v71
  ds_read_b64_tr_b16 a[224:225], v73 offset:0
  ds_read_b64_tr_b16 a[226:227], v73 offset:512
  ds_read_b64_tr_b16 a[232:233], v73 offset:4096
  ds_read_b64_tr_b16 a[234:235], v73 offset:4608
  s_waitcnt lgkmcnt(0)
  s_lshl_b32 s20, s35, 4
  s_add_u32 s20, s20, 65536
  v_add_u32 v73, s20, v71
  ds_read_b64_tr_b16 v[128:129], v73 offset:0
  ds_read_b64_tr_b16 v[130:131], v73 offset:512
  ds_read_b64_tr_b16 v[136:137], v73 offset:4096
  ds_read_b64_tr_b16 v[138:139], v73 offset:4608
  s_lshl_b32 s20, s36, 4
  s_add_u32 s20, s20, 65536
  v_add_u32 v73, s20, v71
  ds_read_b64_tr_b16 v[160:161], v73 offset:0
  ds_read_b64_tr_b16 v[162:163], v73 offset:512
  ds_read_b64_tr_b16 v[168:169], v73 offset:4096
  ds_read_b64_tr_b16 v[170:171], v73 offset:4608
  s_waitcnt lgkmcnt(0)
  s_barrier
  v_cmp_gt_u32 vcc, v21, v22
  s_cbranch_vccz R_init_ok
R_init:
  buffer_load_dword v22, v20, s[12:15], 0 offen sc1
  s_waitcnt vmcnt(0)
  v_cmp_gt_u32 vcc, v21, v22
  s_cbranch_vccz R_init_ok
  s_sleep 2
  s_sub_u32 s18, s18, 1
  s_cbranch_scc0 R_init
  s_endpgm
    R_init_ok:
  s_lshl_b32 s53, s17, 7
  s_add_u32 s53, s53, 83886088
  s_add_u32 s57, s53, 24
  v_lshlrev_b32 v20, 2, v68
  v_mov_b32 v21, 1
  buffer_load_dword v22, v20, s[4:7], s53 offen sc1
  s_lshl_b32 s20, s17, 8
  s_add_u32 s20, s20, 655360
  s_lshl_b32 s21, s16, 10
  s_add_u32 s21, s21, 65536
  s_mov_b32 m0, s21
  s_add_u32 s21, s21, 4096
  buffer_load_dwordx4 v69, s[60:63], s20 offen lds
  s_add_u32 s20, s20, 262144
  s_mov_b32 m0, s21
  s_add_u32 s21, s21, 4096
  buffer_load_dwordx4 v69, s[60:63], s20 offen lds
  s_add_u32 s20, s20, 786432
  s_mov_b32 m0, s21
  s_add_u32 s21, s21, 4096
  buffer_load_dwordx4 v69, s[60:63], s20 offen lds
  s_add_u32 s20, s20, 262144
  s_mov_b32 m0, s21
  s_add_u32 s21, s21, 4096
  buffer_load_dwordx4 v69, s[60:63], s20 offen lds
  s_add_u32 s20, s20, 786432
  s_mov_b32 m0, s21
  s_add_u32 s21, s21, 4096
  buffer_load_dwordx4 v69, s[60:63], s20 offen lds
  s_add_u32 s20, s20, 262144
  s_mov_b32 m0, s21
  s_add_u32 s21, s21, 4096
  buffer_load_dwordx4 v69, s[60:63], s20 offen lds
  s_add_u32 s20, s20, 786432
  s_mov_b32 m0, s21
  s_add_u32 s21, s21, 4096
  buffer_load_dwordx4 v69, s[60:63], s20 offen lds
  s_add_u32 s20, s20, 262144
  s_mov_b32 m0, s21
  s_add_u32 s21, s21, 4096
  buffer_load_dwordx4 v69, s[60:63], s20 offen lds
  s_add_u32 s20, s20, 786432
  s_waitcnt vmcnt(16)
  s_barrier
  s_lshl_b32 s20, s16, 13
  s_add_u32 s20, s20, 0
  v_add_u32 v73, s20, v71
  v_lshl_add_u32 v73, v80, 12, v73
  v_xor_b32 v74, 4096, v73
  ds_read_b64_tr_b16 a[196:197], v73 offset:0
  ds_read_b64_tr_b16 a[198:199], v73 offset:512
  ds_read_b64_tr_b16 a[204:205], v74 offset:0
  ds_read_b64_tr_b16 a[206:207], v74 offset:512
  s_lshl_b32 s20, s34, 4
  s_add_u32 s20, s20, 0
  v_add_u32 v73, s20, v71
  ds_read_b64_tr_b16 a[228:229], v73 offset:0
  ds_read_b64_tr_b16 a[230:231], v73 offset:512
  ds_read_b64_tr_b16 a[236:237], v73 offset:4096
  ds_read_b64_tr_b16 a[238:239], v73 offset:4608
  s_waitcnt lgkmcnt(0)
  s_lshl_b32 s20, s35, 4
  s_add_u32 s20, s20, 0
  v_add_u32 v73, s20, v71
  ds_read_b64_tr_b16 v[132:133], v73 offset:0
  ds_read_b64_tr_b16 v[134:135], v73 offset:512
  ds_read_b64_tr_b16 v[140:141], v73 offset:4096
  ds_read_b64_tr_b16 v[142:143], v73 offset:4608
  s_lshl_b32 s20, s36, 4
  s_add_u32 s20, s20, 0
  v_add_u32 v73, s20, v71
  ds_read_b64_tr_b16 v[164:165], v73 offset:0
  ds_read_b64_tr_b16 v[166:167], v73 offset:512
  ds_read_b64_tr_b16 v[172:173], v73 offset:4096
  ds_read_b64_tr_b16 v[174:175], v73 offset:4608
  s_waitcnt lgkmcnt(0)
  s_barrier
  s_waitcnt vmcnt(8)
  s_barrier
  s_lshl_b32 s20, s16, 13
  s_add_u32 s20, s20, 32768
  v_add_u32 v73, s20, v71
  v_lshl_add_u32 v73, v80, 12, v73
  v_xor_b32 v74, 4096, v73
  ds_read_b64_tr_b16 a[208:209], v73 offset:0
  ds_read_b64_tr_b16 a[210:211], v73 offset:512
  ds_read_b64_tr_b16 a[216:217], v74 offset:0
  ds_read_b64_tr_b16 a[218:219], v74 offset:512
  s_lshl_b32 s20, s34, 4
  s_add_u32 s20, s20, 32768
  v_add_u32 v73, s20, v71
  ds_read_b64_tr_b16 a[240:241], v73 offset:0
  ds_read_b64_tr_b16 a[242:243], v73 offset:512
  ds_read_b64_tr_b16 a[248:249], v73 offset:4096
  ds_read_b64_tr_b16 a[250:251], v73 offset:4608
  s_waitcnt lgkmcnt(0)
  s_lshl_b32 s20, s35, 4
  s_add_u32 s20, s20, 32768
  v_add_u32 v73, s20, v71
  ds_read_b64_tr_b16 v[144:145], v73 offset:0
  ds_read_b64_tr_b16 v[146:147], v73 offset:512
  ds_read_b64_tr_b16 v[152:153], v73 offset:4096
  ds_read_b64_tr_b16 v[154:155], v73 offset:4608
  s_lshl_b32 s20, s36, 4
  s_add_u32 s20, s20, 32768
  v_add_u32 v73, s20, v71
  ds_read_b64_tr_b16 v[176:177], v73 offset:0
  ds_read_b64_tr_b16 v[178:179], v73 offset:512
  ds_read_b64_tr_b16 v[184:185], v73 offset:4096
  ds_read_b64_tr_b16 v[186:187], v73 offset:4608
  s_waitcnt lgkmcnt(0)
  s_barrier
  v_cmp_gt_u32 vcc, v21, v22
  s_cbranch_vccz R_kv0_ok
R_kv0:
  buffer_load_dword v22, v20, s[4:7], s53 offen sc1
  s_waitcnt vmcnt(0)
  v_cmp_gt_u32 vcc, v21, v22
  s_cbranch_vccz R_kv0_ok
  s_sleep 2
  s_sub_u32 s18, s18, 1
  s_cbranch_scc0 R_kv0
  s_endpgm
    R_kv0_ok:
  s_lshl_b32 s30, s17, 13
  s_add_u32 s20, s30, 16777216
  s_lshl_b32 s33, s16, 11
  s_mov_b32 m0, s33
  s_nop 0
  buffer_load_dwordx4 v0, s[4:7], s20 offen sc1 lds
  buffer_load_dwordx4 v0, s[4:7], s20 offen offset:1024 sc1 lds
  v_add_u32 v73, 0, v7
  ds_write_b128 v73, v[32:35] offset:0
  ds_write_b128 v73, v[36:39] offset:1024
  ds_write_b128 v73, v[40:43] offset:2048
  ds_write_b128 v73, v[44:47] offset:3072
  ds_write_b128 v73, v[48:51] offset:4096
  ds_write_b128 v73, v[52:55] offset:5120
  ds_write_b128 v73, v[56:59] offset:6144
  ds_write_b128 v73, v[60:63] offset:7168
  s_waitcnt lgkmcnt(0)
  s_waitcnt vmcnt(2)
  s_barrier
  s_lshl_b32 s20, s16, 13
  s_add_u32 s20, s20, 65536
  v_add_u32 v73, s20, v71
  v_lshl_add_u32 v73, v80, 12, v73
  v_xor_b32 v74, 4096, v73
  ds_read_b64_tr_b16 a[212:213], v73 offset:0
  ds_read_b64_tr_b16 a[214:215], v73 offset:512
  ds_read_b64_tr_b16 a[220:221], v74 offset:0
  ds_read_b64_tr_b16 a[222:223], v74 offset:512
  s_lshl_b32 s20, s34, 4
  s_add_u32 s20, s20, 65536
  v_add_u32 v73, s20, v71
  ds_read_b64_tr_b16 a[244:245], v73 offset:0
  ds_read_b64_tr_b16 a[246:247], v73 offset:512
  ds_read_b64_tr_b16 a[252:253], v73 offset:4096
  ds_read_b64_tr_b16 a[254:255], v73 offset:4608
  s_waitcnt lgkmcnt(0)
  s_lshl_b32 s20, s35, 4
  s_add_u32 s20, s20, 65536
  v_add_u32 v73, s20, v71
  ds_read_b64_tr_b16 v[148:149], v73 offset:0
  ds_read_b64_tr_b16 v[150:151], v73 offset:512
  ds_read_b64_tr_b16 v[156:157], v73 offset:4096
  ds_read_b64_tr_b16 v[158:159], v73 offset:4608
  s_lshl_b32 s20, s36, 4
  s_add_u32 s20, s20, 65536
  v_add_u32 v73, s20, v71
  ds_read_b64_tr_b16 v[180:181], v73 offset:0
  ds_read_b64_tr_b16 v[182:183], v73 offset:512
  ds_read_b64_tr_b16 v[188:189], v73 offset:4096
  ds_read_b64_tr_b16 v[190:191], v73 offset:4608
  s_waitcnt lgkmcnt(0)
  s_barrier
  v_add_u32 v73, 32768, v7
  ds_write_b128 v73, v[96:99] offset:0
  ds_write_b128 v73, v[100:103] offset:1024
  ds_write_b128 v73, v[104:107] offset:2048
  ds_write_b128 v73, v[108:111] offset:3072
  ds_write_b128 v73, v[112:115] offset:4096
  ds_write_b128 v73, v[116:119] offset:5120
  ds_write_b128 v73, v[120:123] offset:6144
  ds_write_b128 v73, v[124:127] offset:7168
  s_waitcnt lgkmcnt(0)
  v_mov_b64 v[64:65], v[12:13]
  v_mov_b64 v[72:73], v[16:17]
  v_mov_b64 v[66:67], v[14:15]
  v_mov_b64 v[74:75], v[18:19]
  s_mov_b32 s19, 0
  s_mov_b32 s56, 0
  s_mov_b32 s27, 84934656
  ds_read_b128 v[32:35], v7 offset:0
  ds_read_b128 v[36:39], v7 offset:1024
  ds_read_b128 v[40:43], v7 offset:2048
  ds_read_b128 v[44:47], v7 offset:3072
  ds_read_b128 v[48:51], v7 offset:4096
  ds_read_b128 v[52:55], v7 offset:5120
  ds_read_b128 v[56:59], v7 offset:6144
  ds_read_b128 v[60:63], v7 offset:7168
  v_mov_b64 v[20:21], 0
  v_mov_b64 v[22:23], 0
  v_mov_b64 v[24:25], 0
  v_mov_b64 v[26:27], 0
  v_mov_b64 v[28:29], 0
  v_mov_b64 v[30:31], 0
  s_xor_b32 s25, s19, s17
  s_and_b32 s25, s25, 1
  s_lshl_b32 s23, s17, 13
  s_add_u32 s20, s19, 3
  s_and_b32 s20, s20, 3
  s_lshl_b32 s29, s20, 13
  s_add_u32 s29, s29, s37
  s_add_u32 s31, s30, 67108864
  s_add_u32 s52, s30, 33554432
  s_add_u32 s21, s19, 1
  s_min_u32 s21, s21, 63
  s_lshl_b32 s21, s21, 18
  s_add_u32 s30, s21, s23
  s_add_u32 s54, s30, 16777216
  s_lshl_b32 s22, s16, 11
  s_add_u32 s55, s30, s22
  s_add_u32 s55, s55, 33554432
  s_xor_b32 s33, s33, 8192
  s_mov_b32 m0, s33
  s_cmp_eq_u32 s19, 63
  s_cselect_b32 s32, 0, 402653184
  s_add_u32 s24, s51, 4096
  s_mov_b32 s48, 0x000f000f
  s_mov_b32 s49, 0x000f000f
  s_waitcnt vmcnt(0) lgkmcnt(0)
  s_barrier
  s_cmp_eq_u32 s16, 0
  s_cbranch_scc0 R_first0
  v_lshlrev_b32 v100, 3, v5
  v_and_b32 v100, 0x7ff, v100
  v_mov_b32 v101, -1
  s_sub_u32 s20, s53, s55
  s_mov_b64 exec, 0xf0000
  v_lshrrev_b32 v100, 5, v100
  v_add_u32 v100, s20, v100
  s_mov_b64 exec, -1
  v_writelane_b32 v8, s19, 20
  s_branch R0_loop
R_first0:
  s_cmp_eq_u32 s16, 1
  s_cbranch_scc0 R_first1
  v_lshlrev_b32 v100, 3, v5
  v_and_b32 v100, 0x7ff, v100
  v_mov_b32 v101, -1
  s_branch R1_loop
R_first1:
  s_cmp_eq_u32 s16, 2
  s_cbranch_scc0 R_first2
  v_lshlrev_b32 v100, 3, v5
  v_and_b32 v100, 0x7ff, v100
  v_mov_b32 v101, -1
  s_branch R2_loop
R_first2:
  v_lshlrev_b32 v100, 3, v5
  v_and_b32 v100, 0x7ff, v100
  v_mov_b32 v101, -1
  s_branch R3_loop
  .p2align 4
R0_top:
  s_xor_b32 s25, s19, s17
  s_and_b32 s25, s25, 1
  s_lshl_b32 s23, s17, 13
  s_add_u32 s20, s19, 3
  s_and_b32 s20, s20, 3
  s_lshl_b32 s29, s20, 13
  s_add_u32 s29, s29, s37
  s_add_u32 s31, s30, 67108864
  s_add_u32 s52, s30, 33554432
  s_add_u32 s21, s19, 1
  s_min_u32 s21, s21, 63
  s_lshl_b32 s21, s21, 18
  s_add_u32 s30, s21, s23
  s_add_u32 s54, s30, 16777216
  s_lshl_b32 s22, s16, 11
  s_add_u32 s55, s30, s22
  s_add_u32 s55, s55, 33554432
  s_xor_b32 s33, s33, 8192
  s_mov_b32 m0, s33
  s_cmp_eq_u32 s19, 63
  s_cselect_b32 s32, 0, 402653184
  s_add_u32 s58, s19, 3
  s_lshr_b32 s58, s58, 1
  s_min_u32 s58, s58, 32
  v_cmp_gt_u32 vcc, s58, v8
  s_and_b32 s20, vcc_lo, 0xf0000
  s_cbranch_scc1 R_kvwait
R_kvok:
  v_lshlrev_b32 v100, 3, v5
  v_and_b32 v100, 0x7ff, v100
  v_mov_b32 v101, -1
  s_sub_u32 s20, s53, s55
  s_mov_b64 exec, 0xf0000
  v_lshrrev_b32 v100, 5, v100
  v_add_u32 v100, s20, v100
  s_mov_b64 exec, -1
  v_writelane_b32 v8, s19, 20
  s_nop 0
  s_nop 0
  s_nop 0
  buffer_load_dwordx4 v[112:115], v0, s[4:7], s27 offen sc1
  buffer_load_dwordx4 v[116:119], v0, s[4:7], s27 offen offset:1024 sc1
  s_nop 0
  s_nop 0
  s_nop 0
  s_nop 0
  s_nop 0
  s_nop 0
  s_nop 0
  s_nop 0
  s_nop 0
  s_nop 0
  s_nop 0
  s_nop 0
  s_nop 0
  s_nop 0
  s_nop 0
  s_nop 0
  s_nop 0
  s_nop 0
  s_nop 0
  s_nop 0
  s_nop 0
  s_nop 0
  s_nop 0
  s_nop 0
  s_nop 0
  s_nop 0
  s_nop 0
  s_nop 0
  s_nop 0
  s_nop 0
  buffer_load_dwordx4 v[120:123], v0, s[4:7], s27 offen sc1
  buffer_load_dwordx4 v[124:127], v0, s[4:7], s27 offen offset:1024 sc1
R0_poll:
  s_waitcnt vmcnt(3)
  v_max3_u32 v96, v112, v113, v114
  v_max_u32 v96, v96, v115
  s_waitcnt vmcnt(2) lgkmcnt(0)
  v_max3_u32 v96, v96, v116, v117
  v_max3_u32 v96, v96, v118, v119
  v_cmp_eq_u32 vcc, -1, v96
  v_mov_b64 v[64:65], v[112:113]
  v_mov_b64 v[66:67], v[114:115]
  v_mov_b64 v[72:73], v[116:117]
  v_mov_b64 v[74:75], v[118:119]
  s_cbranch_vccz R0_loop
  buffer_load_dwordx4 v[112:115], v0, s[4:7], s27 offen sc1
  buffer_load_dwordx4 v[116:119], v0, s[4:7], s27 offen offset:1024 sc1
  s_waitcnt vmcnt(3)
  v_max3_u32 v96, v120, v121, v122
  v_max_u32 v96, v96, v123
  s_waitcnt vmcnt(2) lgkmcnt(0)
  v_max3_u32 v96, v96, v124, v125
  v_max3_u32 v96, v96, v126, v127
  v_cmp_eq_u32 vcc, -1, v96
  v_mov_b64 v[64:65], v[120:121]
  v_mov_b64 v[66:67], v[122:123]
  v_mov_b64 v[72:73], v[124:125]
  v_mov_b64 v[74:75], v[126:127]
  s_cbranch_vccnz R0_pollB
R0_loop:
  v_smfmac_f32_16x16x64_bf16 v[20:23], v[64:67], v[32:39], v1
  ds_write_b128 v0, v[64:67] offset:16384
  v_smfmac_f32_16x16x64_bf16 v[20:23], v[72:75], v[48:55], v1
  ds_write_b128 v0, v[72:75] offset:17408
  v_smfmac_f32_16x16x64_bf16 v[24:27], v[64:67], a[96:103], v1
  buffer_load_dwordx4 v[12:15], v0, s[4:7], s52 offen offset:0 sc1
  v_mov_b32_dpp v68, v64 row_ror:8 row_mask:0xf bank_mask:0xf
  v_smfmac_f32_16x16x64_bf16 v[24:27], v[72:75], a[112:119], v1
  v_mov_b32_dpp v69, v65 row_ror:8 row_mask:0xf bank_mask:0xf
  v_mov_b32_dpp v70, v66 row_ror:8 row_mask:0xf bank_mask:0xf
  v_smfmac_f32_16x16x64_bf16 v[28:31], v[64:67], a[192:199], v1
  buffer_load_dwordx4 v[16:19], v0, s[4:7], s52 offen offset:1024 sc1
  v_mov_b32_dpp v71, v67 row_ror:8 row_mask:0xf bank_mask:0xf
  v_smfmac_f32_16x16x64_bf16 v[28:31], v[72:75], a[208:215], v1
  v_mov_b32_dpp v76, v72 row_ror:8 row_mask:0xf bank_mask:0xf
  v_mov_b32_dpp v77, v73 row_ror:8 row_mask:0xf bank_mask:0xf
  v_smfmac_f32_16x16x64_bf16 v[20:23], v[68:71], v[40:47], v1
  s_waitcnt lgkmcnt(0)
  s_barrier
  ds_read_b128 v[80:83], v2 offset:18432
  v_smfmac_f32_16x16x64_bf16 v[24:27], v[68:71], a[104:111], v1
  ds_read_b128 v[84:87], v2 offset:18944
  v_mov_b32_dpp v78, v74 row_ror:8 row_mask:0xf bank_mask:0xf
  v_mov_b32_dpp v79, v75 row_ror:8 row_mask:0xf bank_mask:0xf
  v_smfmac_f32_16x16x64_bf16 v[28:31], v[68:71], a[200:207], v1
  s_mov_b64 exec, 0xfffff
  buffer_load_dword v8, v100, s[4:7], s55 offen sc1
  s_mov_b64 exec, -1
  v_smfmac_f32_16x16x64_bf16 v[20:23], v[76:79], v[56:63], v1
  ds_read_b128 v[88:91], v2 offset:19456
  ds_read_b128 v[92:95], v2 offset:19968
  v_smfmac_f32_16x16x64_bf16 v[24:27], v[76:79], a[120:127], v1
  ds_read_b128 v[96:99], v2 offset:20480
  buffer_store_dword v101, v10, s[4:7], s29 offen
  v_smfmac_f32_16x16x64_bf16 v[28:31], v[76:79], a[216:223], v1
  ds_read_b128 v[100:103], v2 offset:20992
  s_waitcnt lgkmcnt(5)
  v_smfmac_f32_16x16x64_bf16 v[20:23], v[80:83], a[0:7], v1
  s_waitcnt lgkmcnt(4)
  ds_read_b128 v[104:107], v2 offset:21504
  buffer_load_dwordx4 v0, s[4:7], s54 offen sc1 lds
  v_smfmac_f32_16x16x64_bf16 v[20:23], v[84:87], a[8:15], v1
  s_waitcnt lgkmcnt(4) vmcnt(5)
  ds_read_b128 v[108:111], v2 offset:22016
  v_smfmac_f32_16x16x64_bf16 v[20:23], v[88:91], a[16:23], v1
  ds_read_b128 v[112:115], v2 offset:22528
  buffer_load_dwordx4 v0, s[4:7], s54 offen offset:1024 sc1 lds
  v_smfmac_f32_16x16x64_bf16 v[24:27], v[80:83], a[128:135], v1
  s_waitcnt lgkmcnt(5)
  ds_read_b128 v[116:119], v2 offset:23040
  v_smfmac_f32_16x16x64_bf16 v[20:23], v[92:95], a[24:31], v1
  s_waitcnt lgkmcnt(5)
  ds_read_b128 v[120:123], v2 offset:23552
  v_smfmac_f32_16x16x64_bf16 v[20:23], v[96:99], a[32:39], v1
  s_waitcnt lgkmcnt(5)
  ds_read_b128 v[124:127], v2 offset:24064
  v_smfmac_f32_16x16x64_bf16 v[20:23], v[100:103], a[40:47], v1
  ds_read_b128 v[32:35], v7 offset:32768
  v_smfmac_f32_16x16x64_bf16 v[24:27], v[84:87], a[136:143], v1
  s_waitcnt lgkmcnt(6)
  ds_read_b128 v[36:39], v7 offset:33792
  v_smfmac_f32_16x16x64_bf16 v[20:23], v[104:107], a[48:55], v1
  s_waitcnt lgkmcnt(6)
  ds_read_b128 v[40:43], v7 offset:34816
  v_smfmac_f32_16x16x64_bf16 v[20:23], v[108:111], a[56:63], v1
  s_waitcnt lgkmcnt(6)
  ds_read_b128 v[44:47], v7 offset:35840
  v_smfmac_f32_16x16x64_bf16 v[20:23], v[112:115], a[64:71], v1
  ds_read_b128 v[48:51], v7 offset:36864
  v_smfmac_f32_16x16x64_bf16 v[24:27], v[88:91], a[144:151], v1
  s_waitcnt lgkmcnt(7)
  ds_read_b128 v[52:55], v7 offset:37888
  v_smfmac_f32_16x16x64_bf16 v[20:23], v[116:119], a[72:79], v1
  s_waitcnt lgkmcnt(7)
  ds_read_b128 v[56:59], v7 offset:38912
  v_smfmac_f32_16x16x64_bf16 v[20:23], v[120:123], a[80:87], v1
  s_waitcnt lgkmcnt(7)
  ds_read_b128 v[60:63], v7 offset:39936
  v_smfmac_f32_16x16x64_bf16 v[20:23], v[124:127], a[88:95], v1
  s_mov_b64 exec, 0x100000
  buffer_store_dword v8, off, s[4:7], s57 sc1
  s_mov_b64 exec, -1
  v_smfmac_f32_16x16x64_bf16 v[24:27], v[92:95], a[152:159], v1
  v_smfmac_f32_16x16x64_bf16 v[24:27], v[96:99], a[160:167], v1
  v_mul_f32 v20, s50, v20
  v_smfmac_f32_16x16x64_bf16 v[24:27], v[100:103], a[168:175], v1
  v_mul_f32 v21, s50, v21
  v_smfmac_f32_16x16x64_bf16 v[24:27], v[104:107], a[176:183], v1
  v_mul_f32 v22, s50, v22
  v_smfmac_f32_16x16x64_bf16 v[24:27], v[108:111], a[184:191], v1
  s_waitcnt lgkmcnt(0)
  v_mul_f32 v23, s50, v23
  v_smfmac_f32_16x16x64_bf16 v[24:27], v[112:115], v[32:39], v1
  v_cvt_pk_bf16_f32 v20, v20, v21
  v_smfmac_f32_16x16x64_bf16 v[24:27], v[116:119], v[40:47], v1
  ds_read_b128 v[32:35], v5 offset:0
  v_cvt_pk_bf16_f32 v21, v22, v23
  v_smfmac_f32_16x16x64_bf16 v[24:27], v[120:123], v[48:55], v1
  ds_write_b64 v3, v[20:21] offset:24576
  v_smfmac_f32_16x16x64_bf16 v[24:27], v[124:127], v[56:63], v1
  ds_read_b128 v[36:39], v5 offset:1024
  v_mov_b32 v20, v11
  v_smfmac_f32_16x16x64_bf16 v[28:31], v[84:87], a[232:239], v1
  v_mov_b32 v21, v11
  v_mov_b64 v[22:23], v[20:21]
  v_cvt_pk_bf16_f32 v84, v24, v25
  v_cvt_pk_bf16_f32 v85, v26, v27
  v_smfmac_f32_16x16x64_bf16 v[28:31], v[80:83], a[224:231], v1
  ds_write_b64 v3, v[84:85] offset:26752
  v_smfmac_f32_16x16x64_bf16 v[28:31], v[104:107], v[144:151], v1
  buffer_store_dwordx2 v[84:85], v3, s[4:7], s31 offen sc1
  v_smfmac_f32_16x16x64_bf16 v[28:31], v[108:111], v[152:159], v1
  ds_read_b128 v[40:43], v5 offset:2048
  v_mov_b32 v104, 0x3f803f80
  v_smfmac_f32_16x16x64_bf16 v[28:31], v[88:91], a[240:247], v1
  ds_read_b128 v[44:47], v5 offset:3072
  v_mov_b32 v105, 0x3f803f80
  v_smfmac_f32_16x16x64_bf16 v[28:31], v[112:115], v[160:167], v1
  ds_read_b128 v[48:51], v5 offset:4096
  v_add_u32 v90, 0x10000, v7
  v_smfmac_f32_16x16x64_bf16 v[28:31], v[116:119], v[168:175], v1
  s_waitcnt lgkmcnt(3)
  s_barrier
  ds_read_b64_tr_b16 v[64:65], v4 offset:24576
  ds_read_b64_tr_b16 v[66:67], v4 offset:24704
  v_smfmac_f32_16x16x64_bf16 v[28:31], v[120:123], v[176:183], v1
  ds_read_b64_tr_b16 v[68:69], v4 offset:24832
  ds_read_b64_tr_b16 v[70:71], v4 offset:24960
  v_smfmac_f32_16x16x64_bf16 v[28:31], v[124:127], v[184:191], v1
  ds_read_b64_tr_b16 v[72:73], v4 offset:25088
  ds_read_b64_tr_b16 v[74:75], v4 offset:25216
  v_smfmac_f32_16x16x64_bf16 v[28:31], v[92:95], a[248:255], v1
  ds_read_b64_tr_b16 v[76:77], v4 offset:25344
  ds_read_b64_tr_b16 v[78:79], v4 offset:25472
  v_smfmac_f32_16x16x64_bf16 v[28:31], v[96:99], v[128:135], v1
  ds_read_b128 v[52:55], v5 offset:5120
  v_mov_b64 v[106:107], v[104:105]
  v_smfmac_f32_16x16x64_bf16 v[28:31], v[100:103], v[136:143], v1
  ds_read_b128 v[56:59], v5 offset:6144
  s_waitcnt lgkmcnt(6)
  v_mfma_f32_16x16x32_bf16 v[20:23], v[64:67], v[64:67], v[20:23]
  ds_read_b128 v[60:63], v5 offset:7168
  ds_read_b128 v[112:115], v90 offset:0
  v_mfma_f32_16x16x32_bf16 v[20:23], v[68:71], v[68:71], v[20:23]
  s_waitcnt lgkmcnt(4)
  v_cvt_pk_bf16_f32 v110, v28, v29
  v_cvt_pk_bf16_f32 v111, v30, v31
  v_mfma_f32_16x16x32_bf16 v[20:23], v[72:75], v[72:75], v[20:23]
  buffer_store_dwordx2 v[110:111], v3, s[4:7], s31 offen offset:2176 sc1
  v_mfma_f32_16x16x32_bf16 v[20:23], v[76:79], v[76:79], v[20:23]
  v_permlane32_swap_b32 v108, v110
  v_mfma_f32_16x16x32_bf16 v[24:27], v[32:35], v[64:67], 0
  v_permlane32_swap_b32 v109, v111
  v_mfma_f32_16x16x32_bf16 v[24:27], v[36:39], v[68:71], v[24:27]
  v_exp_f32 v20, v20
  v_mfma_f32_16x16x32_bf16 v[24:27], v[40:43], v[72:75], v[24:27]
  v_exp_f32 v21, v21
  v_mfma_f32_16x16x32_bf16 v[24:27], v[44:47], v[76:79], v[24:27]
  s_waitcnt lgkmcnt(1)
  v_exp_f32 v22, v22
  v_mfma_f32_16x16x32_bf16 v[80:83], v[48:51], v[64:67], 0
  v_exp_f32 v23, v23
  v_mfma_f32_16x16x32_bf16 v[80:83], v[52:55], v[68:71], v[80:83]
  v_exp_f32 v24, v24
  v_mfma_f32_16x16x32_bf16 v[80:83], v[56:59], v[72:75], v[80:83]
  v_exp_f32 v25, v25
  v_mfma_f32_16x16x32_bf16 v[80:83], v[60:63], v[76:79], v[80:83]
  v_exp_f32 v26, v26
  v_exp_f32 v27, v27
  v_cvt_pk_bf16_f32 v88, v20, v21
  v_cvt_pk_bf16_f32 v89, v22, v23
  v_cvt_pk_bf16_f32 v84, v24, v25
  v_cvt_pk_bf16_f32 v85, v26, v27
  v_mfma_f32_16x16x16_bf16 v[100:103], v[104:105], v[88:89], 0
  v_exp_f32 v80, v80
  v_mfma_f32_16x16x16_bf16 v[92:95], v[108:109], v[88:89], 0
  v_exp_f32 v81, v81
  v_mfma_f32_16x16x16_bf16 v[96:99], v[110:111], v[88:89], 0
  v_exp_f32 v82, v82
  v_exp_f32 v83, v83
  v_cvt_pk_bf16_f32 v86, v80, v81
  v_cvt_pk_bf16_f32 v87, v82, v83
  s_waitcnt vmcnt(7)
  v_mov_b64 v[20:21], 0
  v_mfma_f32_16x16x32_bf16 v[100:103], v[104:107], v[84:87], v[100:103]
  ds_read_b128 v[116:119], v90 offset:1024
  ds_read_b128 v[120:123], v90 offset:32768
  v_mfma_f32_16x16x32_bf16 v[92:95], v[12:15], v[84:87], v[92:95]
  ds_read_b128 v[124:127], v90 offset:33792
  ds_read_b128 v[32:35], v90 offset:2048
  v_mfma_f32_16x16x32_bf16 v[96:99], v[16:19], v[84:87], v[96:99]
  v_rcp_f32 v91, v100
  v_mov_b64 v[22:23], 0
  v_mul_f32 v92, v91, v92
  v_mov_b32_dpp v91, v91 row_ror:8 row_mask:0xf bank_mask:0xc
  v_mul_f32 v93, v91, v93
  v_mul_f32 v94, v91, v94
  v_mul_f32 v95, v91, v95
  v_mul_f32_dpp v92, v96, v91 row_ror:8 row_mask:0xf bank_mask:0xc
  v_mul_f32_dpp v93, v97, v91 row_ror:8 row_mask:0xf bank_mask:0xc
  v_mul_f32_dpp v94, v98, v91 row_ror:8 row_mask:0xf bank_mask:0xc
  v_mul_f32_dpp v95, v99, v91 row_ror:8 row_mask:0xf bank_mask:0xc
  v_cvt_pk_bf16_f32 v92, v92, v93
  v_cvt_pk_bf16_f32 v93, v94, v95
  ds_write_b64 v6, v[92:93] offset:28928
  v_subrev_u32 v91, 864026624, v91
  v_cmp_le_u32 vcc, s32, v91
  v_mov_b32_dpp v94, v92 row_ror:8 row_mask:0xf bank_mask:0xf
  v_mov_b32_dpp v95, v93 row_ror:8 row_mask:0xf bank_mask:0xf
  v_mov_b64 v[24:25], 0
  v_mov_b64 v[26:27], 0
  v_mov_b64 v[80:81], 0
  v_mov_b64 v[82:83], 0
  v_mov_b64 v[28:29], 0
  v_mov_b64 v[30:31], 0
  v_xor_b32 v5, 8192, v5
  s_cbranch_vccnz R_slow
R0_slowret:
  v_smfmac_f32_16x16x64_bf16 v[20:23], v[92:95], v[192:199], v1
  s_waitcnt lgkmcnt(0)
  s_barrier
  ds_read_b128 v[96:99], v2 offset:29440
  ds_read_b128 v[100:103], v2 offset:29952
  ds_read_b128 v[84:87], v2 offset:30464
  v_smfmac_f32_16x16x64_bf16 v[24:27], v[92:95], v[200:207], v1
  v_smfmac_f32_16x16x64_bf16 v[80:83], v[92:95], v[208:215], v1
  ds_read_b128 v[36:39], v90 offset:3072
  v_smfmac_f32_16x16x64_bf16 v[28:31], v[92:95], v[216:223], v1
  ds_read_b128 v[40:43], v90 offset:34816
  s_waitcnt lgkmcnt(4)
  v_smfmac_f32_16x16x64_bf16 v[20:23], v[96:99], v[224:231], v1
  ds_read_b128 v[44:47], v90 offset:35840
  s_waitcnt lgkmcnt(4)
  v_smfmac_f32_16x16x64_bf16 v[20:23], v[100:103], v[112:119], v1
  ds_read_b128 v[48:51], v90 offset:4096
  s_waitcnt lgkmcnt(4)
  v_smfmac_f32_16x16x64_bf16 v[20:23], v[84:87], v[120:127], v1
  ds_read_b128 v[52:55], v90 offset:5120
  ds_read_b128 v[56:59], v90 offset:36864
  v_smfmac_f32_16x16x64_bf16 v[24:27], v[96:99], v[232:239], v1
  ds_read_b128 v[60:63], v90 offset:37888
  ds_read_b128 v[64:67], v90 offset:6144
  s_waitcnt lgkmcnt(5)
  v_cvt_pk_bf16_f32 v20, v20, v21
  v_cvt_pk_bf16_f32 v21, v22, v23
  v_and_or_b32 v20, v20, -2, s25
  v_smfmac_f32_16x16x64_bf16 v[24:27], v[100:103], v[32:39], v1
  buffer_store_dwordx2 v[20:21], v9, s[4:7], s51 offen offset:0
  v_smfmac_f32_16x16x64_bf16 v[24:27], v[84:87], v[40:47], v1
  ds_read_b128 v[68:71], v90 offset:7168
  ds_read_b128 v[72:75], v90 offset:38912
  v_smfmac_f32_16x16x64_bf16 v[80:83], v[96:99], v[240:247], v1
  s_add_u32 s19, s19, 1
  ds_read_b128 v[76:79], v90 offset:39936
  s_waitcnt lgkmcnt(4)
  v_smfmac_f32_16x16x64_bf16 v[80:83], v[100:103], v[48:55], v1
  s_and_b32 s20, s19, 3
  s_lshl_b32 s20, s20, 13
  v_cvt_pk_bf16_f32 v24, v24, v25
  v_cvt_pk_bf16_f32 v25, v26, v27
  v_and_or_b32 v24, v24, -2, s25
  v_smfmac_f32_16x16x64_bf16 v[80:83], v[84:87], v[56:63], v1
  s_add_u32 s28, s20, s37
  buffer_store_dwordx2 v[24:25], v9, s[4:7], s51 offen offset:2048
  v_smfmac_f32_16x16x64_bf16 v[28:31], v[96:99], v[248:255], v1
  s_add_u32 s27, s20, 84934656
  s_waitcnt lgkmcnt(0)
  v_smfmac_f32_16x16x64_bf16 v[28:31], v[100:103], v[64:71], v1
  v_cvt_pk_bf16_f32 v80, v80, v81
  v_cvt_pk_bf16_f32 v81, v82, v83
  v_and_or_b32 v80, v80, -2, s25
  v_smfmac_f32_16x16x64_bf16 v[28:31], v[84:87], v[72:79], v1
  buffer_store_dwordx2 v[80:81], v9, s[4:7], s24 offen offset:0
  v_mov_b32 v104, 0x3f80
  v_cndmask_b32 v104, v104, 1.0, s[38:39]
  v_cndmask_b32 v100, 0, v104, s[40:41]
  v_cndmask_b32 v101, 0, v104, s[42:43]
  s_nop 1
  v_cvt_pk_bf16_f32 v28, v28, v29
  v_cvt_pk_bf16_f32 v29, v30, v31
  v_and_or_b32 v28, v28, -2, s25
  buffer_store_dwordx2 v[28:29], v9, s[4:7], s24 offen offset:2048
  v_cndmask_b32 v102, 0, v104, s[44:45]
  v_cndmask_b32 v103, 0, v104, s[46:47]
  v_lshrrev_b32 v98, 6, v5
  v_xnor_b32 v98, s19, v98
  v_mov_b64 v[20:21], 0
  v_mov_b64 v[22:23], 0
  v_mov_b64 v[24:25], 0
  v_mov_b64 v[26:27], 0
  v_mov_b64 v[28:29], 0
  v_mov_b64 v[30:31], 0
  s_waitcnt vmcnt(2)
  buffer_load_dwordx4 v[112:115], v0, s[4:7], s3 offen sc1
  buffer_load_dwordx4 v[116:119], v0, s[4:7], s3 offen offset:1024 sc1
  ds_read_b128 v[32:35], v7 offset:0
  ds_read_b128 v[36:39], v7 offset:1024
  ds_read_b128 v[40:43], v7 offset:2048
  ds_read_b128 v[44:47], v7 offset:3072
  ds_read_b128 v[48:51], v7 offset:4096
  ds_read_b128 v[52:55], v7 offset:5120
  ds_read_b128 v[56:59], v7 offset:6144
  ds_read_b128 v[60:63], v7 offset:7168
  s_waitcnt vmcnt(1)
  v_mfma_f32_16x16x32_bf16 v[104:107], v[100:103], v[112:115], 0
  v_bitop3_b32 v96, v112, v114, v98 bitop3:0x7e
  s_waitcnt vmcnt(0)
  v_mfma_f32_16x16x32_bf16 v[104:107], v[100:103], v[116:119], v[104:107]
  v_bitop3_b32 v97, v116, v118, v98 bitop3:0x7e
  v_bitop3_b32 v96, v96, v97, 1 bitop3:0xa8
  v_cmp_ne_u32 vcc, 0, v96
  s_cbranch_vccnz R0_red2
R0_redok:
  v_add_f32_dpp v104, v104, v104 row_ror:8 row_mask:0xf bank_mask:0xf
  v_add_f32_dpp v105, v105, v105 row_ror:8 row_mask:0xf bank_mask:0xf
  s_nop 0
  v_add_f32_dpp v104, v104, v104 row_ror:4 row_mask:0xf bank_mask:0xf
  v_add_f32_dpp v105, v105, v105 row_ror:4 row_mask:0xf bank_mask:0xf
  v_cvt_pk_bf16_f32 v104, v104, v105
  s_mov_b64 exec, s[48:49]
  buffer_store_dword v104, v10, s[4:7], s28 offen
  s_mov_b64 exec, -1
  s_branch R0_top
R0_red2:
  buffer_load_dwordx4 v[112:115], v0, s[4:7], s3 offen sc1
  buffer_load_dwordx4 v[116:119], v0, s[4:7], s3 offen offset:1024 sc1
  s_add_u32 s56, s56, 1
  s_waitcnt vmcnt(1)
  v_mfma_f32_16x16x32_bf16 v[104:107], v[100:103], v[112:115], 0
  v_bitop3_b32 v96, v112, v114, v98 bitop3:0x7e
  s_waitcnt vmcnt(0)
  v_mfma_f32_16x16x32_bf16 v[104:107], v[100:103], v[116:119], v[104:107]
  v_bitop3_b32 v97, v116, v118, v98 bitop3:0x7e
  v_bitop3_b32 v96, v96, v97, 1 bitop3:0xa8
  v_cmp_ne_u32 vcc, 0, v96
  s_cbranch_vccz R0_redok
  s_cmp_lt_u32 s56, 0x40000
  s_cbranch_scc1 R0_red2
  s_endpgm
R0_pollB:
  buffer_load_dwordx4 v[120:123], v0, s[4:7], s27 offen sc1
  buffer_load_dwordx4 v[124:127], v0, s[4:7], s27 offen offset:1024 sc1
  s_sub_u32 s18, s18, 1
  s_cmp_gt_i32 s18, 0
  s_cbranch_scc1 R0_poll
  s_endpgm
  .p2align 4
R1_top:
  s_xor_b32 s25, s19, s17
  s_and_b32 s25, s25, 1
  s_lshl_b32 s23, s17, 13
  s_add_u32 s20, s19, 3
  s_and_b32 s20, s20, 3
  s_lshl_b32 s29, s20, 13
  s_add_u32 s29, s29, s37
  s_add_u32 s31, s30, 67108864
  s_add_u32 s52, s30, 33554432
  s_add_u32 s21, s19, 1
  s_min_u32 s21, s21, 63
  s_lshl_b32 s21, s21, 18
  s_add_u32 s30, s21, s23
  s_add_u32 s54, s30, 16777216
  s_lshl_b32 s22, s16, 11
  s_add_u32 s55, s30, s22
  s_add_u32 s55, s55, 33554432
  s_xor_b32 s33, s33, 8192
  s_mov_b32 m0, s33
  s_cmp_eq_u32 s19, 63
  s_cselect_b32 s32, 0, 402653184
  v_lshlrev_b32 v100, 3, v5
  v_and_b32 v100, 0x7ff, v100
  v_mov_b32 v101, -1
  s_nop 0
  s_nop 0
  s_nop 0
  s_nop 0
  s_nop 0
  s_nop 0
  buffer_load_dwordx4 v[112:115], v0, s[4:7], s27 offen sc1
  buffer_load_dwordx4 v[116:119], v0, s[4:7], s27 offen offset:1024 sc1
  s_nop 0
  s_nop 0
  s_nop 0
  s_nop 0
  s_nop 0
  s_nop 0
  s_nop 0
  s_nop 0
  s_nop 0
  s_nop 0
  s_nop 0
  s_nop 0
  s_nop 0
  s_nop 0
  s_nop 0
  s_nop 0
  s_nop 0
  s_nop 0
  s_nop 0
  s_nop 0
  s_nop 0
  s_nop 0
  s_nop 0
  s_nop 0
  s_nop 0
  s_nop 0
  s_nop 0
  s_nop 0
  s_nop 0
  s_nop 0
  buffer_load_dwordx4 v[120:123], v0, s[4:7], s27 offen sc1
  buffer_load_dwordx4 v[124:127], v0, s[4:7], s27 offen offset:1024 sc1
R1_poll:
  s_waitcnt vmcnt(3)
  v_max3_u32 v96, v112, v113, v114
  v_max_u32 v96, v96, v115
  s_waitcnt vmcnt(2) lgkmcnt(0)
  v_max3_u32 v96, v96, v116, v117
  v_max3_u32 v96, v96, v118, v119
  v_cmp_eq_u32 vcc, -1, v96
  v_mov_b64 v[64:65], v[112:113]
  v_mov_b64 v[66:67], v[114:115]
  v_mov_b64 v[72:73], v[116:117]
  v_mov_b64 v[74:75], v[118:119]
  s_cbranch_vccz R1_loop
  buffer_load_dwordx4 v[112:115], v0, s[4:7], s27 offen sc1
  buffer_load_dwordx4 v[116:119], v0, s[4:7], s27 offen offset:1024 sc1
  s_waitcnt vmcnt(3)
  v_max3_u32 v96, v120, v121, v122
  v_max_u32 v96, v96, v123
  s_waitcnt vmcnt(2) lgkmcnt(0)
  v_max3_u32 v96, v96, v124, v125
  v_max3_u32 v96, v96, v126, v127
  v_cmp_eq_u32 vcc, -1, v96
  v_mov_b64 v[64:65], v[120:121]
  v_mov_b64 v[66:67], v[122:123]
  v_mov_b64 v[72:73], v[124:125]
  v_mov_b64 v[74:75], v[126:127]
  s_cbranch_vccnz R1_pollB
R1_loop:
  v_smfmac_f32_16x16x64_bf16 v[20:23], v[64:67], v[32:39], v1
  ds_write_b128 v0, v[64:67] offset:16384
  v_smfmac_f32_16x16x64_bf16 v[20:23], v[72:75], v[48:55], v1
  ds_write_b128 v0, v[72:75] offset:17408
  v_smfmac_f32_16x16x64_bf16 v[24:27], v[64:67], a[96:103], v1
  buffer_load_dwordx4 v[12:15], v0, s[4:7], s52 offen offset:0 sc1
  v_mov_b32_dpp v68, v64 row_ror:8 row_mask:0xf bank_mask:0xf
  v_smfmac_f32_16x16x64_bf16 v[24:27], v[72:75], a[112:119], v1
  v_mov_b32_dpp v69, v65 row_ror:8 row_mask:0xf bank_mask:0xf
  v_mov_b32_dpp v70, v66 row_ror:8 row_mask:0xf bank_mask:0xf
  v_smfmac_f32_16x16x64_bf16 v[28:31], v[64:67], a[192:199], v1
  buffer_load_dwordx4 v[16:19], v0, s[4:7], s52 offen offset:1024 sc1
  v_mov_b32_dpp v71, v67 row_ror:8 row_mask:0xf bank_mask:0xf
  v_smfmac_f32_16x16x64_bf16 v[28:31], v[72:75], a[208:215], v1
  v_mov_b32_dpp v76, v72 row_ror:8 row_mask:0xf bank_mask:0xf
  v_mov_b32_dpp v77, v73 row_ror:8 row_mask:0xf bank_mask:0xf
  v_smfmac_f32_16x16x64_bf16 v[20:23], v[68:71], v[40:47], v1
  s_waitcnt lgkmcnt(0)
  s_barrier
  ds_read_b128 v[80:83], v2 offset:20480
  v_smfmac_f32_16x16x64_bf16 v[24:27], v[68:71], a[104:111], v1
  ds_read_b128 v[84:87], v2 offset:20992
  v_mov_b32_dpp v78, v74 row_ror:8 row_mask:0xf bank_mask:0xf
  v_mov_b32_dpp v79, v75 row_ror:8 row_mask:0xf bank_mask:0xf
  v_smfmac_f32_16x16x64_bf16 v[28:31], v[68:71], a[200:207], v1
  s_mov_b64 exec, 0xffff
  buffer_load_dword v8, v100, s[4:7], s55 offen sc1
  s_mov_b64 exec, -1
  v_smfmac_f32_16x16x64_bf16 v[20:23], v[76:79], v[56:63], v1
  ds_read_b128 v[88:91], v2 offset:21504
  ds_read_b128 v[92:95], v2 offset:22016
  v_smfmac_f32_16x16x64_bf16 v[24:27], v[76:79], a[120:127], v1
  ds_read_b128 v[96:99], v2 offset:22528
  buffer_store_dword v101, v10, s[4:7], s29 offen
  v_smfmac_f32_16x16x64_bf16 v[28:31], v[76:79], a[216:223], v1
  ds_read_b128 v[100:103], v2 offset:23040
  s_waitcnt lgkmcnt(5)
  v_smfmac_f32_16x16x64_bf16 v[20:23], v[80:83], a[0:7], v1
  s_waitcnt lgkmcnt(4)
  ds_read_b128 v[104:107], v2 offset:23552
  buffer_load_dwordx4 v0, s[4:7], s54 offen sc1 lds
  v_smfmac_f32_16x16x64_bf16 v[20:23], v[84:87], a[8:15], v1
  s_waitcnt lgkmcnt(4) vmcnt(5)
  ds_read_b128 v[108:111], v2 offset:24064
  v_smfmac_f32_16x16x64_bf16 v[20:23], v[88:91], a[16:23], v1
  ds_read_b128 v[112:115], v2 offset:16384
  buffer_load_dwordx4 v0, s[4:7], s54 offen offset:1024 sc1 lds
  v_smfmac_f32_16x16x64_bf16 v[24:27], v[80:83], a[128:135], v1
  s_waitcnt lgkmcnt(5)
  ds_read_b128 v[116:119], v2 offset:16896
  v_smfmac_f32_16x16x64_bf16 v[20:23], v[92:95], a[24:31], v1
  s_waitcnt lgkmcnt(5)
  ds_read_b128 v[120:123], v2 offset:17408
  v_smfmac_f32_16x16x64_bf16 v[20:23], v[96:99], a[32:39], v1
  s_waitcnt lgkmcnt(5)
  ds_read_b128 v[124:127], v2 offset:17920
  v_smfmac_f32_16x16x64_bf16 v[20:23], v[100:103], a[40:47], v1
  ds_read_b128 v[32:35], v7 offset:32768
  v_smfmac_f32_16x16x64_bf16 v[24:27], v[84:87], a[136:143], v1
  s_waitcnt lgkmcnt(6)
  ds_read_b128 v[36:39], v7 offset:33792
  v_smfmac_f32_16x16x64_bf16 v[20:23], v[104:107], a[48:55], v1
  s_waitcnt lgkmcnt(6)
  ds_read_b128 v[40:43], v7 offset:34816
  v_smfmac_f32_16x16x64_bf16 v[20:23], v[108:111], a[56:63], v1
  s_waitcnt lgkmcnt(6)
  ds_read_b128 v[44:47], v7 offset:35840
  v_smfmac_f32_16x16x64_bf16 v[20:23], v[112:115], a[64:71], v1
  ds_read_b128 v[48:51], v7 offset:36864
  v_smfmac_f32_16x16x64_bf16 v[24:27], v[88:91], a[144:151], v1
  s_waitcnt lgkmcnt(7)
  ds_read_b128 v[52:55], v7 offset:37888
  v_smfmac_f32_16x16x64_bf16 v[20:23], v[116:119], a[72:79], v1
  s_waitcnt lgkmcnt(7)
  ds_read_b128 v[56:59], v7 offset:38912
  v_smfmac_f32_16x16x64_bf16 v[20:23], v[120:123], a[80:87], v1
  s_waitcnt lgkmcnt(7)
  ds_read_b128 v[60:63], v7 offset:39936
  v_smfmac_f32_16x16x64_bf16 v[20:23], v[124:127], a[88:95], v1
  v_smfmac_f32_16x16x64_bf16 v[24:27], v[92:95], a[152:159], v1
  v_smfmac_f32_16x16x64_bf16 v[24:27], v[96:99], a[160:167], v1
  v_mul_f32 v20, s50, v20
  v_smfmac_f32_16x16x64_bf16 v[24:27], v[100:103], a[168:175], v1
  v_mul_f32 v21, s50, v21
  v_smfmac_f32_16x16x64_bf16 v[24:27], v[104:107], a[176:183], v1
  v_mul_f32 v22, s50, v22
  v_smfmac_f32_16x16x64_bf16 v[24:27], v[108:111], a[184:191], v1
  s_waitcnt lgkmcnt(0)
  v_mul_f32 v23, s50, v23
  v_smfmac_f32_16x16x64_bf16 v[24:27], v[112:115], v[32:39], v1
  v_cvt_pk_bf16_f32 v20, v20, v21
  v_smfmac_f32_16x16x64_bf16 v[24:27], v[116:119], v[40:47], v1
  ds_read_b128 v[32:35], v5 offset:0
  v_cvt_pk_bf16_f32 v21, v22, v23
  v_smfmac_f32_16x16x64_bf16 v[24:27], v[120:123], v[48:55], v1
  ds_write_b64 v3, v[20:21] offset:24576
  v_smfmac_f32_16x16x64_bf16 v[24:27], v[124:127], v[56:63], v1
  ds_read_b128 v[36:39], v5 offset:1024
  v_mov_b32 v20, v11
  v_smfmac_f32_16x16x64_bf16 v[28:31], v[84:87], a[232:239], v1
  v_mov_b32 v21, v11
  v_mov_b64 v[22:23], v[20:21]
  v_cvt_pk_bf16_f32 v84, v24, v25
  v_cvt_pk_bf16_f32 v85, v26, v27
  v_smfmac_f32_16x16x64_bf16 v[28:31], v[80:83], a[224:231], v1
  ds_write_b64 v3, v[84:85] offset:26752
  v_smfmac_f32_16x16x64_bf16 v[28:31], v[104:107], v[144:151], v1
  buffer_store_dwordx2 v[84:85], v3, s[4:7], s31 offen sc1
  v_smfmac_f32_16x16x64_bf16 v[28:31], v[108:111], v[152:159], v1
  ds_read_b128 v[40:43], v5 offset:2048
  v_mov_b32 v104, 0x3f803f80
  v_smfmac_f32_16x16x64_bf16 v[28:31], v[88:91], a[240:247], v1
  ds_read_b128 v[44:47], v5 offset:3072
  v_mov_b32 v105, 0x3f803f80
  v_smfmac_f32_16x16x64_bf16 v[28:31], v[112:115], v[160:167], v1
  ds_read_b128 v[48:51], v5 offset:4096
  v_add_u32 v90, 0x10000, v7
  v_smfmac_f32_16x16x64_bf16 v[28:31], v[116:119], v[168:175], v1
  s_waitcnt lgkmcnt(3)
  s_barrier
  ds_read_b64_tr_b16 v[64:65], v4 offset:24576
  ds_read_b64_tr_b16 v[66:67], v4 offset:24704
  v_smfmac_f32_16x16x64_bf16 v[28:31], v[120:123], v[176:183], v1
  ds_read_b64_tr_b16 v[68:69], v4 offset:24832
  ds_read_b64_tr_b16 v[70:71], v4 offset:24960
  v_smfmac_f32_16x16x64_bf16 v[28:31], v[124:127], v[184:191], v1
  ds_read_b64_tr_b16 v[72:73], v4 offset:25088
  ds_read_b64_tr_b16 v[74:75], v4 offset:25216
  v_smfmac_f32_16x16x64_bf16 v[28:31], v[92:95], a[248:255], v1
  ds_read_b64_tr_b16 v[76:77], v4 offset:25344
  ds_read_b64_tr_b16 v[78:79], v4 offset:25472
  v_smfmac_f32_16x16x64_bf16 v[28:31], v[96:99], v[128:135], v1
  ds_read_b128 v[52:55], v5 offset:5120
  v_mov_b64 v[106:107], v[104:105]
  v_smfmac_f32_16x16x64_bf16 v[28:31], v[100:103], v[136:143], v1
  ds_read_b128 v[56:59], v5 offset:6144
  s_waitcnt lgkmcnt(6)
  v_mfma_f32_16x16x32_bf16 v[20:23], v[64:67], v[64:67], v[20:23]
  ds_read_b128 v[60:63], v5 offset:7168
  ds_read_b128 v[112:115], v90 offset:0
  v_mfma_f32_16x16x32_bf16 v[20:23], v[68:71], v[68:71], v[20:23]
  s_waitcnt lgkmcnt(4)
  v_cvt_pk_bf16_f32 v110, v28, v29
  v_cvt_pk_bf16_f32 v111, v30, v31
  v_mfma_f32_16x16x32_bf16 v[20:23], v[72:75], v[72:75], v[20:23]
  buffer_store_dwordx2 v[110:111], v3, s[4:7], s31 offen offset:2176 sc1
  v_mfma_f32_16x16x32_bf16 v[20:23], v[76:79], v[76:79], v[20:23]
  v_permlane32_swap_b32 v108, v110
  v_mfma_f32_16x16x32_bf16 v[24:27], v[32:35], v[64:67], 0
  v_permlane32_swap_b32 v109, v111
  v_mfma_f32_16x16x32_bf16 v[24:27], v[36:39], v[68:71], v[24:27]
  v_exp_f32 v20, v20
  v_mfma_f32_16x16x32_bf16 v[24:27], v[40:43], v[72:75], v[24:27]
  v_exp_f32 v21, v21
  v_mfma_f32_16x16x32_bf16 v[24:27], v[44:47], v[76:79], v[24:27]
  s_waitcnt lgkmcnt(1)
  v_exp_f32 v22, v22
  v_mfma_f32_16x16x32_bf16 v[80:83], v[48:51], v[64:67], 0
  v_exp_f32 v23, v23
  v_mfma_f32_16x16x32_bf16 v[80:83], v[52:55], v[68:71], v[80:83]
  v_exp_f32 v24, v24
  v_mfma_f32_16x16x32_bf16 v[80:83], v[56:59], v[72:75], v[80:83]
  v_exp_f32 v25, v25
  v_mfma_f32_16x16x32_bf16 v[80:83], v[60:63], v[76:79], v[80:83]
  v_exp_f32 v26, v26
  v_exp_f32 v27, v27
  v_cvt_pk_bf16_f32 v88, v20, v21
  v_cvt_pk_bf16_f32 v89, v22, v23
  v_cvt_pk_bf16_f32 v84, v24, v25
  v_cvt_pk_bf16_f32 v85, v26, v27
  v_mfma_f32_16x16x16_bf16 v[100:103], v[104:105], v[88:89], 0
  v_exp_f32 v80, v80
  v_mfma_f32_16x16x16_bf16 v[92:95], v[108:109], v[88:89], 0
  v_exp_f32 v81, v81
  v_mfma_f32_16x16x16_bf16 v[96:99], v[110:111], v[88:89], 0
  v_exp_f32 v82, v82
  v_exp_f32 v83, v83
  v_cvt_pk_bf16_f32 v86, v80, v81
  v_cvt_pk_bf16_f32 v87, v82, v83
  s_waitcnt vmcnt(6)
  v_mov_b64 v[20:21], 0
  v_mfma_f32_16x16x32_bf16 v[100:103], v[104:107], v[84:87], v[100:103]
  ds_read_b128 v[116:119], v90 offset:1024
  ds_read_b128 v[120:123], v90 offset:32768
  v_mfma_f32_16x16x32_bf16 v[92:95], v[12:15], v[84:87], v[92:95]
  ds_read_b128 v[124:127], v90 offset:33792
  ds_read_b128 v[32:35], v90 offset:2048
  v_mfma_f32_16x16x32_bf16 v[96:99], v[16:19], v[84:87], v[96:99]
  v_rcp_f32 v91, v100
  v_mov_b64 v[22:23], 0
  v_mul_f32 v92, v91, v92
  v_mov_b32_dpp v91, v91 row_ror:8 row_mask:0xf bank_mask:0xc
  v_mul_f32 v93, v91, v93
  v_mul_f32 v94, v91, v94
  v_mul_f32 v95, v91, v95
  v_mul_f32_dpp v92, v96, v91 row_ror:8 row_mask:0xf bank_mask:0xc
  v_mul_f32_dpp v93, v97, v91 row_ror:8 row_mask:0xf bank_mask:0xc
  v_mul_f32_dpp v94, v98, v91 row_ror:8 row_mask:0xf bank_mask:0xc
  v_mul_f32_dpp v95, v99, v91 row_ror:8 row_mask:0xf bank_mask:0xc
  v_cvt_pk_bf16_f32 v92, v92, v93
  v_cvt_pk_bf16_f32 v93, v94, v95
  ds_write_b64 v6, v[92:93] offset:28928
  v_subrev_u32 v91, 864026624, v91
  v_cmp_le_u32 vcc, s32, v91
  v_mov_b32_dpp v94, v92 row_ror:8 row_mask:0xf bank_mask:0xf
  v_mov_b32_dpp v95, v93 row_ror:8 row_mask:0xf bank_mask:0xf
  v_mov_b64 v[24:25], 0
  v_mov_b64 v[26:27], 0
  v_mov_b64 v[80:81], 0
  v_mov_b64 v[82:83], 0
  v_mov_b64 v[28:29], 0
  v_mov_b64 v[30:31], 0
  v_xor_b32 v5, 8192, v5
  s_cbranch_vccnz R_slow
R1_slowret:
  v_smfmac_f32_16x16x64_bf16 v[20:23], v[92:95], v[192:199], v1
  s_waitcnt lgkmcnt(0)
  s_barrier
  ds_read_b128 v[96:99], v2 offset:28928
  ds_read_b128 v[100:103], v2 offset:30464
  ds_read_b128 v[84:87], v2 offset:29952
  v_smfmac_f32_16x16x64_bf16 v[24:27], v[92:95], v[200:207], v1
  v_smfmac_f32_16x16x64_bf16 v[80:83], v[92:95], v[208:215], v1
  ds_read_b128 v[36:39], v90 offset:3072
  v_smfmac_f32_16x16x64_bf16 v[28:31], v[92:95], v[216:223], v1
  ds_read_b128 v[40:43], v90 offset:34816
  s_waitcnt lgkmcnt(4)
  v_smfmac_f32_16x16x64_bf16 v[20:23], v[96:99], v[224:231], v1
  ds_read_b128 v[44:47], v90 offset:35840
  s_waitcnt lgkmcnt(4)
  v_smfmac_f32_16x16x64_bf16 v[20:23], v[100:103], v[112:119], v1
  ds_read_b128 v[48:51], v90 offset:4096
  s_waitcnt lgkmcnt(4)
  v_smfmac_f32_16x16x64_bf16 v[20:23], v[84:87], v[120:127], v1
  ds_read_b128 v[52:55], v90 offset:5120
  ds_read_b128 v[56:59], v90 offset:36864
  v_smfmac_f32_16x16x64_bf16 v[24:27], v[96:99], v[232:239], v1
  ds_read_b128 v[60:63], v90 offset:37888
  ds_read_b128 v[64:67], v90 offset:6144
  s_waitcnt lgkmcnt(5)
  v_cvt_pk_bf16_f32 v20, v20, v21
  v_cvt_pk_bf16_f32 v21, v22, v23
  v_and_or_b32 v20, v20, -2, s25
  v_smfmac_f32_16x16x64_bf16 v[24:27], v[100:103], v[32:39], v1
  buffer_store_dwordx2 v[20:21], v9, s[4:7], s51 offen offset:0
  v_smfmac_f32_16x16x64_bf16 v[24:27], v[84:87], v[40:47], v1
  ds_read_b128 v[68:71], v90 offset:7168
  ds_read_b128 v[72:75], v90 offset:38912
  v_smfmac_f32_16x16x64_bf16 v[80:83], v[96:99], v[240:247], v1
  s_add_u32 s19, s19, 1
  ds_read_b128 v[76:79], v90 offset:39936
  s_waitcnt lgkmcnt(4)
  v_smfmac_f32_16x16x64_bf16 v[80:83], v[100:103], v[48:55], v1
  s_and_b32 s20, s19, 3
  s_lshl_b32 s20, s20, 13
  v_cvt_pk_bf16_f32 v24, v24, v25
  v_cvt_pk_bf16_f32 v25, v26, v27
  v_and_or_b32 v24, v24, -2, s25
  v_smfmac_f32_16x16x64_bf16 v[80:83], v[84:87], v[56:63], v1
  s_add_u32 s28, s20, s37
  buffer_store_dwordx2 v[24:25], v9, s[4:7], s51 offen offset:2048
  v_smfmac_f32_16x16x64_bf16 v[28:31], v[96:99], v[248:255], v1
  s_add_u32 s27, s20, 84934656
  s_waitcnt lgkmcnt(0)
  v_smfmac_f32_16x16x64_bf16 v[28:31], v[100:103], v[64:71], v1
  v_cvt_pk_bf16_f32 v80, v80, v81
  v_cvt_pk_bf16_f32 v81, v82, v83
  v_and_or_b32 v80, v80, -2, s25
  v_smfmac_f32_16x16x64_bf16 v[28:31], v[84:87], v[72:79], v1
  buffer_store_dwordx2 v[80:81], v9, s[4:7], s24 offen offset:0
  v_mov_b32 v104, 0x3f80
  v_cndmask_b32 v104, v104, 1.0, s[38:39]
  v_cndmask_b32 v100, 0, v104, s[40:41]
  v_cndmask_b32 v101, 0, v104, s[42:43]
  s_nop 1
  v_cvt_pk_bf16_f32 v28, v28, v29
  v_cvt_pk_bf16_f32 v29, v30, v31
  v_and_or_b32 v28, v28, -2, s25
  buffer_store_dwordx2 v[28:29], v9, s[4:7], s24 offen offset:2048
  v_cndmask_b32 v102, 0, v104, s[44:45]
  v_cndmask_b32 v103, 0, v104, s[46:47]
  v_lshrrev_b32 v98, 6, v5
  v_xnor_b32 v98, s19, v98
  v_mov_b64 v[20:21], 0
  v_mov_b64 v[22:23], 0
  v_mov_b64 v[24:25], 0
  v_mov_b64 v[26:27], 0
  v_mov_b64 v[28:29], 0
  v_mov_b64 v[30:31], 0
  s_waitcnt vmcnt(1)
  buffer_load_dwordx4 v[112:115], v0, s[4:7], s3 offen sc1
  buffer_load_dwordx4 v[116:119], v0, s[4:7], s3 offen offset:1024 sc1
  ds_read_b128 v[32:35], v7 offset:0
  ds_read_b128 v[36:39], v7 offset:1024
  ds_read_b128 v[40:43], v7 offset:2048
  ds_read_b128 v[44:47], v7 offset:3072
  ds_read_b128 v[48:51], v7 offset:4096
  ds_read_b128 v[52:55], v7 offset:5120
  ds_read_b128 v[56:59], v7 offset:6144
  ds_read_b128 v[60:63], v7 offset:7168
  s_waitcnt vmcnt(1)
  v_mfma_f32_16x16x32_bf16 v[104:107], v[100:103], v[112:115], 0
  v_bitop3_b32 v96, v112, v114, v98 bitop3:0x7e
  s_waitcnt vmcnt(0)
  v_mfma_f32_16x16x32_bf16 v[104:107], v[100:103], v[116:119], v[104:107]
  v_bitop3_b32 v97, v116, v118, v98 bitop3:0x7e
  v_bitop3_b32 v96, v96, v97, 1 bitop3:0xa8
  v_cmp_ne_u32 vcc, 0, v96
  s_cbranch_vccnz R1_red2
R1_redok:
  v_add_f32_dpp v104, v104, v104 row_ror:8 row_mask:0xf bank_mask:0xf
  v_add_f32_dpp v105, v105, v105 row_ror:8 row_mask:0xf bank_mask:0xf
  s_nop 0
  v_add_f32_dpp v104, v104, v104 row_ror:4 row_mask:0xf bank_mask:0xf
  v_add_f32_dpp v105, v105, v105 row_ror:4 row_mask:0xf bank_mask:0xf
  v_cvt_pk_bf16_f32 v104, v104, v105
  s_mov_b64 exec, s[48:49]
  buffer_store_dword v104, v10, s[4:7], s28 offen
  s_mov_b64 exec, -1
  s_branch R1_top
R1_red2:
  buffer_load_dwordx4 v[112:115], v0, s[4:7], s3 offen sc1
  buffer_load_dwordx4 v[116:119], v0, s[4:7], s3 offen offset:1024 sc1
  s_add_u32 s56, s56, 1
  s_waitcnt vmcnt(1)
  v_mfma_f32_16x16x32_bf16 v[104:107], v[100:103], v[112:115], 0
  v_bitop3_b32 v96, v112, v114, v98 bitop3:0x7e
  s_waitcnt vmcnt(0)
  v_mfma_f32_16x16x32_bf16 v[104:107], v[100:103], v[116:119], v[104:107]
  v_bitop3_b32 v97, v116, v118, v98 bitop3:0x7e
  v_bitop3_b32 v96, v96, v97, 1 bitop3:0xa8
  v_cmp_ne_u32 vcc, 0, v96
  s_cbranch_vccz R1_redok
  s_cmp_lt_u32 s56, 0x40000
  s_cbranch_scc1 R1_red2
  s_endpgm
R1_pollB:
  buffer_load_dwordx4 v[120:123], v0, s[4:7], s27 offen sc1
  buffer_load_dwordx4 v[124:127], v0, s[4:7], s27 offen offset:1024 sc1
  s_sub_u32 s18, s18, 1
  s_cmp_gt_i32 s18, 0
  s_cbranch_scc1 R1_poll
  s_endpgm
  .p2align 4
R2_top:
  s_xor_b32 s25, s19, s17
  s_and_b32 s25, s25, 1
  s_lshl_b32 s23, s17, 13
  s_add_u32 s20, s19, 3
  s_and_b32 s20, s20, 3
  s_lshl_b32 s29, s20, 13
  s_add_u32 s29, s29, s37
  s_add_u32 s31, s30, 67108864
  s_add_u32 s52, s30, 33554432
  s_add_u32 s21, s19, 1
  s_min_u32 s21, s21, 63
  s_lshl_b32 s21, s21, 18
  s_add_u32 s30, s21, s23
  s_add_u32 s54, s30, 16777216
  s_lshl_b32 s22, s16, 11
  s_add_u32 s55, s30, s22
  s_add_u32 s55, s55, 33554432
  s_xor_b32 s33, s33, 8192
  s_mov_b32 m0, s33
  s_cmp_eq_u32 s19, 63
  buffer_load_dwordx4 v[112:115], v0, s[4:7], s27 offen sc1
  buffer_load_dwordx4 v[116:119], v0, s[4:7], s27 offen offset:1024 sc1
  s_cselect_b32 s32, 0, 402653184
  v_lshlrev_b32 v100, 3, v5
  v_and_b32 v100, 0x7ff, v100
  v_mov_b32 v101, -1
  s_nop 0
  s_nop 0
  s_nop 0
  s_nop 0
  s_nop 0
  s_nop 0
  s_nop 0
  s_nop 0
  s_nop 0
  s_nop 0
  s_nop 0
  s_nop 0
  s_nop 0
  s_nop 0
  s_nop 0
  s_nop 0
  s_nop 0
  s_nop 0
  s_nop 0
  s_nop 0
  s_nop 0
  s_nop 0
  s_nop 0
  s_nop 0
  s_nop 0
  s_nop 0
  buffer_load_dwordx4 v[120:123], v0, s[4:7], s27 offen sc1
  buffer_load_dwordx4 v[124:127], v0, s[4:7], s27 offen offset:1024 sc1
R2_poll:
  s_waitcnt vmcnt(3)
  v_max3_u32 v96, v112, v113, v114
  v_max_u32 v96, v96, v115
  s_waitcnt vmcnt(2) lgkmcnt(0)
  v_max3_u32 v96, v96, v116, v117
  v_max3_u32 v96, v96, v118, v119
  v_cmp_eq_u32 vcc, -1, v96
  v_mov_b64 v[64:65], v[112:113]
  v_mov_b64 v[66:67], v[114:115]
  v_mov_b64 v[72:73], v[116:117]
  v_mov_b64 v[74:75], v[118:119]
  s_cbranch_vccz R2_loop
  buffer_load_dwordx4 v[112:115], v0, s[4:7], s27 offen sc1
  buffer_load_dwordx4 v[116:119], v0, s[4:7], s27 offen offset:1024 sc1
  s_waitcnt vmcnt(3)
  v_max3_u32 v96, v120, v121, v122
  v_max_u32 v96, v96, v123
  s_waitcnt vmcnt(2) lgkmcnt(0)
  v_max3_u32 v96, v96, v124, v125
  v_max3_u32 v96, v96, v126, v127
  v_cmp_eq_u32 vcc, -1, v96
  v_mov_b64 v[64:65], v[120:121]
  v_mov_b64 v[66:67], v[122:123]
  v_mov_b64 v[72:73], v[124:125]
  v_mov_b64 v[74:75], v[126:127]
  s_cbranch_vccnz R2_pollB
R2_loop:
  v_smfmac_f32_16x16x64_bf16 v[20:23], v[64:67], v[32:39], v1
  ds_write_b128 v0, v[64:67] offset:16384
  v_smfmac_f32_16x16x64_bf16 v[20:23], v[72:75], v[48:55], v1
  ds_write_b128 v0, v[72:75] offset:17408
  v_smfmac_f32_16x16x64_bf16 v[24:27], v[64:67], a[96:103], v1
  buffer_load_dwordx4 v[12:15], v0, s[4:7], s52 offen offset:0 sc1
  v_mov_b32_dpp v68, v64 row_ror:8 row_mask:0xf bank_mask:0xf
  v_smfmac_f32_16x16x64_bf16 v[24:27], v[72:75], a[112:119], v1
  v_mov_b32_dpp v69, v65 row_ror:8 row_mask:0xf bank_mask:0xf
  v_mov_b32_dpp v70, v66 row_ror:8 row_mask:0xf bank_mask:0xf
  v_smfmac_f32_16x16x64_bf16 v[28:31], v[64:67], a[192:199], v1
  buffer_load_dwordx4 v[16:19], v0, s[4:7], s52 offen offset:1024 sc1
  v_mov_b32_dpp v71, v67 row_ror:8 row_mask:0xf bank_mask:0xf
  v_smfmac_f32_16x16x64_bf16 v[28:31], v[72:75], a[208:215], v1
  v_mov_b32_dpp v76, v72 row_ror:8 row_mask:0xf bank_mask:0xf
  v_mov_b32_dpp v77, v73 row_ror:8 row_mask:0xf bank_mask:0xf
  v_smfmac_f32_16x16x64_bf16 v[20:23], v[68:71], v[40:47], v1
  s_waitcnt lgkmcnt(0)
  s_barrier
  ds_read_b128 v[80:83], v2 offset:22528
  v_smfmac_f32_16x16x64_bf16 v[24:27], v[68:71], a[104:111], v1
  ds_read_b128 v[84:87], v2 offset:23040
  v_mov_b32_dpp v78, v74 row_ror:8 row_mask:0xf bank_mask:0xf
  v_mov_b32_dpp v79, v75 row_ror:8 row_mask:0xf bank_mask:0xf
  v_smfmac_f32_16x16x64_bf16 v[28:31], v[68:71], a[200:207], v1
  s_mov_b64 exec, 0xffff
  buffer_load_dword v8, v100, s[4:7], s55 offen sc1
  s_mov_b64 exec, -1
  v_smfmac_f32_16x16x64_bf16 v[20:23], v[76:79], v[56:63], v1
  ds_read_b128 v[88:91], v2 offset:23552
  ds_read_b128 v[92:95], v2 offset:24064
  v_smfmac_f32_16x16x64_bf16 v[24:27], v[76:79], a[120:127], v1
  ds_read_b128 v[96:99], v2 offset:16384
  buffer_store_dword v101, v10, s[4:7], s29 offen
  v_smfmac_f32_16x16x64_bf16 v[28:31], v[76:79], a[216:223], v1
  ds_read_b128 v[100:103], v2 offset:16896
  s_waitcnt lgkmcnt(5)
  v_smfmac_f32_16x16x64_bf16 v[20:23], v[80:83], a[0:7], v1
  s_waitcnt lgkmcnt(4)
  ds_read_b128 v[104:107], v2 offset:17408
  buffer_load_dwordx4 v0, s[4:7], s54 offen sc1 lds
  v_smfmac_f32_16x16x64_bf16 v[20:23], v[84:87], a[8:15], v1
  s_waitcnt lgkmcnt(4) vmcnt(5)
  ds_read_b128 v[108:111], v2 offset:17920
  v_smfmac_f32_16x16x64_bf16 v[20:23], v[88:91], a[16:23], v1
  ds_read_b128 v[112:115], v2 offset:18432
  buffer_load_dwordx4 v0, s[4:7], s54 offen offset:1024 sc1 lds
  v_smfmac_f32_16x16x64_bf16 v[24:27], v[80:83], a[128:135], v1
  s_waitcnt lgkmcnt(5)
  ds_read_b128 v[116:119], v2 offset:18944
  v_smfmac_f32_16x16x64_bf16 v[20:23], v[92:95], a[24:31], v1
  s_waitcnt lgkmcnt(5)
  ds_read_b128 v[120:123], v2 offset:19456
  v_smfmac_f32_16x16x64_bf16 v[20:23], v[96:99], a[32:39], v1
  s_waitcnt lgkmcnt(5)
  ds_read_b128 v[124:127], v2 offset:19968
  v_smfmac_f32_16x16x64_bf16 v[20:23], v[100:103], a[40:47], v1
  ds_read_b128 v[32:35], v7 offset:32768
  v_smfmac_f32_16x16x64_bf16 v[24:27], v[84:87], a[136:143], v1
  s_waitcnt lgkmcnt(6)
  ds_read_b128 v[36:39], v7 offset:33792
  v_smfmac_f32_16x16x64_bf16 v[20:23], v[104:107], a[48:55], v1
  s_waitcnt lgkmcnt(6)
  ds_read_b128 v[40:43], v7 offset:34816
  v_smfmac_f32_16x16x64_bf16 v[20:23], v[108:111], a[56:63], v1
  s_waitcnt lgkmcnt(6)
  ds_read_b128 v[44:47], v7 offset:35840
  v_smfmac_f32_16x16x64_bf16 v[20:23], v[112:115], a[64:71], v1
  ds_read_b128 v[48:51], v7 offset:36864
  v_smfmac_f32_16x16x64_bf16 v[24:27], v[88:91], a[144:151], v1
  s_waitcnt lgkmcnt(7)
  ds_read_b128 v[52:55], v7 offset:37888
  v_smfmac_f32_16x16x64_bf16 v[20:23], v[116:119], a[72:79], v1
  s_waitcnt lgkmcnt(7)
  ds_read_b128 v[56:59], v7 offset:38912
  v_smfmac_f32_16x16x64_bf16 v[20:23], v[120:123], a[80:87], v1
  s_waitcnt lgkmcnt(7)
  ds_read_b128 v[60:63], v7 offset:39936
  v_smfmac_f32_16x16x64_bf16 v[20:23], v[124:127], a[88:95], v1
  v_smfmac_f32_16x16x64_bf16 v[24:27], v[92:95], a[152:159], v1
  v_smfmac_f32_16x16x64_bf16 v[24:27], v[96:99], a[160:167], v1
  v_mul_f32 v20, s50, v20
  v_smfmac_f32_16x16x64_bf16 v[24:27], v[100:103], a[168:175], v1
  v_mul_f32 v21, s50, v21
  v_smfmac_f32_16x16x64_bf16 v[24:27], v[104:107], a[176:183], v1
  v_mul_f32 v22, s50, v22
  v_smfmac_f32_16x16x64_bf16 v[24:27], v[108:111], a[184:191], v1
  s_waitcnt lgkmcnt(0)
  v_mul_f32 v23, s50, v23
  v_smfmac_f32_16x16x64_bf16 v[24:27], v[112:115], v[32:39], v1
  v_cvt_pk_bf16_f32 v20, v20, v21
  v_smfmac_f32_16x16x64_bf16 v[24:27], v[116:119], v[40:47], v1
  ds_read_b128 v[32:35], v5 offset:0
  v_cvt_pk_bf16_f32 v21, v22, v23
  v_smfmac_f32_16x16x64_bf16 v[24:27], v[120:123], v[48:55], v1
  ds_write_b64 v3, v[20:21] offset:24576
  v_smfmac_f32_16x16x64_bf16 v[24:27], v[124:127], v[56:63], v1
  ds_read_b128 v[36:39], v5 offset:1024
  v_mov_b32 v20, v11
  v_smfmac_f32_16x16x64_bf16 v[28:31], v[84:87], a[232:239], v1
  v_mov_b32 v21, v11
  v_mov_b64 v[22:23], v[20:21]
  v_cvt_pk_bf16_f32 v84, v24, v25
  v_cvt_pk_bf16_f32 v85, v26, v27
  v_smfmac_f32_16x16x64_bf16 v[28:31], v[80:83], a[224:231], v1
  ds_write_b64 v3, v[84:85] offset:26752
  v_smfmac_f32_16x16x64_bf16 v[28:31], v[104:107], v[144:151], v1
  buffer_store_dwordx2 v[84:85], v3, s[4:7], s31 offen sc1
  v_smfmac_f32_16x16x64_bf16 v[28:31], v[108:111], v[152:159], v1
  ds_read_b128 v[40:43], v5 offset:2048
  v_mov_b32 v104, 0x3f803f80
  v_smfmac_f32_16x16x64_bf16 v[28:31], v[88:91], a[240:247], v1
  ds_read_b128 v[44:47], v5 offset:3072
  v_mov_b32 v105, 0x3f803f80
  v_smfmac_f32_16x16x64_bf16 v[28:31], v[112:115], v[160:167], v1
  ds_read_b128 v[48:51], v5 offset:4096
  v_add_u32 v90, 0x10000, v7
  v_smfmac_f32_16x16x64_bf16 v[28:31], v[116:119], v[168:175], v1
  s_waitcnt lgkmcnt(3)
  s_barrier
  ds_read_b64_tr_b16 v[64:65], v4 offset:24576
  ds_read_b64_tr_b16 v[66:67], v4 offset:24704
  v_smfmac_f32_16x16x64_bf16 v[28:31], v[120:123], v[176:183], v1
  ds_read_b64_tr_b16 v[68:69], v4 offset:24832
  ds_read_b64_tr_b16 v[70:71], v4 offset:24960
  v_smfmac_f32_16x16x64_bf16 v[28:31], v[124:127], v[184:191], v1
  ds_read_b64_tr_b16 v[72:73], v4 offset:25088
  ds_read_b64_tr_b16 v[74:75], v4 offset:25216
  v_smfmac_f32_16x16x64_bf16 v[28:31], v[92:95], a[248:255], v1
  ds_read_b64_tr_b16 v[76:77], v4 offset:25344
  ds_read_b64_tr_b16 v[78:79], v4 offset:25472
  v_smfmac_f32_16x16x64_bf16 v[28:31], v[96:99], v[128:135], v1
  ds_read_b128 v[52:55], v5 offset:5120
  v_mov_b64 v[106:107], v[104:105]
  v_smfmac_f32_16x16x64_bf16 v[28:31], v[100:103], v[136:143], v1
  ds_read_b128 v[56:59], v5 offset:6144
  s_waitcnt lgkmcnt(6)
  v_mfma_f32_16x16x32_bf16 v[20:23], v[64:67], v[64:67], v[20:23]
  ds_read_b128 v[60:63], v5 offset:7168
  ds_read_b128 v[112:115], v90 offset:0
  v_mfma_f32_16x16x32_bf16 v[20:23], v[68:71], v[68:71], v[20:23]
  s_waitcnt lgkmcnt(4)
  v_cvt_pk_bf16_f32 v110, v28, v29
  v_cvt_pk_bf16_f32 v111, v30, v31
  v_mfma_f32_16x16x32_bf16 v[20:23], v[72:75], v[72:75], v[20:23]
  buffer_store_dwordx2 v[110:111], v3, s[4:7], s31 offen offset:2176 sc1
  v_mfma_f32_16x16x32_bf16 v[20:23], v[76:79], v[76:79], v[20:23]
  v_permlane32_swap_b32 v108, v110
  v_mfma_f32_16x16x32_bf16 v[24:27], v[32:35], v[64:67], 0
  v_permlane32_swap_b32 v109, v111
  v_mfma_f32_16x16x32_bf16 v[24:27], v[36:39], v[68:71], v[24:27]
  v_exp_f32 v20, v20
  v_mfma_f32_16x16x32_bf16 v[24:27], v[40:43], v[72:75], v[24:27]
  v_exp_f32 v21, v21
  v_mfma_f32_16x16x32_bf16 v[24:27], v[44:47], v[76:79], v[24:27]
  s_waitcnt lgkmcnt(1)
  v_exp_f32 v22, v22
  v_mfma_f32_16x16x32_bf16 v[80:83], v[48:51], v[64:67], 0
  v_exp_f32 v23, v23
  v_mfma_f32_16x16x32_bf16 v[80:83], v[52:55], v[68:71], v[80:83]
  v_exp_f32 v24, v24
  v_mfma_f32_16x16x32_bf16 v[80:83], v[56:59], v[72:75], v[80:83]
  v_exp_f32 v25, v25
  v_mfma_f32_16x16x32_bf16 v[80:83], v[60:63], v[76:79], v[80:83]
  v_exp_f32 v26, v26
  v_exp_f32 v27, v27
  v_cvt_pk_bf16_f32 v88, v20, v21
  v_cvt_pk_bf16_f32 v89, v22, v23
  v_cvt_pk_bf16_f32 v84, v24, v25
  v_cvt_pk_bf16_f32 v85, v26, v27
  v_mfma_f32_16x16x16_bf16 v[100:103], v[104:105], v[88:89], 0
  v_exp_f32 v80, v80
  v_mfma_f32_16x16x16_bf16 v[92:95], v[108:109], v[88:89], 0
  v_exp_f32 v81, v81
  v_mfma_f32_16x16x16_bf16 v[96:99], v[110:111], v[88:89], 0
  v_exp_f32 v82, v82
  v_exp_f32 v83, v83
  v_cvt_pk_bf16_f32 v86, v80, v81
  v_cvt_pk_bf16_f32 v87, v82, v83
  s_waitcnt vmcnt(6)
  v_mov_b64 v[20:21], 0
  v_mfma_f32_16x16x32_bf16 v[100:103], v[104:107], v[84:87], v[100:103]
  ds_read_b128 v[116:119], v90 offset:1024
  ds_read_b128 v[120:123], v90 offset:32768
  v_mfma_f32_16x16x32_bf16 v[92:95], v[12:15], v[84:87], v[92:95]
  ds_read_b128 v[124:127], v90 offset:33792
  ds_read_b128 v[32:35], v90 offset:2048
  v_mfma_f32_16x16x32_bf16 v[96:99], v[16:19], v[84:87], v[96:99]
  v_rcp_f32 v91, v100
  v_mov_b64 v[22:23], 0
  v_mul_f32 v92, v91, v92
  v_mov_b32_dpp v91, v91 row_ror:8 row_mask:0xf bank_mask:0xc
  v_mul_f32 v93, v91, v93
  v_mul_f32 v94, v91, v94
  v_mul_f32 v95, v91, v95
  v_mul_f32_dpp v92, v96, v91 row_ror:8 row_mask:0xf bank_mask:0xc
  v_mul_f32_dpp v93, v97, v91 row_ror:8 row_mask:0xf bank_mask:0xc
  v_mul_f32_dpp v94, v98, v91 row_ror:8 row_mask:0xf bank_mask:0xc
  v_mul_f32_dpp v95, v99, v91 row_ror:8 row_mask:0xf bank_mask:0xc
  v_cvt_pk_bf16_f32 v92, v92, v93
  v_cvt_pk_bf16_f32 v93, v94, v95
  ds_write_b64 v6, v[92:93] offset:28928
  v_subrev_u32 v91, 864026624, v91
  v_cmp_le_u32 vcc, s32, v91
  v_mov_b32_dpp v94, v92 row_ror:8 row_mask:0xf bank_mask:0xf
  v_mov_b32_dpp v95, v93 row_ror:8 row_mask:0xf bank_mask:0xf
  v_mov_b64 v[24:25], 0
  v_mov_b64 v[26:27], 0
  v_mov_b64 v[80:81], 0
  v_mov_b64 v[82:83], 0
  v_mov_b64 v[28:29], 0
  v_mov_b64 v[30:31], 0
  v_xor_b32 v5, 8192, v5
  s_cbranch_vccnz R_slow
R2_slowret:
  v_smfmac_f32_16x16x64_bf16 v[20:23], v[92:95], v[192:199], v1
  s_waitcnt lgkmcnt(0)
  s_barrier
  ds_read_b128 v[96:99], v2 offset:30464
  ds_read_b128 v[100:103], v2 offset:28928
  ds_read_b128 v[84:87], v2 offset:29440
  v_smfmac_f32_16x16x64_bf16 v[24:27], v[92:95], v[200:207], v1
  v_smfmac_f32_16x16x64_bf16 v[80:83], v[92:95], v[208:215], v1
  ds_read_b128 v[36:39], v90 offset:3072
  v_smfmac_f32_16x16x64_bf16 v[28:31], v[92:95], v[216:223], v1
  ds_read_b128 v[40:43], v90 offset:34816
  s_waitcnt lgkmcnt(4)
  v_smfmac_f32_16x16x64_bf16 v[20:23], v[96:99], v[224:231], v1
  ds_read_b128 v[44:47], v90 offset:35840
  s_waitcnt lgkmcnt(4)
  v_smfmac_f32_16x16x64_bf16 v[20:23], v[100:103], v[112:119], v1
  ds_read_b128 v[48:51], v90 offset:4096
  s_waitcnt lgkmcnt(4)
  v_smfmac_f32_16x16x64_bf16 v[20:23], v[84:87], v[120:127], v1
  ds_read_b128 v[52:55], v90 offset:5120
  ds_read_b128 v[56:59], v90 offset:36864
  v_smfmac_f32_16x16x64_bf16 v[24:27], v[96:99], v[232:239], v1
  ds_read_b128 v[60:63], v90 offset:37888
  ds_read_b128 v[64:67], v90 offset:6144
  s_waitcnt lgkmcnt(5)
  v_cvt_pk_bf16_f32 v20, v20, v21
  v_cvt_pk_bf16_f32 v21, v22, v23
  v_and_or_b32 v20, v20, -2, s25
  v_smfmac_f32_16x16x64_bf16 v[24:27], v[100:103], v[32:39], v1
  buffer_store_dwordx2 v[20:21], v9, s[4:7], s51 offen offset:0
  v_smfmac_f32_16x16x64_bf16 v[24:27], v[84:87], v[40:47], v1
  ds_read_b128 v[68:71], v90 offset:7168
  ds_read_b128 v[72:75], v90 offset:38912
  v_smfmac_f32_16x16x64_bf16 v[80:83], v[96:99], v[240:247], v1
  s_add_u32 s19, s19, 1
  ds_read_b128 v[76:79], v90 offset:39936
  s_waitcnt lgkmcnt(4)
  v_smfmac_f32_16x16x64_bf16 v[80:83], v[100:103], v[48:55], v1
  s_and_b32 s20, s19, 3
  s_lshl_b32 s20, s20, 13
  v_cvt_pk_bf16_f32 v24, v24, v25
  v_cvt_pk_bf16_f32 v25, v26, v27
  v_and_or_b32 v24, v24, -2, s25
  v_smfmac_f32_16x16x64_bf16 v[80:83], v[84:87], v[56:63], v1
  s_add_u32 s28, s20, s37
  buffer_store_dwordx2 v[24:25], v9, s[4:7], s51 offen offset:2048
  v_smfmac_f32_16x16x64_bf16 v[28:31], v[96:99], v[248:255], v1
  s_add_u32 s27, s20, 84934656
  s_waitcnt lgkmcnt(0)
  v_smfmac_f32_16x16x64_bf16 v[28:31], v[100:103], v[64:71], v1
  v_cvt_pk_bf16_f32 v80, v80, v81
  v_cvt_pk_bf16_f32 v81, v82, v83
  v_and_or_b32 v80, v80, -2, s25
  v_smfmac_f32_16x16x64_bf16 v[28:31], v[84:87], v[72:79], v1
  buffer_store_dwordx2 v[80:81], v9, s[4:7], s24 offen offset:0
  v_mov_b32 v104, 0x3f80
  v_cndmask_b32 v104, v104, 1.0, s[38:39]
  v_cndmask_b32 v100, 0, v104, s[40:41]
  v_cndmask_b32 v101, 0, v104, s[42:43]
  s_nop 1
  v_cvt_pk_bf16_f32 v28, v28, v29
  v_cvt_pk_bf16_f32 v29, v30, v31
  v_and_or_b32 v28, v28, -2, s25
  buffer_store_dwordx2 v[28:29], v9, s[4:7], s24 offen offset:2048
  v_cndmask_b32 v102, 0, v104, s[44:45]
  v_cndmask_b32 v103, 0, v104, s[46:47]
  v_lshrrev_b32 v98, 6, v5
  v_xnor_b32 v98, s19, v98
  v_mov_b64 v[20:21], 0
  v_mov_b64 v[22:23], 0
  v_mov_b64 v[24:25], 0
  v_mov_b64 v[26:27], 0
  v_mov_b64 v[28:29], 0
  v_mov_b64 v[30:31], 0
  ds_read_b128 v[32:35], v7 offset:0
  ds_read_b128 v[36:39], v7 offset:1024
  ds_read_b128 v[40:43], v7 offset:2048
  ds_read_b128 v[44:47], v7 offset:3072
  ds_read_b128 v[48:51], v7 offset:4096
  ds_read_b128 v[52:55], v7 offset:5120
  ds_read_b128 v[56:59], v7 offset:6144
  ds_read_b128 v[60:63], v7 offset:7168
  s_waitcnt vmcnt(1)
  buffer_load_dwordx4 v[112:115], v0, s[4:7], s3 offen sc1
  buffer_load_dwordx4 v[116:119], v0, s[4:7], s3 offen offset:1024 sc1
  s_waitcnt vmcnt(2)
  buffer_load_dwordx4 v[120:123], v0, s[4:7], s3 offen sc1
  buffer_load_dwordx4 v[124:127], v0, s[4:7], s3 offen offset:1024 sc1
  s_waitcnt vmcnt(3)
  v_mfma_f32_16x16x32_bf16 v[104:107], v[100:103], v[112:115], 0
  v_bitop3_b32 v96, v112, v114, v98 bitop3:0x7e
  s_waitcnt vmcnt(2)
  v_mfma_f32_16x16x32_bf16 v[104:107], v[100:103], v[116:119], v[104:107]
  v_bitop3_b32 v97, v116, v118, v98 bitop3:0x7e
  v_bitop3_b32 v96, v96, v97, 1 bitop3:0xa8
  v_cmp_ne_u32 vcc, 0, v96
  s_cbranch_vccz R2_redok
  buffer_load_dwordx4 v[112:115], v0, s[4:7], s3 offen sc1
  buffer_load_dwordx4 v[116:119], v0, s[4:7], s3 offen offset:1024 sc1
  s_waitcnt vmcnt(3)
  v_mfma_f32_16x16x32_bf16 v[104:107], v[100:103], v[120:123], 0
  v_bitop3_b32 v96, v120, v122, v98 bitop3:0x7e
  s_waitcnt vmcnt(2)
  v_mfma_f32_16x16x32_bf16 v[104:107], v[100:103], v[124:127], v[104:107]
  v_bitop3_b32 v97, v124, v126, v98 bitop3:0x7e
  v_bitop3_b32 v96, v96, v97, 1 bitop3:0xa8
  v_cmp_ne_u32 vcc, 0, v96
  s_cbranch_vccnz R2_red2
R2_redok:
  v_add_f32_dpp v104, v104, v104 row_ror:8 row_mask:0xf bank_mask:0xf
  v_add_f32_dpp v105, v105, v105 row_ror:8 row_mask:0xf bank_mask:0xf
  s_nop 0
  v_add_f32_dpp v104, v104, v104 row_ror:4 row_mask:0xf bank_mask:0xf
  v_add_f32_dpp v105, v105, v105 row_ror:4 row_mask:0xf bank_mask:0xf
  v_cvt_pk_bf16_f32 v104, v104, v105
  s_mov_b64 exec, s[48:49]
  buffer_store_dword v104, v10, s[4:7], s28 offen
  s_mov_b64 exec, -1
  s_branch R2_top
R2_red2:
  buffer_load_dwordx4 v[120:123], v0, s[4:7], s3 offen sc1
  buffer_load_dwordx4 v[124:127], v0, s[4:7], s3 offen offset:1024 sc1
  s_add_u32 s56, s56, 1
  s_waitcnt vmcnt(3)
  v_mfma_f32_16x16x32_bf16 v[104:107], v[100:103], v[112:115], 0
  v_bitop3_b32 v96, v112, v114, v98 bitop3:0x7e
  s_waitcnt vmcnt(2)
  v_mfma_f32_16x16x32_bf16 v[104:107], v[100:103], v[116:119], v[104:107]
  v_bitop3_b32 v97, v116, v118, v98 bitop3:0x7e
  v_bitop3_b32 v96, v96, v97, 1 bitop3:0xa8
  v_cmp_ne_u32 vcc, 0, v96
  s_cbranch_vccz R2_redok
  buffer_load_dwordx4 v[112:115], v0, s[4:7], s3 offen sc1
  buffer_load_dwordx4 v[116:119], v0, s[4:7], s3 offen offset:1024 sc1
  s_add_u32 s56, s56, 1
  s_waitcnt vmcnt(3)
  v_mfma_f32_16x16x32_bf16 v[104:107], v[100:103], v[120:123], 0
  v_bitop3_b32 v96, v120, v122, v98 bitop3:0x7e
  s_waitcnt vmcnt(2)
  v_mfma_f32_16x16x32_bf16 v[104:107], v[100:103], v[124:127], v[104:107]
  v_bitop3_b32 v97, v124, v126, v98 bitop3:0x7e
  v_bitop3_b32 v96, v96, v97, 1 bitop3:0xa8
  v_cmp_ne_u32 vcc, 0, v96
  s_cbranch_vccz R2_redok
  s_cmp_lt_u32 s56, 0x40000
  s_cbranch_scc1 R2_red2
  s_endpgm
R2_pollB:
  buffer_load_dwordx4 v[120:123], v0, s[4:7], s27 offen sc1
  buffer_load_dwordx4 v[124:127], v0, s[4:7], s27 offen offset:1024 sc1
  s_sub_u32 s18, s18, 1
  s_cmp_gt_i32 s18, 0
  s_cbranch_scc1 R2_poll
  s_endpgm
  .p2align 4
R3_top:
  s_xor_b32 s25, s19, s17
  s_and_b32 s25, s25, 1
  s_lshl_b32 s23, s17, 13
  s_add_u32 s20, s19, 3
  s_and_b32 s20, s20, 3
  s_lshl_b32 s29, s20, 13
  s_add_u32 s29, s29, s37
  s_add_u32 s31, s30, 67108864
  s_add_u32 s52, s30, 33554432
  s_add_u32 s21, s19, 1
  s_min_u32 s21, s21, 63
  s_lshl_b32 s21, s21, 18
  s_add_u32 s30, s21, s23
  s_add_u32 s54, s30, 16777216
  s_lshl_b32 s22, s16, 11
  s_add_u32 s55, s30, s22
  s_add_u32 s55, s55, 33554432
  s_xor_b32 s33, s33, 8192
  s_mov_b32 m0, s33
  s_cmp_eq_u32 s19, 63
  buffer_load_dwordx4 v[112:115], v0, s[4:7], s27 offen sc1
  buffer_load_dwordx4 v[116:119], v0, s[4:7], s27 offen offset:1024 sc1
  s_cselect_b32 s32, 0, 402653184
  v_lshlrev_b32 v100, 3, v5
  v_and_b32 v100, 0x7ff, v100
  v_mov_b32 v101, -1
  s_nop 0
  s_nop 0
  s_nop 0
  s_nop 0
  s_nop 0
  s_nop 0
  s_nop 0
  s_nop 0
  s_nop 0
  s_nop 0
  s_nop 0
  s_nop 0
  s_nop 0
  s_nop 0
  s_nop 0
  s_nop 0
  s_nop 0
  s_nop 0
  s_nop 0
  s_nop 0
  s_nop 0
  s_nop 0
  s_nop 0
  s_nop 0
  s_nop 0
  s_nop 0
  buffer_load_dwordx4 v[120:123], v0, s[4:7], s27 offen sc1
  buffer_load_dwordx4 v[124:127], v0, s[4:7], s27 offen offset:1024 sc1
R3_poll:
  s_waitcnt vmcnt(3)
  v_max3_u32 v96, v112, v113, v114
  v_max_u32 v96, v96, v115
  s_waitcnt vmcnt(2) lgkmcnt(0)
  v_max3_u32 v96, v96, v116, v117
  v_max3_u32 v96, v96, v118, v119
  v_cmp_eq_u32 vcc, -1, v96
  v_mov_b64 v[64:65], v[112:113]
  v_mov_b64 v[66:67], v[114:115]
  v_mov_b64 v[72:73], v[116:117]
  v_mov_b64 v[74:75], v[118:119]
  s_cbranch_vccz R3_loop
  buffer_load_dwordx4 v[112:115], v0, s[4:7], s27 offen sc1
  buffer_load_dwordx4 v[116:119], v0, s[4:7], s27 offen offset:1024 sc1
  s_waitcnt vmcnt(3)
  v_max3_u32 v96, v120, v121, v122
  v_max_u32 v96, v96, v123
  s_waitcnt vmcnt(2) lgkmcnt(0)
  v_max3_u32 v96, v96, v124, v125
  v_max3_u32 v96, v96, v126, v127
  v_cmp_eq_u32 vcc, -1, v96
  v_mov_b64 v[64:65], v[120:121]
  v_mov_b64 v[66:67], v[122:123]
  v_mov_b64 v[72:73], v[124:125]
  v_mov_b64 v[74:75], v[126:127]
  s_cbranch_vccnz R3_pollB
R3_loop:
  v_smfmac_f32_16x16x64_bf16 v[20:23], v[64:67], v[32:39], v1
  ds_write_b128 v0, v[64:67] offset:16384
  v_smfmac_f32_16x16x64_bf16 v[20:23], v[72:75], v[48:55], v1
  ds_write_b128 v0, v[72:75] offset:17408
  v_smfmac_f32_16x16x64_bf16 v[24:27], v[64:67], a[96:103], v1
  buffer_load_dwordx4 v[12:15], v0, s[4:7], s52 offen offset:0 sc1
  v_mov_b32_dpp v68, v64 row_ror:8 row_mask:0xf bank_mask:0xf
  v_smfmac_f32_16x16x64_bf16 v[24:27], v[72:75], a[112:119], v1
  v_mov_b32_dpp v69, v65 row_ror:8 row_mask:0xf bank_mask:0xf
  v_mov_b32_dpp v70, v66 row_ror:8 row_mask:0xf bank_mask:0xf
  v_smfmac_f32_16x16x64_bf16 v[28:31], v[64:67], a[192:199], v1
  buffer_load_dwordx4 v[16:19], v0, s[4:7], s52 offen offset:1024 sc1
  v_mov_b32_dpp v71, v67 row_ror:8 row_mask:0xf bank_mask:0xf
  v_smfmac_f32_16x16x64_bf16 v[28:31], v[72:75], a[208:215], v1
  v_mov_b32_dpp v76, v72 row_ror:8 row_mask:0xf bank_mask:0xf
  v_mov_b32_dpp v77, v73 row_ror:8 row_mask:0xf bank_mask:0xf
  v_smfmac_f32_16x16x64_bf16 v[20:23], v[68:71], v[40:47], v1
  s_waitcnt lgkmcnt(0)
  s_barrier
  ds_read_b128 v[80:83], v2 offset:16384
  v_smfmac_f32_16x16x64_bf16 v[24:27], v[68:71], a[104:111], v1
  ds_read_b128 v[84:87], v2 offset:16896
  v_mov_b32_dpp v78, v74 row_ror:8 row_mask:0xf bank_mask:0xf
  v_mov_b32_dpp v79, v75 row_ror:8 row_mask:0xf bank_mask:0xf
  v_smfmac_f32_16x16x64_bf16 v[28:31], v[68:71], a[200:207], v1
  s_mov_b64 exec, 0xffff
  buffer_load_dword v8, v100, s[4:7], s55 offen sc1
  s_mov_b64 exec, -1
  v_smfmac_f32_16x16x64_bf16 v[20:23], v[76:79], v[56:63], v1
  ds_read_b128 v[88:91], v2 offset:17408
  ds_read_b128 v[92:95], v2 offset:17920
  v_smfmac_f32_16x16x64_bf16 v[24:27], v[76:79], a[120:127], v1
  ds_read_b128 v[96:99], v2 offset:18432
  buffer_store_dword v101, v10, s[4:7], s29 offen
  v_smfmac_f32_16x16x64_bf16 v[28:31], v[76:79], a[216:223], v1
  ds_read_b128 v[100:103], v2 offset:18944
  s_waitcnt lgkmcnt(5)
  v_smfmac_f32_16x16x64_bf16 v[20:23], v[80:83], a[0:7], v1
  s_waitcnt lgkmcnt(4)
  ds_read_b128 v[104:107], v2 offset:19456
  buffer_load_dwordx4 v0, s[4:7], s54 offen sc1 lds
  v_smfmac_f32_16x16x64_bf16 v[20:23], v[84:87], a[8:15], v1
  s_waitcnt lgkmcnt(4) vmcnt(5)
  ds_read_b128 v[108:111], v2 offset:19968
  v_smfmac_f32_16x16x64_bf16 v[20:23], v[88:91], a[16:23], v1
  ds_read_b128 v[112:115], v2 offset:20480
  buffer_load_dwordx4 v0, s[4:7], s54 offen offset:1024 sc1 lds
  v_smfmac_f32_16x16x64_bf16 v[24:27], v[80:83], a[128:135], v1
  s_waitcnt lgkmcnt(5)
  ds_read_b128 v[116:119], v2 offset:20992
  v_smfmac_f32_16x16x64_bf16 v[20:23], v[92:95], a[24:31], v1
  s_waitcnt lgkmcnt(5)
  ds_read_b128 v[120:123], v2 offset:21504
  v_smfmac_f32_16x16x64_bf16 v[20:23], v[96:99], a[32:39], v1
  s_waitcnt lgkmcnt(5)
  ds_read_b128 v[124:127], v2 offset:22016
  v_smfmac_f32_16x16x64_bf16 v[20:23], v[100:103], a[40:47], v1
  ds_read_b128 v[32:35], v7 offset:32768
  v_smfmac_f32_16x16x64_bf16 v[24:27], v[84:87], a[136:143], v1
  s_waitcnt lgkmcnt(6)
  ds_read_b128 v[36:39], v7 offset:33792
  v_smfmac_f32_16x16x64_bf16 v[20:23], v[104:107], a[48:55], v1
  s_waitcnt lgkmcnt(6)
  ds_read_b128 v[40:43], v7 offset:34816
  v_smfmac_f32_16x16x64_bf16 v[20:23], v[108:111], a[56:63], v1
  s_waitcnt lgkmcnt(6)
  ds_read_b128 v[44:47], v7 offset:35840
  v_smfmac_f32_16x16x64_bf16 v[20:23], v[112:115], a[64:71], v1
  ds_read_b128 v[48:51], v7 offset:36864
  v_smfmac_f32_16x16x64_bf16 v[24:27], v[88:91], a[144:151], v1
  s_waitcnt lgkmcnt(7)
  ds_read_b128 v[52:55], v7 offset:37888
  v_smfmac_f32_16x16x64_bf16 v[20:23], v[116:119], a[72:79], v1
  s_waitcnt lgkmcnt(7)
  ds_read_b128 v[56:59], v7 offset:38912
  v_smfmac_f32_16x16x64_bf16 v[20:23], v[120:123], a[80:87], v1
  s_waitcnt lgkmcnt(7)
  ds_read_b128 v[60:63], v7 offset:39936
  v_smfmac_f32_16x16x64_bf16 v[20:23], v[124:127], a[88:95], v1
  v_smfmac_f32_16x16x64_bf16 v[24:27], v[92:95], a[152:159], v1
  v_smfmac_f32_16x16x64_bf16 v[24:27], v[96:99], a[160:167], v1
  v_mul_f32 v20, s50, v20
  v_smfmac_f32_16x16x64_bf16 v[24:27], v[100:103], a[168:175], v1
  v_mul_f32 v21, s50, v21
  v_smfmac_f32_16x16x64_bf16 v[24:27], v[104:107], a[176:183], v1
  v_mul_f32 v22, s50, v22
  v_smfmac_f32_16x16x64_bf16 v[24:27], v[108:111], a[184:191], v1
  s_waitcnt lgkmcnt(0)
  v_mul_f32 v23, s50, v23
  v_smfmac_f32_16x16x64_bf16 v[24:27], v[112:115], v[32:39], v1
  v_cvt_pk_bf16_f32 v20, v20, v21
  v_smfmac_f32_16x16x64_bf16 v[24:27], v[116:119], v[40:47], v1
  ds_read_b128 v[32:35], v5 offset:0
  v_cvt_pk_bf16_f32 v21, v22, v23
  v_smfmac_f32_16x16x64_bf16 v[24:27], v[120:123], v[48:55], v1
  ds_write_b64 v3, v[20:21] offset:24576
  v_smfmac_f32_16x16x64_bf16 v[24:27], v[124:127], v[56:63], v1
  ds_read_b128 v[36:39], v5 offset:1024
  v_mov_b32 v20, v11
  v_smfmac_f32_16x16x64_bf16 v[28:31], v[84:87], a[232:239], v1
  v_mov_b32 v21, v11
  v_mov_b64 v[22:23], v[20:21]
  v_cvt_pk_bf16_f32 v84, v24, v25
  v_cvt_pk_bf16_f32 v85, v26, v27
  v_smfmac_f32_16x16x64_bf16 v[28:31], v[80:83], a[224:231], v1
  ds_write_b64 v3, v[84:85] offset:26752
  v_smfmac_f32_16x16x64_bf16 v[28:31], v[104:107], v[144:151], v1
  buffer_store_dwordx2 v[84:85], v3, s[4:7], s31 offen sc1
  v_smfmac_f32_16x16x64_bf16 v[28:31], v[108:111], v[152:159], v1
  ds_read_b128 v[40:43], v5 offset:2048
  v_mov_b32 v104, 0x3f803f80
  v_smfmac_f32_16x16x64_bf16 v[28:31], v[88:91], a[240:247], v1
  ds_read_b128 v[44:47], v5 offset:3072
  v_mov_b32 v105, 0x3f803f80
  v_smfmac_f32_16x16x64_bf16 v[28:31], v[112:115], v[160:167], v1
  ds_read_b128 v[48:51], v5 offset:4096
  v_add_u32 v90, 0x10000, v7
  v_smfmac_f32_16x16x64_bf16 v[28:31], v[116:119], v[168:175], v1
  s_waitcnt lgkmcnt(3)
  s_barrier
  ds_read_b64_tr_b16 v[64:65], v4 offset:24576
  ds_read_b64_tr_b16 v[66:67], v4 offset:24704
  v_smfmac_f32_16x16x64_bf16 v[28:31], v[120:123], v[176:183], v1
  ds_read_b64_tr_b16 v[68:69], v4 offset:24832
  ds_read_b64_tr_b16 v[70:71], v4 offset:24960
  v_smfmac_f32_16x16x64_bf16 v[28:31], v[124:127], v[184:191], v1
  ds_read_b64_tr_b16 v[72:73], v4 offset:25088
  ds_read_b64_tr_b16 v[74:75], v4 offset:25216
  v_smfmac_f32_16x16x64_bf16 v[28:31], v[92:95], a[248:255], v1
  ds_read_b64_tr_b16 v[76:77], v4 offset:25344
  ds_read_b64_tr_b16 v[78:79], v4 offset:25472
  v_smfmac_f32_16x16x64_bf16 v[28:31], v[96:99], v[128:135], v1
  ds_read_b128 v[52:55], v5 offset:5120
  v_mov_b64 v[106:107], v[104:105]
  v_smfmac_f32_16x16x64_bf16 v[28:31], v[100:103], v[136:143], v1
  ds_read_b128 v[56:59], v5 offset:6144
  s_waitcnt lgkmcnt(6)
  v_mfma_f32_16x16x32_bf16 v[20:23], v[64:67], v[64:67], v[20:23]
  ds_read_b128 v[60:63], v5 offset:7168
  ds_read_b128 v[112:115], v90 offset:0
  v_mfma_f32_16x16x32_bf16 v[20:23], v[68:71], v[68:71], v[20:23]
  s_waitcnt lgkmcnt(4)
  v_cvt_pk_bf16_f32 v110, v28, v29
  v_cvt_pk_bf16_f32 v111, v30, v31
  v_mfma_f32_16x16x32_bf16 v[20:23], v[72:75], v[72:75], v[20:23]
  buffer_store_dwordx2 v[110:111], v3, s[4:7], s31 offen offset:2176 sc1
  v_mfma_f32_16x16x32_bf16 v[20:23], v[76:79], v[76:79], v[20:23]
  v_permlane32_swap_b32 v108, v110
  v_mfma_f32_16x16x32_bf16 v[24:27], v[32:35], v[64:67], 0
  v_permlane32_swap_b32 v109, v111
  v_mfma_f32_16x16x32_bf16 v[24:27], v[36:39], v[68:71], v[24:27]
  v_exp_f32 v20, v20
  v_mfma_f32_16x16x32_bf16 v[24:27], v[40:43], v[72:75], v[24:27]
  v_exp_f32 v21, v21
  v_mfma_f32_16x16x32_bf16 v[24:27], v[44:47], v[76:79], v[24:27]
  s_waitcnt lgkmcnt(1)
  v_exp_f32 v22, v22
  v_mfma_f32_16x16x32_bf16 v[80:83], v[48:51], v[64:67], 0
  v_exp_f32 v23, v23
  v_mfma_f32_16x16x32_bf16 v[80:83], v[52:55], v[68:71], v[80:83]
  v_exp_f32 v24, v24
  v_mfma_f32_16x16x32_bf16 v[80:83], v[56:59], v[72:75], v[80:83]
  v_exp_f32 v25, v25
  v_mfma_f32_16x16x32_bf16 v[80:83], v[60:63], v[76:79], v[80:83]
  v_exp_f32 v26, v26
  v_exp_f32 v27, v27
  v_cvt_pk_bf16_f32 v88, v20, v21
  v_cvt_pk_bf16_f32 v89, v22, v23
  v_cvt_pk_bf16_f32 v84, v24, v25
  v_cvt_pk_bf16_f32 v85, v26, v27
  v_mfma_f32_16x16x16_bf16 v[100:103], v[104:105], v[88:89], 0
  v_exp_f32 v80, v80
  v_mfma_f32_16x16x16_bf16 v[92:95], v[108:109], v[88:89], 0
  v_exp_f32 v81, v81
  v_mfma_f32_16x16x16_bf16 v[96:99], v[110:111], v[88:89], 0
  v_exp_f32 v82, v82
  v_exp_f32 v83, v83
  v_cvt_pk_bf16_f32 v86, v80, v81
  v_cvt_pk_bf16_f32 v87, v82, v83
  s_waitcnt vmcnt(6)
  v_mov_b64 v[20:21], 0
  v_mfma_f32_16x16x32_bf16 v[100:103], v[104:107], v[84:87], v[100:103]
  ds_read_b128 v[116:119], v90 offset:1024
  ds_read_b128 v[120:123], v90 offset:32768
  v_mfma_f32_16x16x32_bf16 v[92:95], v[12:15], v[84:87], v[92:95]
  ds_read_b128 v[124:127], v90 offset:33792
  ds_read_b128 v[32:35], v90 offset:2048
  v_mfma_f32_16x16x32_bf16 v[96:99], v[16:19], v[84:87], v[96:99]
  v_rcp_f32 v91, v100
  v_mov_b64 v[22:23], 0
  v_mul_f32 v92, v91, v92
  v_mov_b32_dpp v91, v91 row_ror:8 row_mask:0xf bank_mask:0xc
  v_mul_f32 v93, v91, v93
  v_mul_f32 v94, v91, v94
  v_mul_f32 v95, v91, v95
  v_mul_f32_dpp v92, v96, v91 row_ror:8 row_mask:0xf bank_mask:0xc
  v_mul_f32_dpp v93, v97, v91 row_ror:8 row_mask:0xf bank_mask:0xc
  v_mul_f32_dpp v94, v98, v91 row_ror:8 row_mask:0xf bank_mask:0xc
  v_mul_f32_dpp v95, v99, v91 row_ror:8 row_mask:0xf bank_mask:0xc
  v_cvt_pk_bf16_f32 v92, v92, v93
  v_cvt_pk_bf16_f32 v93, v94, v95
  ds_write_b64 v6, v[92:93] offset:28928
  v_subrev_u32 v91, 864026624, v91
  v_cmp_le_u32 vcc, s32, v91
  v_mov_b32_dpp v94, v92 row_ror:8 row_mask:0xf bank_mask:0xf
  v_mov_b32_dpp v95, v93 row_ror:8 row_mask:0xf bank_mask:0xf
  v_mov_b64 v[24:25], 0
  v_mov_b64 v[26:27], 0
  v_mov_b64 v[80:81], 0
  v_mov_b64 v[82:83], 0
  v_mov_b64 v[28:29], 0
  v_mov_b64 v[30:31], 0
  v_xor_b32 v5, 8192, v5
  s_cbranch_vccnz R_slow
R3_slowret:
  v_smfmac_f32_16x16x64_bf16 v[20:23], v[92:95], v[192:199], v1
  s_waitcnt lgkmcnt(0)
  s_barrier
  ds_read_b128 v[96:99], v2 offset:29952
  ds_read_b128 v[100:103], v2 offset:29440
  ds_read_b128 v[84:87], v2 offset:28928
  v_smfmac_f32_16x16x64_bf16 v[24:27], v[92:95], v[200:207], v1
  v_smfmac_f32_16x16x64_bf16 v[80:83], v[92:95], v[208:215], v1
  ds_read_b128 v[36:39], v90 offset:3072
  v_smfmac_f32_16x16x64_bf16 v[28:31], v[92:95], v[216:223], v1
  ds_read_b128 v[40:43], v90 offset:34816
  s_waitcnt lgkmcnt(4)
  v_smfmac_f32_16x16x64_bf16 v[20:23], v[96:99], v[224:231], v1
  ds_read_b128 v[44:47], v90 offset:35840
  s_waitcnt lgkmcnt(4)
  v_smfmac_f32_16x16x64_bf16 v[20:23], v[100:103], v[112:119], v1
  ds_read_b128 v[48:51], v90 offset:4096
  s_waitcnt lgkmcnt(4)
  v_smfmac_f32_16x16x64_bf16 v[20:23], v[84:87], v[120:127], v1
  ds_read_b128 v[52:55], v90 offset:5120
  ds_read_b128 v[56:59], v90 offset:36864
  v_smfmac_f32_16x16x64_bf16 v[24:27], v[96:99], v[232:239], v1
  ds_read_b128 v[60:63], v90 offset:37888
  ds_read_b128 v[64:67], v90 offset:6144
  s_waitcnt lgkmcnt(5)
  v_cvt_pk_bf16_f32 v20, v20, v21
  v_cvt_pk_bf16_f32 v21, v22, v23
  v_and_or_b32 v20, v20, -2, s25
  v_smfmac_f32_16x16x64_bf16 v[24:27], v[100:103], v[32:39], v1
  buffer_store_dwordx2 v[20:21], v9, s[4:7], s51 offen offset:0
  v_smfmac_f32_16x16x64_bf16 v[24:27], v[84:87], v[40:47], v1
  ds_read_b128 v[68:71], v90 offset:7168
  ds_read_b128 v[72:75], v90 offset:38912
  v_smfmac_f32_16x16x64_bf16 v[80:83], v[96:99], v[240:247], v1
  s_add_u32 s19, s19, 1
  ds_read_b128 v[76:79], v90 offset:39936
  s_waitcnt lgkmcnt(4)
  v_smfmac_f32_16x16x64_bf16 v[80:83], v[100:103], v[48:55], v1
  s_and_b32 s20, s19, 3
  s_lshl_b32 s20, s20, 13
  v_cvt_pk_bf16_f32 v24, v24, v25
  v_cvt_pk_bf16_f32 v25, v26, v27
  v_and_or_b32 v24, v24, -2, s25
  v_smfmac_f32_16x16x64_bf16 v[80:83], v[84:87], v[56:63], v1
  s_add_u32 s28, s20, s37
  buffer_store_dwordx2 v[24:25], v9, s[4:7], s51 offen offset:2048
  v_smfmac_f32_16x16x64_bf16 v[28:31], v[96:99], v[248:255], v1
  s_add_u32 s27, s20, 84934656
  s_waitcnt lgkmcnt(0)
  v_smfmac_f32_16x16x64_bf16 v[28:31], v[100:103], v[64:71], v1
  v_cvt_pk_bf16_f32 v80, v80, v81
  v_cvt_pk_bf16_f32 v81, v82, v83
  v_and_or_b32 v80, v80, -2, s25
  v_smfmac_f32_16x16x64_bf16 v[28:31], v[84:87], v[72:79], v1
  buffer_store_dwordx2 v[80:81], v9, s[4:7], s24 offen offset:0
  v_mov_b32 v104, 0x3f80
  v_cndmask_b32 v104, v104, 1.0, s[38:39]
  v_cndmask_b32 v100, 0, v104, s[40:41]
  v_cndmask_b32 v101, 0, v104, s[42:43]
  s_nop 1
  v_cvt_pk_bf16_f32 v28, v28, v29
  v_cvt_pk_bf16_f32 v29, v30, v31
  v_and_or_b32 v28, v28, -2, s25
  buffer_store_dwordx2 v[28:29], v9, s[4:7], s24 offen offset:2048
  v_cndmask_b32 v102, 0, v104, s[44:45]
  v_cndmask_b32 v103, 0, v104, s[46:47]
  v_lshrrev_b32 v98, 6, v5
  v_xnor_b32 v98, s19, v98
  v_mov_b64 v[20:21], 0
  v_mov_b64 v[22:23], 0
  v_mov_b64 v[24:25], 0
  v_mov_b64 v[26:27], 0
  v_mov_b64 v[28:29], 0
  v_mov_b64 v[30:31], 0
  ds_read_b128 v[32:35], v7 offset:0
  ds_read_b128 v[36:39], v7 offset:1024
  ds_read_b128 v[40:43], v7 offset:2048
  ds_read_b128 v[44:47], v7 offset:3072
  ds_read_b128 v[48:51], v7 offset:4096
  ds_read_b128 v[52:55], v7 offset:5120
  ds_read_b128 v[56:59], v7 offset:6144
  ds_read_b128 v[60:63], v7 offset:7168
  s_waitcnt vmcnt(1)
  buffer_load_dwordx4 v[112:115], v0, s[4:7], s3 offen sc1
  buffer_load_dwordx4 v[116:119], v0, s[4:7], s3 offen offset:1024 sc1
  s_waitcnt vmcnt(2)
  buffer_load_dwordx4 v[120:123], v0, s[4:7], s3 offen sc1
  buffer_load_dwordx4 v[124:127], v0, s[4:7], s3 offen offset:1024 sc1
  s_waitcnt vmcnt(3)
  v_mfma_f32_16x16x32_bf16 v[104:107], v[100:103], v[112:115], 0
  v_bitop3_b32 v96, v112, v114, v98 bitop3:0x7e
  s_waitcnt vmcnt(2)
  v_mfma_f32_16x16x32_bf16 v[104:107], v[100:103], v[116:119], v[104:107]
  v_bitop3_b32 v97, v116, v118, v98 bitop3:0x7e
  v_bitop3_b32 v96, v96, v97, 1 bitop3:0xa8
  v_cmp_ne_u32 vcc, 0, v96
  s_cbranch_vccz R3_redok
  buffer_load_dwordx4 v[112:115], v0, s[4:7], s3 offen sc1
  buffer_load_dwordx4 v[116:119], v0, s[4:7], s3 offen offset:1024 sc1
  s_waitcnt vmcnt(3)
  v_mfma_f32_16x16x32_bf16 v[104:107], v[100:103], v[120:123], 0
  v_bitop3_b32 v96, v120, v122, v98 bitop3:0x7e
  s_waitcnt vmcnt(2)
  v_mfma_f32_16x16x32_bf16 v[104:107], v[100:103], v[124:127], v[104:107]
  v_bitop3_b32 v97, v124, v126, v98 bitop3:0x7e
  v_bitop3_b32 v96, v96, v97, 1 bitop3:0xa8
  v_cmp_ne_u32 vcc, 0, v96
  s_cbranch_vccnz R3_red2
R3_redok:
  v_add_f32_dpp v104, v104, v104 row_ror:8 row_mask:0xf bank_mask:0xf
  v_add_f32_dpp v105, v105, v105 row_ror:8 row_mask:0xf bank_mask:0xf
  s_nop 0
  v_add_f32_dpp v104, v104, v104 row_ror:4 row_mask:0xf bank_mask:0xf
  v_add_f32_dpp v105, v105, v105 row_ror:4 row_mask:0xf bank_mask:0xf
  v_cvt_pk_bf16_f32 v104, v104, v105
  s_mov_b64 exec, s[48:49]
  buffer_store_dword v104, v10, s[4:7], s28 offen
  s_mov_b64 exec, -1
  s_branch R3_top
R3_red2:
  buffer_load_dwordx4 v[120:123], v0, s[4:7], s3 offen sc1
  buffer_load_dwordx4 v[124:127], v0, s[4:7], s3 offen offset:1024 sc1
  s_add_u32 s56, s56, 1
  s_waitcnt vmcnt(3)
  v_mfma_f32_16x16x32_bf16 v[104:107], v[100:103], v[112:115], 0
  v_bitop3_b32 v96, v112, v114, v98 bitop3:0x7e
  s_waitcnt vmcnt(2)
  v_mfma_f32_16x16x32_bf16 v[104:107], v[100:103], v[116:119], v[104:107]
  v_bitop3_b32 v97, v116, v118, v98 bitop3:0x7e
  v_bitop3_b32 v96, v96, v97, 1 bitop3:0xa8
  v_cmp_ne_u32 vcc, 0, v96
  s_cbranch_vccz R3_redok
  buffer_load_dwordx4 v[112:115], v0, s[4:7], s3 offen sc1
  buffer_load_dwordx4 v[116:119], v0, s[4:7], s3 offen offset:1024 sc1
  s_add_u32 s56, s56, 1
  s_waitcnt vmcnt(3)
  v_mfma_f32_16x16x32_bf16 v[104:107], v[100:103], v[120:123], 0
  v_bitop3_b32 v96, v120, v122, v98 bitop3:0x7e
  s_waitcnt vmcnt(2)
  v_mfma_f32_16x16x32_bf16 v[104:107], v[100:103], v[124:127], v[104:107]
  v_bitop3_b32 v97, v124, v126, v98 bitop3:0x7e
  v_bitop3_b32 v96, v96, v97, 1 bitop3:0xa8
  v_cmp_ne_u32 vcc, 0, v96
  s_cbranch_vccz R3_redok
  s_cmp_lt_u32 s56, 0x40000
  s_cbranch_scc1 R3_red2
  s_endpgm
R3_pollB:
  buffer_load_dwordx4 v[120:123], v0, s[4:7], s27 offen sc1
  buffer_load_dwordx4 v[124:127], v0, s[4:7], s27 offen offset:1024 sc1
  s_sub_u32 s18, s18, 1
  s_cmp_gt_i32 s18, 0
  s_cbranch_scc1 R3_poll
  s_endpgm
R_kvwait:
  v_bfe_u32 v96, v5, 4, 2
  v_lshlrev_b32 v96, 2, v96
  v_mov_b32 v97, s58
R_kv:
  buffer_load_dword v99, v96, s[4:7], s53 offen sc1
  s_waitcnt vmcnt(0)
  v_cmp_gt_u32 vcc, v97, v99
  s_cbranch_vccz R_kv_ok
  s_sleep 2
  s_sub_u32 s18, s18, 1
  s_cbranch_scc0 R_kv
  s_endpgm
    R_kv_ok:
  s_branch R_kvok
R_slow:
  s_cmp_eq_u32 s19, 63
  s_cbranch_scc1 R_done
  s_waitcnt lgkmcnt(0)
  v_xor_b32 v5, 8192, v5
  ds_read_b128 v[32:35], v5 offset:0
  ds_read_b128 v[36:39], v5 offset:1024
  ds_read_b128 v[40:43], v5 offset:2048
  ds_read_b128 v[44:47], v5 offset:3072
  ds_read_b128 v[48:51], v5 offset:4096
  ds_read_b128 v[52:55], v5 offset:5120
  ds_read_b128 v[56:59], v5 offset:6144
  ds_read_b128 v[60:63], v5 offset:7168
  v_xor_b32 v5, 8192, v5
  s_waitcnt lgkmcnt(0)
  ds_read_b64_tr_b16 v[64:65], v4 offset:24576
  ds_read_b64_tr_b16 v[66:67], v4 offset:24704
  ds_read_b64_tr_b16 v[68:69], v4 offset:24832
  ds_read_b64_tr_b16 v[70:71], v4 offset:24960
  ds_read_b64_tr_b16 v[72:73], v4 offset:25088
  ds_read_b64_tr_b16 v[74:75], v4 offset:25216
  ds_read_b64_tr_b16 v[76:77], v4 offset:25344
  ds_read_b64_tr_b16 v[78:79], v4 offset:25472
  v_mov_b32 v20, v11
  v_mov_b32 v21, v11
  v_mov_b32 v22, v11
  v_mov_b32 v23, v11
  s_waitcnt lgkmcnt(0)
  v_mfma_f32_16x16x32_bf16 v[24:27], v[32:35], v[64:67], 0
  v_mfma_f32_16x16x32_bf16 v[24:27], v[36:39], v[68:71], v[24:27]
  v_mfma_f32_16x16x32_bf16 v[24:27], v[40:43], v[72:75], v[24:27]
  v_mfma_f32_16x16x32_bf16 v[24:27], v[44:47], v[76:79], v[24:27]
  v_mfma_f32_16x16x32_bf16 v[80:83], v[48:51], v[64:67], 0
  v_mfma_f32_16x16x32_bf16 v[80:83], v[52:55], v[68:71], v[80:83]
  v_mfma_f32_16x16x32_bf16 v[80:83], v[56:59], v[72:75], v[80:83]
  v_mfma_f32_16x16x32_bf16 v[80:83], v[60:63], v[76:79], v[80:83]
  v_mfma_f32_16x16x32_bf16 v[20:23], v[64:67], v[64:67], v[20:23]
  v_mfma_f32_16x16x32_bf16 v[20:23], v[68:71], v[68:71], v[20:23]
  v_mfma_f32_16x16x32_bf16 v[20:23], v[72:75], v[72:75], v[20:23]
  v_mfma_f32_16x16x32_bf16 v[20:23], v[76:79], v[76:79], v[20:23]
  ds_read_b128 v[32:35], v90 offset:2048
  v_max3_f32 v92, v24, v25, v26
  v_max3_f32 v92, v92, v27, v80
  v_max3_f32 v92, v92, v81, v82
  s_nop 2
  v_max3_f32 v92, v92, v83, v20
  v_max3_f32 v92, v92, v21, v22
  v_max_f32 v92, v92, v23
  v_mov_b32 v93, v92
  s_nop 1
  v_permlane32_swap_b32 v92, v93
  v_max_f32 v92, v92, v93
  v_mov_b32 v93, v92
  s_nop 1
  v_permlane16_swap_b32 v92, v93
  v_max_f32 v92, v92, v93
  v_sub_f32 v24, v24, v92
  v_sub_f32 v25, v25, v92
  v_sub_f32 v26, v26, v92
  v_sub_f32 v27, v27, v92
  v_sub_f32 v80, v80, v92
  v_sub_f32 v81, v81, v92
  v_sub_f32 v82, v82, v92
  v_sub_f32 v83, v83, v92
  v_sub_f32 v20, v20, v92
  v_sub_f32 v21, v21, v92
  v_sub_f32 v22, v22, v92
  v_sub_f32 v23, v23, v92
  v_exp_f32 v24, v24
  v_exp_f32 v25, v25
  v_exp_f32 v26, v26
  v_exp_f32 v27, v27
  v_exp_f32 v80, v80
  v_exp_f32 v81, v81
  v_exp_f32 v82, v82
  v_exp_f32 v83, v83
  v_exp_f32 v20, v20
  v_exp_f32 v21, v21
  v_exp_f32 v22, v22
  v_exp_f32 v23, v23
  v_cvt_pk_bf16_f32 v84, v24, v25
  v_cvt_pk_bf16_f32 v85, v26, v27
  v_cvt_pk_bf16_f32 v86, v80, v81
  v_cvt_pk_bf16_f32 v87, v82, v83
  v_cvt_pk_bf16_f32 v88, v20, v21
  v_cvt_pk_bf16_f32 v89, v22, v23
  v_mfma_f32_16x16x32_bf16 v[100:103], v[104:107], v[84:87], 0
  v_mfma_f32_16x16x32_bf16 v[92:95], v[12:15], v[84:87], 0
  v_mfma_f32_16x16x32_bf16 v[96:99], v[16:19], v[84:87], 0
  v_mfma_f32_16x16x16_bf16 v[100:103], v[104:105], v[88:89], v[100:103]
  v_mfma_f32_16x16x16_bf16 v[92:95], v[108:109], v[88:89], v[92:95]
  v_mfma_f32_16x16x16_bf16 v[96:99], v[110:111], v[88:89], v[96:99]
  v_rcp_f32 v91, v100
  s_nop 1
  v_mov_b32_dpp v91, v91 row_ror:8 row_mask:0xf bank_mask:0xc
  v_mul_f32 v92, v91, v92
  v_mul_f32 v93, v91, v93
  v_mul_f32 v94, v91, v94
  v_mul_f32 v95, v91, v95
  v_mul_f32_dpp v92, v96, v91 row_ror:8 row_mask:0xf bank_mask:0xc
  v_mul_f32_dpp v93, v97, v91 row_ror:8 row_mask:0xf bank_mask:0xc
  v_mul_f32_dpp v94, v98, v91 row_ror:8 row_mask:0xf bank_mask:0xc
  v_mul_f32_dpp v95, v99, v91 row_ror:8 row_mask:0xf bank_mask:0xc
  v_cvt_pk_bf16_f32 v92, v92, v93
  v_cvt_pk_bf16_f32 v93, v94, v95
  ds_write_b64 v6, v[92:93] offset:28928
  v_mov_b32_dpp v94, v92 row_ror:8 row_mask:0xf bank_mask:0xf
  v_mov_b32_dpp v95, v93 row_ror:8 row_mask:0xf bank_mask:0xf
  v_mov_b64 v[24:25], 0
  v_mov_b64 v[26:27], 0
  v_mov_b64 v[80:81], 0
  v_mov_b64 v[82:83], 0
  v_mov_b64 v[28:29], 0
  v_mov_b64 v[30:31], 0
  v_mov_b64 v[20:21], 0
  v_mov_b64 v[22:23], 0
  s_waitcnt lgkmcnt(0)
  s_cmp_eq_u32 s16, 0
  s_cbranch_scc1 R0_slowret
  s_cmp_eq_u32 s16, 1
  s_cbranch_scc1 R1_slowret
  s_cmp_eq_u32 s16, 2
  s_cbranch_scc1 R2_slowret
  s_branch R3_slowret
R_done:
  s_waitcnt vmcnt(0) lgkmcnt(0)
  s_barrier
  s_cmp_eq_u32 s16, 0
  v_mov_b32 v8, 64
  s_cselect_b64 exec, 1, 0
  buffer_store_dword v8, off, s[4:7], s57 sc1
  s_mov_b64 exec, -1
  s_endpgm
.section .rodata,"a"
.p2align 6
.amdhsa_kernel concat_heads__mha_block__memory_aug_recurrent_mem_tr__prompt_kernel
  .amdhsa_next_free_vgpr 512
  .amdhsa_next_free_sgpr 102
  .amdhsa_accum_offset 256
  .amdhsa_group_segment_fixed_size 0
  .amdhsa_kernarg_size 104
  .amdhsa_user_sgpr_count 2
  .amdhsa_user_sgpr_kernarg_segment_ptr 1
  .amdhsa_system_sgpr_workgroup_id_x 1
  .amdhsa_float_denorm_mode_32 3
.end_amdhsa_kernel
```
